```python
import torch

def _softmax(x, axis=-1):
    return torch.softmax(x, dim=axis)
def _gelu(x):
    return torch.nn.functional.gelu(x, approximate="tanh")
def _silu(x):
    return torch.nn.functional.silu(x)
def _sigmoid(x):
    return torch.sigmoid(x)
def _layernorm(x, axis=-1, eps=1e-5):
    m = x.mean(dim=axis, keepdim=True)
    v = x.var(dim=axis, keepdim=True, unbiased=False)
    return (x - m) / torch.sqrt(v + eps)
def _scatter_add(tgt, idx, src, axis=0):
    return tgt.clone().index_add_(axis, idx, src)
def _segment_sum(src, seg, n):
    out = torch.zeros((n,) + src.shape[1:], dtype=src.dtype)
    return out.index_add_(0, seg, src)
def _pad(x, pw):
    flat = tuple(v for pair in reversed(pw) for v in pair)
    return torch.nn.functional.pad(x, flat)

kernel_name = 'standalone__gqa_softmax__near_ridge'

def setup_inputs():

    _w = (lambda a: (lambda t: t.to(torch.bfloat16) if t.is_floating_point() else t)(torch.as_tensor(a)))
    B, Hq, Hkv, Sq, Sk, D = 32, 16, 8, 384, 384, 256
    return {
        "q": _w((lambda *s: torch.randn(*s, dtype=torch.bfloat16) * 0.8)(B, Hq, Sq, D)),
        "k": _w((lambda *s: torch.randn(*s, dtype=torch.bfloat16) * 0.8)(B, Hkv, Sk, D)),
        "v": _w((lambda *s: torch.randn(*s, dtype=torch.bfloat16) * 0.05)(B, Hkv, Sk, D)),
    }

def reference(q, k, v):
    B, Hq, Sq, D = q.shape
    Hkv = k.shape[1]
    rep = Hq // Hkv
    k = (lambda x, n, axis: torch.repeat_interleave(x, n, dim=axis))(k, rep, axis=1)
    v = (lambda x, n, axis: torch.repeat_interleave(x, n, dim=axis))(v, rep, axis=1)
    scale = D ** -0.5
    scores = torch.einsum("bhqd,bhkd->bhqk", q, k) * scale
    p = _softmax(scores, axis=-1)
    return torch.einsum("bhqk,bhkd->bhqd", p, v)
```

```asm
; @launch grid=(256,1,1) block=(256,1,1) lds=163840
.amdgcn_target "amdgcn-amd-amdhsa--gfx950"
.text
.globl standalone__gqa_softmax__near_ridge_kernel
.p2align 8
.type standalone__gqa_softmax__near_ridge_kernel,@function
standalone__gqa_softmax__near_ridge_kernel:
    s_cmp_ge_u32 s2, 256
    s_cbranch_scc1 L_end
    s_load_dwordx4 s[4:7], s[0:1], 0
    s_load_dwordx4 s[12:15], s[0:1], 16
    s_getpc_b64 s[52:53]
L_pc:
    s_lshr_b32 s38, s2, 3
    s_lshl_b32 s38, s38, 11
    s_add_u32 s38, s38, L_head-L_pc
    v_and_b32 v2, 15, v0
    v_lshlrev_b32 v2, 7, v2
    v_bfe_u32 v3, v0, 4, 1
    v_mad_u32_u24 v2, v3, s38, v2
    v_min_u32 v2, L_slow-L_pc, v2
    v_mov_b32 v3, s53
    v_add_co_u32 v2, vcc, s52, v2
    s_nop 1
    v_addc_co_u32 v3, vcc, 0, v3, vcc
    global_load_dword v8, v[2:3], off
    v_lshrrev_b32 v247, 6, v0
    v_and_b32 v246, 63, v0
    v_readfirstlane_b32 s20, v247
    s_and_b32 s36, s2, 7
    s_mul_i32 s36, s36, 96
    s_lshr_b32 s26, s2, 3
    s_add_u32 s26, s26, s36
    s_cmp_lt_u32 s2, 240
    s_cselect_b32 s36, 0, 60
    s_cselect_b32 s54, 30, 3
    s_cselect_b32 s55, 60, 2
    s_cmp_lt_u32 s2, 248
    s_cselect_b32 s55, s55, 4
    s_add_u32 s26, s26, s36
    s_add_u32 s54, s54, s26
    s_add_u32 s55, s55, s26
    s_mov_b32 s25, 0
    s_lshl_b32 s23, s20, 12
    v_lshrrev_b32 v248, 3, v246
    v_and_b32 v249, 7, v246
    v_xor_b32 v249, v249, v248
    v_lshlrev_b32 v249, 4, v249
    v_lshl_add_u32 v232, v248, 9, v249
    v_add_u32 v233, 0xc00, v232
    v_add_u32 v234, 0x1800, v232
    v_add_u32 v235, 0x2400, v232
    s_lshr_b32 s96, s2, 3
    s_and_b32 s96, s96, 3
    s_lshl_b32 s96, s96, 7
    s_mul_hi_u32 s31, s26, 0x55555556
    s_mul_i32 s27, s31, 196608
    s_lshr_b32 s28, s23, 5
    s_xor_b32 s28, s28, s96
    s_add_u32 s28, s28, s27
    s_lshl_b32 s37, s26, 17
    s_lshl3_add_u32 s37, s23, s37
    s_or_b32 s32, s37, s96
    s_bitcmp0_b32 s2, 0
    s_cselect_b32 s39, 6, 0
    s_waitcnt lgkmcnt(0)
    s_mov_b32 s8, s6
    s_mov_b32 s9, s7
    s_mov_b32 s7, 0x20000
    s_mov_b32 s11, 0x20000
    s_mov_b32 s10, 50331648
    s_mov_b32 s6, 100663296
    s_add_u32 m0, s23, 0x14000
    s_add_u32 s34, s28, 0
    buffer_load_dwordx4 v232, s[8:11], s34 offen nt lds
    buffer_load_dwordx4 v233, s[8:11], s34 offen offset:1024 nt lds
    s_cmp_lt_u32 s39, 1
    s_cbranch_scc1 L_pw2
    s_waitcnt vmcnt(0)
L_pw2:
    buffer_load_dwordx4 v234, s[8:11], s34 offen offset:2048 nt lds
    buffer_load_dwordx4 v235, s[8:11], s34 offen offset:3072 nt lds
    s_cmp_lt_u32 s39, 2
    s_cbranch_scc1 L_pw4
    s_waitcnt vmcnt(0)
L_pw4:
    s_add_u32 m0, s23, 0x4000
    s_xor_b32 s34, s32, 0
    buffer_load_dwordx4 v232, s[4:7], s34 offen nt lds
    buffer_load_dwordx4 v233, s[4:7], s34 offen offset:1024 nt lds
    s_cmp_lt_u32 s39, 3
    s_cbranch_scc1 L_pw6
    s_waitcnt vmcnt(0)
L_pw6:
    buffer_load_dwordx4 v234, s[4:7], s34 offen offset:2048 nt lds
    buffer_load_dwordx4 v235, s[4:7], s34 offen offset:3072 nt lds
    s_cmp_lt_u32 s39, 4
    s_cbranch_scc1 L_pw8
    s_waitcnt vmcnt(0)
L_pw8:
    s_add_u32 m0, s23, 0x8000
    s_xor_b32 s34, s32, 0x4000
    buffer_load_dwordx4 v232, s[4:7], s34 offen nt lds
    buffer_load_dwordx4 v233, s[4:7], s34 offen offset:1024 nt lds
    s_cmp_lt_u32 s39, 5
    s_cbranch_scc1 L_pw10
    s_waitcnt vmcnt(0)
L_pw10:
    buffer_load_dwordx4 v234, s[4:7], s34 offen offset:2048 nt lds
    buffer_load_dwordx4 v235, s[4:7], s34 offen offset:3072 nt lds
    s_cmp_lt_u32 s39, 6
    s_cbranch_scc1 L_pw12
    s_waitcnt vmcnt(0)
L_pw12:
    s_mov_b32 s16, s14
    s_mov_b32 s17, s15
    s_mov_b32 s15, 0x20000
    s_mov_b32 s19, 0x20000
    s_mov_b32 s14, 50331648
    s_mov_b32 s18, 100663296
    s_lshl_b32 s30, s54, 17
    s_lshl3_add_u32 s30, s23, s30
    s_or_b32 s30, s30, s96
    s_and_b32 s36, s31, 3
    s_lshl_b32 s36, s36, 7
    s_lshl2_add_u32 s38, s23, s27
    s_add_u32 s40, s38, s36
    s_add_u32 s44, s37, s36
    s_xor_b32 s41, s40, 0x80
    s_xor_b32 s45, s44, 0x80
    s_xor_b32 s42, s40, 0x100
    s_xor_b32 s46, s44, 0x100
    s_xor_b32 s43, s40, 0x180
    s_xor_b32 s47, s44, 0x180
    s_mov_b32 s21, 0x3db8aa3b
    s_mov_b32 s24, 0xbdb8aa3b
    s_mov_b32 s22, 0x20800000
    v_and_b32 v248, 15, v246
    v_lshrrev_b32 v249, 4, v246
    v_and_b32 v250, 7, v246
    v_xor_b32 v251, v249, v250
    v_lshlrev_b32 v251, 4, v251
    v_lshl_add_u32 v224, v248, 7, v251
    v_xor_b32 v225, 64, v224
    v_add_u32 v226, 0x10000, v224
    v_add_u32 v4, s23, v224
    v_add_u32 v228, 0x18000, v4
    v_add_u32 v4, 0x4000, v4
    v_add_u32 v227, 0x10000, v225
    v_add_u32 v5, s23, v225
    v_add_u32 v229, 0x18000, v5
    v_add_u32 v5, 0x4000, v5
    v_lshrrev_b32 v251, 1, v249
    v_xor_b32 v251, v251, v250
    v_lshlrev_b32 v251, 4, v251
    v_lshl_add_u32 v251, v248, 7, v251
    v_and_b32 v252, 1, v249
    v_lshl_add_u32 v251, v252, 3, v251
    v_xor_b32 v251, 0x60, v251
    s_add_u32 s36, s23, 0x20000
    v_add_u32 v236, s36, v251
    v_lshlrev_b32 v251, 4, v246
    v_add_u32 v237, s36, v251
    v_lshrrev_b32 v251, 2, v246
    v_and_b32 v252, 7, v251
    v_bfe_u32 v253, v246, 1, 1
    v_xor_b32 v252, v252, v253
    v_lshlrev_b32 v252, 4, v252
    v_lshl_add_u32 v252, v251, 7, v252
    v_and_b32 v253, 1, v246
    v_lshl_add_u32 v252, v253, 3, v252
    v_xor_b32 v230, 0x60, v252
    v_add_u32 v231, 0x10000, v230
    v_and_b32 v251, 1, v246
    v_mul_u32_u24 v251, 0xaaaa, v251
    v_add_u32 v251, 0x4444, v251
    v_lshl_or_b32 v254, v251, 16, v251
    v_accvgpr_write_b32 a192, 0
    v_accvgpr_write_b32 a193, 0
    v_accvgpr_write_b32 a194, 0
    v_accvgpr_write_b32 a195, 0
    v_accvgpr_write_b32 a196, 0
    v_accvgpr_write_b32 a197, 0
    v_accvgpr_write_b32 a198, 0
    v_accvgpr_write_b32 a199, 0
    v_accvgpr_write_b32 a200, 0
    v_accvgpr_write_b32 a201, 0
    v_accvgpr_write_b32 a202, 0
    v_accvgpr_write_b32 a203, 0
    v_accvgpr_write_b32 a204, 0
    v_accvgpr_write_b32 a205, 0
    v_accvgpr_write_b32 a206, 0
    v_accvgpr_write_b32 a207, 0
    v_and_b32 v251, 2, v246
    v_mov_b32 v252, 0x3f803f80
    v_cmp_eq_u32 vcc, 0, v251
    s_nop 1
    v_cndmask_b32 v252, 0, v252, vcc
    v_accvgpr_write_b32 a208, v252
    v_accvgpr_write_b32 a209, v252
    v_accvgpr_write_b32 a210, v252
    v_accvgpr_write_b32 a211, v252
    v_lshrrev_b32 v252, 5, v246
    v_and_b32 v251, 31, v246
    v_lshlrev_b32 v252, 30, v252
    v_lshl_add_u32 v251, v251, 9, v252
    s_cmp_ge_u32 s2, 64
    s_cselect_b32 s36, 0x40000000, 0
    v_or_b32 v252, s36, v251
    s_add_u32 m0, s23, 0x18000
    s_xor_b32 s34, s32, 0x80
    buffer_load_dwordx4 v232, s[4:7], s34 offen nt lds
    buffer_load_dwordx4 v233, s[4:7], s34 offen offset:1024 nt lds
    buffer_load_dwordx4 v234, s[4:7], s34 offen offset:2048 nt lds
    buffer_load_dwordx4 v235, s[4:7], s34 offen offset:3072 nt lds
    s_add_u32 m0, s23, 0xc000
    s_xor_b32 s34, s32, 0x4080
    buffer_load_dwordx4 v232, s[4:7], s34 offen nt lds
    buffer_load_dwordx4 v233, s[4:7], s34 offen offset:1024 nt lds
    buffer_load_dwordx4 v234, s[4:7], s34 offen offset:2048 nt lds
    buffer_load_dwordx4 v235, s[4:7], s34 offen offset:3072 nt lds
    s_waitcnt vmcnt(12)
    ds_read_b128 a[0:3], v4 offset:0
    ds_read_b128 a[4:7], v5 offset:0
    ds_read_b128 a[32:35], v4 offset:2048
    ds_read_b128 a[36:39], v5 offset:2048
    s_add_u32 m0, s23, 0x10000
    s_xor_b32 s34, s32, 0x100
    buffer_load_dwordx4 v232, s[4:7], s34 offen nt lds
    buffer_load_dwordx4 v233, s[4:7], s34 offen offset:1024 nt lds
    buffer_load_dwordx4 v234, s[4:7], s34 offen offset:2048 nt lds
    buffer_load_dwordx4 v235, s[4:7], s34 offen offset:3072 nt lds
    s_waitcnt vmcnt(12)
    ds_read_b128 a[64:67], v4 offset:16384
    ds_read_b128 a[68:71], v5 offset:16384
    ds_read_b128 a[96:99], v4 offset:18432
    ds_read_b128 a[100:103], v5 offset:18432
    s_mov_b64 exec, 0
    s_cmp_eq_u32 s20, 0
    s_cbranch_scc1 L_hop0
    s_cmp_eq_u32 s20, 1
    s_cbranch_scc1 L_hop1
    s_cmp_eq_u32 s20, 2
    s_cbranch_scc1 L_hop2
    s_cmp_eq_u32 s20, 3
    s_cbranch_scc1 L_hop3
L_hopret0:
    s_mov_b64 exec, -1
    s_add_u32 m0, s23, 0x1c000
    s_xor_b32 s34, s32, 0x4100
    buffer_load_dwordx4 v232, s[4:7], s34 offen nt lds
    buffer_load_dwordx4 v233, s[4:7], s34 offen offset:1024 nt lds
    buffer_load_dwordx4 v234, s[4:7], s34 offen offset:2048 nt lds
    buffer_load_dwordx4 v235, s[4:7], s34 offen offset:3072 nt lds
    s_waitcnt vmcnt(12)
    ds_read_b128 a[8:11], v228 offset:0
    ds_read_b128 a[12:15], v229 offset:0
    ds_read_b128 a[40:43], v228 offset:2048
    ds_read_b128 a[44:47], v229 offset:2048
    s_mov_b64 exec, 0
    s_cmp_eq_u32 s20, 0
    s_cbranch_scc1 L_hop4
    s_cmp_eq_u32 s20, 1
    s_cbranch_scc1 L_hop5
    s_cmp_eq_u32 s20, 2
    s_cbranch_scc1 L_hop6
    s_cmp_eq_u32 s20, 3
    s_cbranch_scc1 L_hop7
L_hopret1:
    s_mov_b64 exec, -1
    s_add_u32 m0, s23, 0x20000
    s_xor_b32 s34, s32, 0x180
    buffer_load_dwordx4 v232, s[4:7], s34 offen nt lds
    buffer_load_dwordx4 v233, s[4:7], s34 offen offset:1024 nt lds
    buffer_load_dwordx4 v234, s[4:7], s34 offen offset:2048 nt lds
    buffer_load_dwordx4 v235, s[4:7], s34 offen offset:3072 nt lds
    s_waitcnt vmcnt(12)
    ds_read_b128 a[72:75], v4 offset:32768
    ds_read_b128 a[76:79], v5 offset:32768
    ds_read_b128 a[104:107], v4 offset:34816
    ds_read_b128 a[108:111], v5 offset:34816
    s_mov_b64 exec, 0
    s_cmp_eq_u32 s20, 0
    s_cbranch_scc1 L_hop8
    s_cmp_eq_u32 s20, 1
    s_cbranch_scc1 L_hop9
    s_cmp_eq_u32 s20, 2
    s_cbranch_scc1 L_hop10
    s_cmp_eq_u32 s20, 3
    s_cbranch_scc1 L_hop11
L_hopret2:
    s_mov_b64 exec, -1
    s_add_u32 m0, s23, 0x24000
    s_xor_b32 s34, s32, 0x4180
    buffer_load_dwordx4 v232, s[4:7], s34 offen nt lds
    buffer_load_dwordx4 v233, s[4:7], s34 offen offset:1024 nt lds
    buffer_load_dwordx4 v234, s[4:7], s34 offen offset:2048 nt lds
    buffer_load_dwordx4 v235, s[4:7], s34 offen offset:3072 nt lds
    s_waitcnt vmcnt(12)
    ds_read_b128 a[16:19], v4 offset:49152
    ds_read_b128 a[20:23], v5 offset:49152
    ds_read_b128 a[48:51], v4 offset:51200
    ds_read_b128 a[52:55], v5 offset:51200
    s_mov_b64 exec, 0
    s_cmp_eq_u32 s20, 0
    s_cbranch_scc1 L_hop12
    s_cmp_eq_u32 s20, 1
    s_cbranch_scc1 L_hop13
    s_cmp_eq_u32 s20, 2
    s_cbranch_scc1 L_hop14
L_hopret3:
    s_mov_b64 exec, -1
    s_barrier
    ds_read_b128 a[128:131], v226 offset:16384
    ds_read_b128 a[132:135], v227 offset:16384
    ds_read_b128 a[136:139], v226 offset:20480
    ds_read_b128 a[140:143], v227 offset:20480
    ds_read_b128 a[144:147], v226 offset:24576
    ds_read_b128 a[148:151], v227 offset:24576
    s_add_u32 m0, s23, 0
    s_add_u32 s34, s28, 0x4000
    buffer_load_dwordx4 v232, s[8:11], s34 offen nt lds
    buffer_load_dwordx4 v233, s[8:11], s34 offen offset:1024 nt lds
    buffer_load_dwordx4 v234, s[8:11], s34 offen offset:2048 nt lds
    buffer_load_dwordx4 v235, s[8:11], s34 offen offset:3072 nt lds
    s_waitcnt vmcnt(12)
    ds_read_b128 a[80:83], v228 offset:16384
    ds_read_b128 a[84:87], v229 offset:16384
    ds_read_b128 a[112:115], v228 offset:18432
    ds_read_b128 a[116:119], v229 offset:18432
    s_waitcnt lgkmcnt(14)
    s_add_u32 m0, s23, 0x4000
    s_add_u32 s34, s28, 0x8000
    buffer_load_dwordx4 v232, s[8:11], s34 offen nt lds
    buffer_load_dwordx4 v233, s[8:11], s34 offen offset:1024 nt lds
    buffer_load_dwordx4 v234, s[8:11], s34 offen offset:2048 nt lds
    buffer_load_dwordx4 v235, s[8:11], s34 offen offset:3072 nt lds
    s_waitcnt lgkmcnt(0)
    s_branch L_head
.p2align 12
L_head:
    v_mfma_f32_16x16x32_bf16 v[192:195], a[128:131], a[0:3], 0
L_hop0:
    s_cbranch_execz L_hopret0
    s_add_u32 m0, s23, 0x8000
    ds_read_b128 a[152:155], v226 offset:28672
    v_mfma_f32_16x16x32_bf16 v[192:195], a[132:135], a[4:7], v[192:195]
    v_mfma_f32_16x16x32_bf16 v[196:199], a[132:135], a[36:39], 0
    s_add_u32 s34, s28, 0xc000
    v_mfma_f32_16x16x32_bf16 v[196:199], a[128:131], a[32:35], v[196:199]
    v_mfma_f32_16x16x32_bf16 v[200:203], a[128:131], a[64:67], 0
    ds_read_b128 a[156:159], v227 offset:28672
    v_mfma_f32_16x16x32_bf16 v[200:203], a[132:135], a[68:71], v[200:203]
    s_waitcnt vmcnt(12)
    ds_read_b128 a[24:27], v228 offset:32768
    v_mfma_f32_16x16x32_bf16 v[204:207], a[132:135], a[100:103], 0
    v_mfma_f32_16x16x32_bf16 v[204:207], a[128:131], a[96:99], v[204:207]
    ds_read_b128 a[28:31], v229 offset:32768
    v_mfma_f32_16x16x32_bf16 v[204:207], a[136:139], a[104:107], v[204:207]
    ds_read_b128 a[128:131], v226 offset:18432
    v_mfma_f32_16x16x32_bf16 v[204:207], a[140:143], a[108:111], v[204:207]
    buffer_load_dwordx4 v232, s[8:11], s34 offen nt lds
    v_mfma_f32_16x16x32_bf16 v[200:203], a[140:143], a[76:79], v[200:203]
    ds_read_b128 a[56:59], v228 offset:34816
    v_mfma_f32_16x16x32_bf16 v[200:203], a[136:139], a[72:75], v[200:203]
    ds_read_b128 a[60:63], v229 offset:34816
    v_mfma_f32_16x16x32_bf16 v[196:199], a[136:139], a[40:43], v[196:199]
    ds_read_b128 a[132:135], v227 offset:18432
    v_mfma_f32_16x16x32_bf16 v[196:199], a[140:143], a[44:47], v[196:199]
    s_waitcnt vmcnt(9)
    ds_read_b128 a[88:91], v228 offset:49152
    v_mfma_f32_16x16x32_bf16 v[192:195], a[140:143], a[12:15], v[192:195]
    ds_read_b128 a[92:95], v229 offset:49152
    v_mfma_f32_16x16x32_bf16 v[192:195], a[136:139], a[8:11], v[192:195]
    s_waitcnt lgkmcnt(8)
    ds_read_b128 a[120:123], v228 offset:51200
    v_mfma_f32_16x16x32_bf16 v[192:195], a[144:147], a[16:19], v[192:195]
    ds_read_b128 a[136:139], v226 offset:22528
    v_mfma_f32_16x16x32_bf16 v[192:195], a[148:151], a[20:23], v[192:195]
    ds_read_b128 a[124:127], v229 offset:51200
    v_mfma_f32_16x16x32_bf16 v[196:199], a[148:151], a[52:55], v[196:199]
    v_mfma_f32_16x16x32_bf16 v[196:199], a[144:147], a[48:51], v[196:199]
    buffer_load_dwordx4 v233, s[8:11], s34 offen offset:1024 nt lds
    v_mfma_f32_16x16x32_bf16 v[200:203], a[144:147], a[80:83], v[200:203]
    ds_read_b128 a[140:143], v227 offset:22528
    v_mfma_f32_16x16x32_bf16 v[200:203], a[148:151], a[84:87], v[200:203]
    v_mfma_f32_16x16x32_bf16 v[204:207], a[148:151], a[116:119], v[204:207]
    v_mfma_f32_16x16x32_bf16 v[204:207], a[144:147], a[112:115], v[204:207]
    s_waitcnt lgkmcnt(1)
    v_mfma_f32_16x16x32_bf16 v[204:207], a[152:155], a[120:123], v[204:207]
    ds_read_b128 a[144:147], v226 offset:26624
    v_mfma_f32_16x16x32_bf16 v[204:207], a[156:159], a[124:127], v[204:207]
    v_mfma_f32_16x16x32_bf16 v[200:203], a[156:159], a[92:95], v[200:203]
    s_nop 0
    v_mfma_f32_16x16x32_bf16 v[200:203], a[152:155], a[88:91], v[200:203]
    s_nop 0
    v_mfma_f32_16x16x32_bf16 v[196:199], a[152:155], a[56:59], v[196:199]
    ds_read_b128 a[148:151], v227 offset:26624
    v_mfma_f32_16x16x32_bf16 v[196:199], a[156:159], a[60:63], v[196:199]
    buffer_load_dwordx4 v234, s[8:11], s34 offen offset:2048 nt lds
    v_mfma_f32_16x16x32_bf16 v[192:195], a[156:159], a[28:31], v[192:195]
    v_max3_f32 v241, v204, v205, v206
    v_max_f32 v241, v241, v207
    v_mfma_f32_16x16x32_bf16 v[192:195], a[152:155], a[24:27], v[192:195]
    s_waitcnt lgkmcnt(2)
    v_max3_f32 v240, v200, v201, v202
    v_max_f32 v240, v240, v203
    v_mfma_f32_16x16x32_bf16 v[208:211], a[128:131], a[0:3], 0
    ds_read_b128 a[152:155], v226 offset:30720
    v_max3_f32 v239, v196, v197, v198
    v_mfma_f32_16x16x32_bf16 v[208:211], a[132:135], a[4:7], v[208:211]
    v_max_f32 v239, v239, v199
    v_max3_f32 v238, v192, v193, v194
    v_max_f32 v238, v238, v195
    v_mfma_f32_16x16x32_bf16 v[212:215], a[132:135], a[36:39], 0
    s_nop 0
    v_permlane32_swap_b32 v239, v241
    v_permlane32_swap_b32 v238, v240
    v_mfma_f32_16x16x32_bf16 v[212:215], a[128:131], a[32:35], v[212:215]
    v_max_f32 v239, v239, v241
    v_max_f32 v238, v238, v240
    v_mfma_f32_16x16x32_bf16 v[216:219], a[128:131], a[64:67], 0
    s_nop 0
    ds_read_b128 a[156:159], v227 offset:30720
    v_permlane16_swap_b32 v238, v239
    v_mfma_f32_16x16x32_bf16 v[216:219], a[132:135], a[68:71], v[216:219]
    v_max_f32 v239, v238, v239
    v_mul_f32 v238, s24, v239
    v_mul_f32 v239, s24, v239
    v_mfma_f32_16x16x32_bf16 v[220:223], a[132:135], a[100:103], 0
    s_nop 0
    v_permlane16_swap_b32 v238, v239
    v_mov_b32 v240, v238
    v_mov_b32 v241, v239
    v_mfma_f32_16x16x32_bf16 v[220:223], a[128:131], a[96:99], v[220:223]
    s_nop 0
    v_permlane32_swap_b32 v238, v240
    v_permlane32_swap_b32 v239, v241
    v_mfma_f32_16x16x32_bf16 v[220:223], a[136:139], a[104:107], v[220:223]
    v_fma_f32 v200, v200, s21, v240
    v_fma_f32 v201, v201, s21, v240
    v_mfma_f32_16x16x32_bf16 v[220:223], a[140:143], a[108:111], v[220:223]
    buffer_load_dwordx4 v235, s[8:11], s34 offen offset:3072 nt lds
    v_exp_f32 v200, v200
    v_mfma_f32_16x16x32_bf16 v[216:219], a[140:143], a[76:79], v[216:219]
    v_exp_f32 v201, v201
    v_mfma_f32_16x16x32_bf16 v[216:219], a[136:139], a[72:75], v[216:219]
    v_fma_f32 v202, v202, s21, v240
    v_fma_f32 v203, v203, s21, v240
    v_mfma_f32_16x16x32_bf16 v[212:215], a[136:139], a[40:43], v[212:215]
    v_exp_f32 v202, v202
    v_mfma_f32_16x16x32_bf16 v[212:215], a[140:143], a[44:47], v[212:215]
    v_cvt_pk_bf16_f32 v16, v200, v201
    v_exp_f32 v203, v203
    v_mfma_f32_16x16x32_bf16 v[208:211], a[140:143], a[12:15], v[208:211]
    v_fma_f32 v192, v192, s21, v238
    v_fma_f32 v193, v193, s21, v238
    v_mfma_f32_16x16x32_bf16 v[208:211], a[136:139], a[8:11], v[208:211]
    s_waitcnt vmcnt(8) lgkmcnt(0)
    s_barrier
    v_exp_f32 v192, v192
    v_mfma_f32_16x16x32_bf16 v[208:211], a[144:147], a[16:19], v[208:211]
    s_add_u32 m0, s23, 0x1c000
    ds_read_b128 a[128:131], v224 offset:0
    v_cvt_pk_bf16_f32 v17, v202, v203
    v_mfma_f32_16x16x32_bf16 v[208:211], a[148:151], a[20:23], v[208:211]
    ds_read_b128 a[132:135], v225 offset:0
    v_exp_f32 v193, v193
    v_fma_f32 v194, v194, s21, v238
    v_fma_f32 v195, v195, s21, v238
    v_mfma_f32_16x16x32_bf16 v[212:215], a[148:151], a[52:55], v[212:215]
    s_add_u32 s34, s28, 0x10000
    v_exp_f32 v194, v194
    v_mfma_f32_16x16x32_bf16 v[212:215], a[144:147], a[48:51], v[212:215]
    v_cvt_pk_bf16_f32 v0, v192, v193
    v_exp_f32 v195, v195
    v_mfma_f32_16x16x32_bf16 v[216:219], a[144:147], a[80:83], v[216:219]
    ds_read_b128 a[136:139], v224 offset:4096
    v_fma_f32 v196, v196, s21, v239
    v_mfma_f32_16x16x32_bf16 v[216:219], a[148:151], a[84:87], v[216:219]
    ds_read_b128 a[140:143], v225 offset:4096
    v_fma_f32 v197, v197, s21, v239
    v_exp_f32 v196, v196
    v_cvt_pk_bf16_f32 v1, v194, v195
    v_exp_f32 v197, v197
    v_mfma_f32_16x16x32_bf16 v[220:223], a[148:151], a[116:119], v[220:223]
    v_fma_f32 v198, v198, s21, v239
    v_fma_f32 v199, v199, s21, v239
    v_mfma_f32_16x16x32_bf16 v[220:223], a[144:147], a[112:115], v[220:223]
    v_exp_f32 v198, v198
    v_mfma_f32_16x16x32_bf16 v[220:223], a[152:155], a[120:123], v[220:223]
    ds_read_b128 a[144:147], v224 offset:8192
    v_cvt_pk_bf16_f32 v8, v196, v197
    v_mfma_f32_16x16x32_bf16 v[220:223], a[156:159], a[124:127], v[220:223]
    v_exp_f32 v199, v199
    v_mfma_f32_16x16x32_bf16 v[216:219], a[156:159], a[92:95], v[216:219]
    v_fma_f32 v204, v204, s21, v241
    v_fma_f32 v205, v205, s21, v241
    v_mfma_f32_16x16x32_bf16 v[216:219], a[152:155], a[88:91], v[216:219]
    buffer_load_dwordx4 v232, s[8:11], s34 offen nt lds
    v_exp_f32 v204, v204
    v_mfma_f32_16x16x32_bf16 v[212:215], a[152:155], a[56:59], v[212:215]
    ds_read_b128 a[148:151], v225 offset:8192
    v_cvt_pk_bf16_f32 v9, v198, v199
    v_mfma_f32_16x16x32_bf16 v[212:215], a[156:159], a[60:63], v[212:215]
    v_exp_f32 v205, v205
    v_fma_f32 v206, v206, s21, v241
    v_fma_f32 v207, v207, s21, v241
    v_mfma_f32_16x16x32_bf16 v[208:211], a[156:159], a[28:31], v[208:211]
    v_exp_f32 v206, v206
    v_mfma_f32_16x16x32_bf16 v[208:211], a[152:155], a[24:27], v[208:211]
    s_waitcnt lgkmcnt(2)
    v_cvt_pk_bf16_f32 v24, v204, v205
    v_exp_f32 v207, v207
    v_mfma_f32_16x16x32_bf16 v[192:195], a[128:131], a[0:3], 0
    ds_read_b128 a[152:155], v224 offset:12288
    v_fma_f32 v216, v216, s21, v240
    v_mfma_f32_16x16x32_bf16 v[192:195], a[132:135], a[4:7], v[192:195]
    v_exp_f32 v216, v216
    v_mfma_f32_16x16x32_bf16 v[196:199], a[132:135], a[36:39], 0
    v_cvt_pk_bf16_f32 v25, v206, v207
    v_fma_f32 v217, v217, s21, v240
    v_mfma_f32_16x16x32_bf16 v[196:199], a[128:131], a[32:35], v[196:199]
    v_exp_f32 v217, v217
    v_mfma_f32_16x16x32_bf16 v[200:203], a[128:131], a[64:67], 0
    ds_read_b128 a[156:159], v225 offset:12288
    v_fma_f32 v218, v218, s21, v240
    v_mfma_f32_16x16x32_bf16 v[200:203], a[132:135], a[68:71], v[200:203]
    v_exp_f32 v218, v218
    v_mfma_f32_16x16x32_bf16 v[204:207], a[132:135], a[100:103], 0
    v_cvt_pk_bf16_f32 v18, v216, v217
    v_fma_f32 v219, v219, s21, v240
    v_mfma_f32_16x16x32_bf16 v[204:207], a[128:131], a[96:99], v[204:207]
    v_exp_f32 v219, v219
    v_mfma_f32_16x16x32_bf16 v[204:207], a[136:139], a[104:107], v[204:207]
    ds_read_b128 a[128:131], v224 offset:2048
    v_fma_f32 v208, v208, s21, v238
    v_mfma_f32_16x16x32_bf16 v[204:207], a[140:143], a[108:111], v[204:207]
    buffer_load_dwordx4 v233, s[8:11], s34 offen offset:1024 nt lds
    v_exp_f32 v208, v208
    v_mfma_f32_16x16x32_bf16 v[200:203], a[140:143], a[76:79], v[200:203]
    v_cvt_pk_bf16_f32 v19, v218, v219
    v_fma_f32 v209, v209, s21, v238
    v_mfma_f32_16x16x32_bf16 v[200:203], a[136:139], a[72:75], v[200:203]
    v_exp_f32 v209, v209
    v_mfma_f32_16x16x32_bf16 v[196:199], a[136:139], a[40:43], v[196:199]
    ds_read_b128 a[132:135], v225 offset:2048
    v_fma_f32 v210, v210, s21, v238
    v_mfma_f32_16x16x32_bf16 v[196:199], a[140:143], a[44:47], v[196:199]
    v_exp_f32 v210, v210
    v_mfma_f32_16x16x32_bf16 v[192:195], a[140:143], a[12:15], v[192:195]
    v_cvt_pk_bf16_f32 v2, v208, v209
    v_fma_f32 v211, v211, s21, v238
    v_mfma_f32_16x16x32_bf16 v[192:195], a[136:139], a[8:11], v[192:195]
    s_waitcnt lgkmcnt(2)
    v_exp_f32 v211, v211
    v_mfma_f32_16x16x32_bf16 v[192:195], a[144:147], a[16:19], v[192:195]
    ds_read_b128 a[136:139], v224 offset:6144
    v_fma_f32 v212, v212, s21, v239
    v_mfma_f32_16x16x32_bf16 v[192:195], a[148:151], a[20:23], v[192:195]
    v_exp_f32 v212, v212
    v_mfma_f32_16x16x32_bf16 v[196:199], a[148:151], a[52:55], v[196:199]
    v_cvt_pk_bf16_f32 v3, v210, v211
    v_fma_f32 v213, v213, s21, v239
    v_mfma_f32_16x16x32_bf16 v[196:199], a[144:147], a[48:51], v[196:199]
    v_exp_f32 v213, v213
    v_mfma_f32_16x16x32_bf16 v[200:203], a[144:147], a[80:83], v[200:203]
    ds_read_b128 a[140:143], v225 offset:6144
    v_fma_f32 v214, v214, s21, v239
    v_mfma_f32_16x16x32_bf16 v[200:203], a[148:151], a[84:87], v[200:203]
    v_exp_f32 v214, v214
    v_mfma_f32_16x16x32_bf16 v[204:207], a[148:151], a[116:119], v[204:207]
    v_cvt_pk_bf16_f32 v10, v212, v213
    v_fma_f32 v215, v215, s21, v239
    v_mfma_f32_16x16x32_bf16 v[204:207], a[144:147], a[112:115], v[204:207]
    v_exp_f32 v215, v215
    v_mfma_f32_16x16x32_bf16 v[204:207], a[152:155], a[120:123], v[204:207]
    ds_read_b128 a[144:147], v224 offset:10240
    v_fma_f32 v220, v220, s21, v241
    v_mfma_f32_16x16x32_bf16 v[204:207], a[156:159], a[124:127], v[204:207]
    buffer_load_dwordx4 v234, s[8:11], s34 offen offset:2048 nt lds
    v_exp_f32 v220, v220
    v_mfma_f32_16x16x32_bf16 v[200:203], a[156:159], a[92:95], v[200:203]
    v_cvt_pk_bf16_f32 v11, v214, v215
    v_fma_f32 v221, v221, s21, v241
    v_mfma_f32_16x16x32_bf16 v[200:203], a[152:155], a[88:91], v[200:203]
    v_exp_f32 v221, v221
    v_mfma_f32_16x16x32_bf16 v[196:199], a[152:155], a[56:59], v[196:199]
    ds_read_b128 a[148:151], v225 offset:10240
    v_fma_f32 v222, v222, s21, v241
    v_mfma_f32_16x16x32_bf16 v[196:199], a[156:159], a[60:63], v[196:199]
    v_exp_f32 v222, v222
    v_mfma_f32_16x16x32_bf16 v[192:195], a[156:159], a[28:31], v[192:195]
    v_cvt_pk_bf16_f32 v26, v220, v221
    v_fma_f32 v223, v223, s21, v241
    v_mfma_f32_16x16x32_bf16 v[192:195], a[152:155], a[24:27], v[192:195]
    s_waitcnt lgkmcnt(2)
    v_exp_f32 v223, v223
    v_mfma_f32_16x16x32_bf16 v[208:211], a[128:131], a[0:3], 0
    ds_read_b128 a[152:155], v224 offset:14336
    v_fma_f32 v200, v200, s21, v240
    v_mfma_f32_16x16x32_bf16 v[208:211], a[132:135], a[4:7], v[208:211]
    v_exp_f32 v200, v200
    v_mfma_f32_16x16x32_bf16 v[212:215], a[132:135], a[36:39], 0
    v_cvt_pk_bf16_f32 v27, v222, v223
    v_fma_f32 v201, v201, s21, v240
    v_mfma_f32_16x16x32_bf16 v[212:215], a[128:131], a[32:35], v[212:215]
    v_exp_f32 v201, v201
    v_mfma_f32_16x16x32_bf16 v[216:219], a[128:131], a[64:67], 0
    ds_read_b128 a[156:159], v225 offset:14336
    v_fma_f32 v202, v202, s21, v240
    v_mfma_f32_16x16x32_bf16 v[216:219], a[132:135], a[68:71], v[216:219]
    v_exp_f32 v202, v202
    v_mfma_f32_16x16x32_bf16 v[220:223], a[132:135], a[100:103], 0
    v_cvt_pk_bf16_f32 v20, v200, v201
    v_fma_f32 v203, v203, s21, v240
    v_mfma_f32_16x16x32_bf16 v[220:223], a[128:131], a[96:99], v[220:223]
    v_exp_f32 v203, v203
    v_mfma_f32_16x16x32_bf16 v[220:223], a[136:139], a[104:107], v[220:223]
    buffer_load_dwordx4 v235, s[8:11], s34 offen offset:3072 nt lds
    v_fma_f32 v192, v192, s21, v238
    v_mfma_f32_16x16x32_bf16 v[220:223], a[140:143], a[108:111], v[220:223]
    v_exp_f32 v192, v192
    v_mfma_f32_16x16x32_bf16 v[216:219], a[140:143], a[76:79], v[216:219]
    v_cvt_pk_bf16_f32 v21, v202, v203
    v_fma_f32 v193, v193, s21, v238
    v_mfma_f32_16x16x32_bf16 v[216:219], a[136:139], a[72:75], v[216:219]
    v_exp_f32 v193, v193
    v_mfma_f32_16x16x32_bf16 v[212:215], a[136:139], a[40:43], v[212:215]
    v_fma_f32 v194, v194, s21, v238
    v_mfma_f32_16x16x32_bf16 v[212:215], a[140:143], a[44:47], v[212:215]
    v_exp_f32 v194, v194
    v_mfma_f32_16x16x32_bf16 v[208:211], a[140:143], a[12:15], v[208:211]
    v_cvt_pk_bf16_f32 v4, v192, v193
    v_fma_f32 v195, v195, s21, v238
    v_mfma_f32_16x16x32_bf16 v[208:211], a[136:139], a[8:11], v[208:211]
    s_waitcnt vmcnt(8) lgkmcnt(0)
    s_barrier
    v_exp_f32 v195, v195
    v_mfma_f32_16x16x32_bf16 v[208:211], a[144:147], a[16:19], v[208:211]
    s_add_u32 m0, s23, 0xc000
    ds_read_b128 a[128:131], v224 offset:16384
    v_fma_f32 v196, v196, s21, v239
    v_mfma_f32_16x16x32_bf16 v[208:211], a[148:151], a[20:23], v[208:211]
    ds_read_b128 a[132:135], v225 offset:16384
    v_exp_f32 v196, v196
    v_mfma_f32_16x16x32_bf16 v[212:215], a[148:151], a[52:55], v[212:215]
    s_add_u32 s34, s28, 0x14000
    v_cvt_pk_bf16_f32 v5, v194, v195
    v_fma_f32 v197, v197, s21, v239
    v_mfma_f32_16x16x32_bf16 v[212:215], a[144:147], a[48:51], v[212:215]
    v_exp_f32 v197, v197
    v_mfma_f32_16x16x32_bf16 v[216:219], a[144:147], a[80:83], v[216:219]
    ds_read_b128 a[136:139], v224 offset:20480
    v_fma_f32 v198, v198, s21, v239
    v_mfma_f32_16x16x32_bf16 v[216:219], a[148:151], a[84:87], v[216:219]
    ds_read_b128 a[140:143], v225 offset:20480
    v_exp_f32 v198, v198
    v_mfma_f32_16x16x32_bf16 v[220:223], a[148:151], a[116:119], v[220:223]
    v_cvt_pk_bf16_f32 v12, v196, v197
    v_fma_f32 v199, v199, s21, v239
    v_mfma_f32_16x16x32_bf16 v[220:223], a[144:147], a[112:115], v[220:223]
    v_exp_f32 v199, v199
    v_mfma_f32_16x16x32_bf16 v[220:223], a[152:155], a[120:123], v[220:223]
    ds_read_b128 a[144:147], v224 offset:24576
    v_fma_f32 v204, v204, s21, v241
    v_mfma_f32_16x16x32_bf16 v[220:223], a[156:159], a[124:127], v[220:223]
    v_exp_f32 v204, v204
    v_mfma_f32_16x16x32_bf16 v[216:219], a[156:159], a[92:95], v[216:219]
    v_cvt_pk_bf16_f32 v13, v198, v199
    v_fma_f32 v205, v205, s21, v241
    v_mfma_f32_16x16x32_bf16 v[216:219], a[152:155], a[88:91], v[216:219]
    buffer_load_dwordx4 v232, s[8:11], s34 offen nt lds
    v_exp_f32 v205, v205
    v_mfma_f32_16x16x32_bf16 v[212:215], a[152:155], a[56:59], v[212:215]
    ds_read_b128 a[148:151], v225 offset:24576
    v_fma_f32 v206, v206, s21, v241
    v_mfma_f32_16x16x32_bf16 v[212:215], a[156:159], a[60:63], v[212:215]
    v_exp_f32 v206, v206
    v_mfma_f32_16x16x32_bf16 v[208:211], a[156:159], a[28:31], v[208:211]
    v_cvt_pk_bf16_f32 v28, v204, v205
    v_fma_f32 v207, v207, s21, v241
    v_mfma_f32_16x16x32_bf16 v[208:211], a[152:155], a[24:27], v[208:211]
    s_waitcnt lgkmcnt(2)
    v_exp_f32 v207, v207
    v_mfma_f32_16x16x32_bf16 v[192:195], a[128:131], a[0:3], 0
    ds_read_b128 a[152:155], v224 offset:28672
    v_fma_f32 v216, v216, s21, v240
    v_mfma_f32_16x16x32_bf16 v[192:195], a[132:135], a[4:7], v[192:195]
    v_exp_f32 v216, v216
    v_mfma_f32_16x16x32_bf16 v[196:199], a[132:135], a[36:39], 0
    v_cvt_pk_bf16_f32 v29, v206, v207
    v_fma_f32 v217, v217, s21, v240
    v_mfma_f32_16x16x32_bf16 v[196:199], a[128:131], a[32:35], v[196:199]
    v_exp_f32 v217, v217
    v_mfma_f32_16x16x32_bf16 v[200:203], a[128:131], a[64:67], 0
    ds_read_b128 a[156:159], v225 offset:28672
    v_fma_f32 v218, v218, s21, v240
    v_mfma_f32_16x16x32_bf16 v[200:203], a[132:135], a[68:71], v[200:203]
    v_exp_f32 v218, v218
    v_mfma_f32_16x16x32_bf16 v[204:207], a[132:135], a[100:103], 0
    v_cvt_pk_bf16_f32 v22, v216, v217
    v_fma_f32 v219, v219, s21, v240
    v_mfma_f32_16x16x32_bf16 v[204:207], a[128:131], a[96:99], v[204:207]
    v_exp_f32 v219, v219
    v_mfma_f32_16x16x32_bf16 v[204:207], a[136:139], a[104:107], v[204:207]
    ds_read_b128 a[128:131], v224 offset:18432
    v_fma_f32 v208, v208, s21, v238
    v_mfma_f32_16x16x32_bf16 v[204:207], a[140:143], a[108:111], v[204:207]
    v_exp_f32 v208, v208
    v_mfma_f32_16x16x32_bf16 v[200:203], a[140:143], a[76:79], v[200:203]
    v_cvt_pk_bf16_f32 v23, v218, v219
    v_fma_f32 v209, v209, s21, v238
    v_mfma_f32_16x16x32_bf16 v[200:203], a[136:139], a[72:75], v[200:203]
    v_exp_f32 v209, v209
    v_mfma_f32_16x16x32_bf16 v[196:199], a[136:139], a[40:43], v[196:199]
    ds_read_b128 a[132:135], v225 offset:18432
    v_fma_f32 v210, v210, s21, v238
    v_mfma_f32_16x16x32_bf16 v[196:199], a[140:143], a[44:47], v[196:199]
    v_exp_f32 v210, v210
    v_mfma_f32_16x16x32_bf16 v[192:195], a[140:143], a[12:15], v[192:195]
    v_cvt_pk_bf16_f32 v6, v208, v209
    v_fma_f32 v211, v211, s21, v238
    v_mfma_f32_16x16x32_bf16 v[192:195], a[136:139], a[8:11], v[192:195]
    s_waitcnt lgkmcnt(2)
    v_exp_f32 v211, v211
    v_smfmac_f32_16x16x64_bf16 a[200:203], a[208:211], v[16:23], v254
    buffer_load_dwordx4 v233, s[8:11], s34 offen offset:1024 nt lds
    v_mfma_f32_16x16x32_bf16 v[192:195], a[144:147], a[16:19], v[192:195]
    ds_read_b128 a[136:139], v224 offset:22528
    v_fma_f32 v212, v212, s21, v239
    v_mfma_f32_16x16x32_bf16 v[192:195], a[148:151], a[20:23], v[192:195]
    v_exp_f32 v212, v212
    v_mfma_f32_16x16x32_bf16 v[196:199], a[148:151], a[52:55], v[196:199]
    v_cvt_pk_bf16_f32 v7, v210, v211
    v_fma_f32 v213, v213, s21, v239
    v_mfma_f32_16x16x32_bf16 v[196:199], a[144:147], a[48:51], v[196:199]
    v_exp_f32 v213, v213
    v_mfma_f32_16x16x32_bf16 v[200:203], a[144:147], a[80:83], v[200:203]
    ds_read_b128 a[140:143], v225 offset:22528
    v_fma_f32 v214, v214, s21, v239
    v_mfma_f32_16x16x32_bf16 v[200:203], a[148:151], a[84:87], v[200:203]
    v_exp_f32 v214, v214
    v_mfma_f32_16x16x32_bf16 v[204:207], a[148:151], a[116:119], v[204:207]
    v_cvt_pk_bf16_f32 v14, v212, v213
    v_fma_f32 v215, v215, s21, v239
    v_mfma_f32_16x16x32_bf16 v[204:207], a[144:147], a[112:115], v[204:207]
    v_exp_f32 v215, v215
    v_mfma_f32_16x16x32_bf16 v[204:207], a[152:155], a[120:123], v[204:207]
    ds_read_b128 a[144:147], v224 offset:26624
    v_fma_f32 v220, v220, s21, v241
    v_mfma_f32_16x16x32_bf16 v[204:207], a[156:159], a[124:127], v[204:207]
    buffer_load_dwordx4 v234, s[8:11], s34 offen offset:2048 nt lds
    v_exp_f32 v220, v220
    v_mfma_f32_16x16x32_bf16 v[200:203], a[156:159], a[92:95], v[200:203]
    v_cvt_pk_bf16_f32 v15, v214, v215
    v_fma_f32 v221, v221, s21, v241
    v_mfma_f32_16x16x32_bf16 v[200:203], a[152:155], a[88:91], v[200:203]
    v_exp_f32 v221, v221
    v_mfma_f32_16x16x32_bf16 v[196:199], a[152:155], a[56:59], v[196:199]
    ds_read_b128 a[148:151], v225 offset:26624
    v_fma_f32 v222, v222, s21, v241
    v_mfma_f32_16x16x32_bf16 v[196:199], a[156:159], a[60:63], v[196:199]
    v_exp_f32 v222, v222
    v_mfma_f32_16x16x32_bf16 v[192:195], a[156:159], a[28:31], v[192:195]
    v_cvt_pk_bf16_f32 v30, v220, v221
    v_fma_f32 v223, v223, s21, v241
    v_mfma_f32_16x16x32_bf16 v[192:195], a[152:155], a[24:27], v[192:195]
    s_waitcnt lgkmcnt(2)
    v_exp_f32 v223, v223
    v_mfma_f32_16x16x32_bf16 v[208:211], a[128:131], a[0:3], 0
    ds_read_b128 a[152:155], v224 offset:30720
    v_fma_f32 v200, v200, s21, v240
    v_mfma_f32_16x16x32_bf16 v[208:211], a[132:135], a[4:7], v[208:211]
    v_exp_f32 v200, v200
    v_mfma_f32_16x16x32_bf16 v[212:215], a[132:135], a[36:39], 0
    v_cvt_pk_bf16_f32 v31, v222, v223
    v_fma_f32 v201, v201, s21, v240
    v_mfma_f32_16x16x32_bf16 v[212:215], a[128:131], a[32:35], v[212:215]
    v_exp_f32 v201, v201
    v_mfma_f32_16x16x32_bf16 v[216:219], a[128:131], a[64:67], 0
    ds_read_b128 a[156:159], v225 offset:30720
    v_fma_f32 v202, v202, s21, v240
    v_mfma_f32_16x16x32_bf16 v[216:219], a[132:135], a[68:71], v[216:219]
    v_exp_f32 v202, v202
    v_mfma_f32_16x16x32_bf16 v[220:223], a[132:135], a[100:103], 0
    v_cvt_pk_bf16_f32 v48, v200, v201
    v_fma_f32 v203, v203, s21, v240
    v_mfma_f32_16x16x32_bf16 v[220:223], a[128:131], a[96:99], v[220:223]
    v_exp_f32 v203, v203
    v_mfma_f32_16x16x32_bf16 v[220:223], a[136:139], a[104:107], v[220:223]
    buffer_load_dwordx4 v235, s[8:11], s34 offen offset:3072 nt lds
    v_fma_f32 v192, v192, s21, v238
    v_mfma_f32_16x16x32_bf16 v[220:223], a[140:143], a[108:111], v[220:223]
    v_exp_f32 v192, v192
    v_mfma_f32_16x16x32_bf16 v[216:219], a[140:143], a[76:79], v[216:219]
    v_cvt_pk_bf16_f32 v49, v202, v203
    v_fma_f32 v193, v193, s21, v238
    v_mfma_f32_16x16x32_bf16 v[216:219], a[136:139], a[72:75], v[216:219]
    v_exp_f32 v193, v193
    v_mfma_f32_16x16x32_bf16 v[212:215], a[136:139], a[40:43], v[212:215]
    v_fma_f32 v194, v194, s21, v238
    v_mfma_f32_16x16x32_bf16 v[212:215], a[140:143], a[44:47], v[212:215]
    v_exp_f32 v194, v194
    v_mfma_f32_16x16x32_bf16 v[208:211], a[140:143], a[12:15], v[208:211]
    v_cvt_pk_bf16_f32 v32, v192, v193
    v_fma_f32 v195, v195, s21, v238
    v_mfma_f32_16x16x32_bf16 v[208:211], a[136:139], a[8:11], v[208:211]
    s_waitcnt vmcnt(8) lgkmcnt(0)
    v_exp_f32 v195, v195
    v_smfmac_f32_16x16x64_bf16 a[192:195], a[208:211], v[0:7], v254
    s_barrier
    v_mfma_f32_16x16x32_bf16 v[208:211], a[144:147], a[16:19], v[208:211]
    s_add_u32 m0, s23, 0x10000
    ds_read_b128 a[128:131], v224 offset:32768
    v_fma_f32 v196, v196, s21, v239
    v_mfma_f32_16x16x32_bf16 v[208:211], a[148:151], a[20:23], v[208:211]
    ds_read_b128 a[132:135], v225 offset:32768
    v_exp_f32 v196, v196
    v_mfma_f32_16x16x32_bf16 v[212:215], a[148:151], a[52:55], v[212:215]
    s_add_u32 s34, s28, 0x18000
    v_cvt_pk_bf16_f32 v33, v194, v195
    v_fma_f32 v197, v197, s21, v239
    v_mfma_f32_16x16x32_bf16 v[212:215], a[144:147], a[48:51], v[212:215]
    v_exp_f32 v197, v197
    v_mfma_f32_16x16x32_bf16 v[216:219], a[144:147], a[80:83], v[216:219]
    ds_read_b128 a[136:139], v224 offset:36864
    v_fma_f32 v198, v198, s21, v239
    v_mfma_f32_16x16x32_bf16 v[216:219], a[148:151], a[84:87], v[216:219]
    ds_read_b128 a[140:143], v225 offset:36864
    v_exp_f32 v198, v198
    v_mfma_f32_16x16x32_bf16 v[220:223], a[148:151], a[116:119], v[220:223]
    v_cvt_pk_bf16_f32 v40, v196, v197
    v_fma_f32 v199, v199, s21, v239
    v_mfma_f32_16x16x32_bf16 v[220:223], a[144:147], a[112:115], v[220:223]
    v_exp_f32 v199, v199
    v_mfma_f32_16x16x32_bf16 v[220:223], a[152:155], a[120:123], v[220:223]
    ds_read_b128 a[144:147], v224 offset:40960
    v_fma_f32 v204, v204, s21, v241
    v_mfma_f32_16x16x32_bf16 v[220:223], a[156:159], a[124:127], v[220:223]
    v_exp_f32 v204, v204
    v_mfma_f32_16x16x32_bf16 v[216:219], a[156:159], a[92:95], v[216:219]
    v_cvt_pk_bf16_f32 v41, v198, v199
    v_fma_f32 v205, v205, s21, v241
    v_mfma_f32_16x16x32_bf16 v[216:219], a[152:155], a[88:91], v[216:219]
    buffer_load_dwordx4 v232, s[8:11], s34 offen nt lds
    v_exp_f32 v205, v205
    v_mfma_f32_16x16x32_bf16 v[212:215], a[152:155], a[56:59], v[212:215]
    ds_read_b128 a[148:151], v225 offset:40960
    v_fma_f32 v206, v206, s21, v241
    v_mfma_f32_16x16x32_bf16 v[212:215], a[156:159], a[60:63], v[212:215]
    v_exp_f32 v206, v206
    v_mfma_f32_16x16x32_bf16 v[208:211], a[156:159], a[28:31], v[208:211]
    v_cvt_pk_bf16_f32 v56, v204, v205
    v_fma_f32 v207, v207, s21, v241
    v_mfma_f32_16x16x32_bf16 v[208:211], a[152:155], a[24:27], v[208:211]
    s_waitcnt lgkmcnt(2)
    v_exp_f32 v207, v207
    v_mfma_f32_16x16x32_bf16 v[192:195], a[128:131], a[0:3], 0
    ds_read_b128 a[152:155], v224 offset:45056
    v_fma_f32 v216, v216, s21, v240
    v_mfma_f32_16x16x32_bf16 v[192:195], a[132:135], a[4:7], v[192:195]
    v_exp_f32 v216, v216
    v_mfma_f32_16x16x32_bf16 v[196:199], a[132:135], a[36:39], 0
    v_cvt_pk_bf16_f32 v57, v206, v207
    v_fma_f32 v217, v217, s21, v240
    v_mfma_f32_16x16x32_bf16 v[196:199], a[128:131], a[32:35], v[196:199]
    v_exp_f32 v217, v217
    v_mfma_f32_16x16x32_bf16 v[200:203], a[128:131], a[64:67], 0
    ds_read_b128 a[156:159], v225 offset:45056
    v_fma_f32 v218, v218, s21, v240
    v_mfma_f32_16x16x32_bf16 v[200:203], a[132:135], a[68:71], v[200:203]
    v_exp_f32 v218, v218
    v_mfma_f32_16x16x32_bf16 v[204:207], a[132:135], a[100:103], 0
    v_cvt_pk_bf16_f32 v50, v216, v217
    v_fma_f32 v219, v219, s21, v240
    v_mfma_f32_16x16x32_bf16 v[204:207], a[128:131], a[96:99], v[204:207]
    v_exp_f32 v219, v219
    v_mfma_f32_16x16x32_bf16 v[204:207], a[136:139], a[104:107], v[204:207]
    ds_read_b128 a[128:131], v224 offset:34816
    v_fma_f32 v208, v208, s21, v238
    v_mfma_f32_16x16x32_bf16 v[204:207], a[140:143], a[108:111], v[204:207]
    v_exp_f32 v208, v208
    v_mfma_f32_16x16x32_bf16 v[200:203], a[140:143], a[76:79], v[200:203]
    v_cvt_pk_bf16_f32 v51, v218, v219
    v_fma_f32 v209, v209, s21, v238
    v_mfma_f32_16x16x32_bf16 v[200:203], a[136:139], a[72:75], v[200:203]
    v_exp_f32 v209, v209
    v_mfma_f32_16x16x32_bf16 v[196:199], a[136:139], a[40:43], v[196:199]
    ds_read_b128 a[132:135], v225 offset:34816
    v_fma_f32 v210, v210, s21, v238
    v_mfma_f32_16x16x32_bf16 v[196:199], a[140:143], a[44:47], v[196:199]
    v_exp_f32 v210, v210
    v_mfma_f32_16x16x32_bf16 v[192:195], a[140:143], a[12:15], v[192:195]
    v_cvt_pk_bf16_f32 v34, v208, v209
    v_fma_f32 v211, v211, s21, v238
    v_mfma_f32_16x16x32_bf16 v[192:195], a[136:139], a[8:11], v[192:195]
    s_waitcnt lgkmcnt(2)
    v_exp_f32 v211, v211
    v_smfmac_f32_16x16x64_bf16 a[196:199], a[208:211], v[8:15], v254
    buffer_load_dwordx4 v233, s[8:11], s34 offen offset:1024 nt lds
    v_mfma_f32_16x16x32_bf16 v[192:195], a[144:147], a[16:19], v[192:195]
    ds_read_b128 a[136:139], v224 offset:38912
    v_fma_f32 v212, v212, s21, v239
    v_mfma_f32_16x16x32_bf16 v[192:195], a[148:151], a[20:23], v[192:195]
    v_exp_f32 v212, v212
    v_mfma_f32_16x16x32_bf16 v[196:199], a[148:151], a[52:55], v[196:199]
    v_cvt_pk_bf16_f32 v35, v210, v211
    v_fma_f32 v213, v213, s21, v239
    v_mfma_f32_16x16x32_bf16 v[196:199], a[144:147], a[48:51], v[196:199]
    v_exp_f32 v213, v213
    v_mfma_f32_16x16x32_bf16 v[200:203], a[144:147], a[80:83], v[200:203]
    ds_read_b128 a[140:143], v225 offset:38912
    v_fma_f32 v214, v214, s21, v239
    v_mfma_f32_16x16x32_bf16 v[200:203], a[148:151], a[84:87], v[200:203]
    v_exp_f32 v214, v214
    v_mfma_f32_16x16x32_bf16 v[204:207], a[148:151], a[116:119], v[204:207]
    v_cvt_pk_bf16_f32 v42, v212, v213
    v_fma_f32 v215, v215, s21, v239
    v_mfma_f32_16x16x32_bf16 v[204:207], a[144:147], a[112:115], v[204:207]
    v_exp_f32 v215, v215
    v_mfma_f32_16x16x32_bf16 v[204:207], a[152:155], a[120:123], v[204:207]
L_hop1:
    s_cbranch_execz L_hopret0
    ds_read_b128 a[144:147], v224 offset:43008
    v_fma_f32 v220, v220, s21, v241
    v_mfma_f32_16x16x32_bf16 v[204:207], a[156:159], a[124:127], v[204:207]
    buffer_load_dwordx4 v234, s[8:11], s34 offen offset:2048 nt lds
    v_exp_f32 v220, v220
    v_mfma_f32_16x16x32_bf16 v[200:203], a[156:159], a[92:95], v[200:203]
    v_cvt_pk_bf16_f32 v43, v214, v215
    v_fma_f32 v221, v221, s21, v241
    v_mfma_f32_16x16x32_bf16 v[200:203], a[152:155], a[88:91], v[200:203]
    v_exp_f32 v221, v221
    v_mfma_f32_16x16x32_bf16 v[196:199], a[152:155], a[56:59], v[196:199]
    ds_read_b128 a[148:151], v225 offset:43008
    v_fma_f32 v222, v222, s21, v241
    v_mfma_f32_16x16x32_bf16 v[196:199], a[156:159], a[60:63], v[196:199]
    v_exp_f32 v222, v222
    v_mfma_f32_16x16x32_bf16 v[192:195], a[156:159], a[28:31], v[192:195]
    v_cvt_pk_bf16_f32 v58, v220, v221
    v_fma_f32 v223, v223, s21, v241
    v_mfma_f32_16x16x32_bf16 v[192:195], a[152:155], a[24:27], v[192:195]
    s_waitcnt lgkmcnt(2)
    v_exp_f32 v223, v223
    v_mfma_f32_16x16x32_bf16 v[208:211], a[128:131], a[0:3], 0
    ds_read_b128 a[152:155], v224 offset:47104
    v_fma_f32 v200, v200, s21, v240
    v_mfma_f32_16x16x32_bf16 v[208:211], a[132:135], a[4:7], v[208:211]
    v_exp_f32 v200, v200
    v_mfma_f32_16x16x32_bf16 v[212:215], a[132:135], a[36:39], 0
    v_cvt_pk_bf16_f32 v59, v222, v223
    v_fma_f32 v201, v201, s21, v240
    v_mfma_f32_16x16x32_bf16 v[212:215], a[128:131], a[32:35], v[212:215]
    v_exp_f32 v201, v201
    v_mfma_f32_16x16x32_bf16 v[216:219], a[128:131], a[64:67], 0
    ds_read_b128 a[156:159], v225 offset:47104
    v_fma_f32 v202, v202, s21, v240
    v_mfma_f32_16x16x32_bf16 v[216:219], a[132:135], a[68:71], v[216:219]
    v_exp_f32 v202, v202
    v_mfma_f32_16x16x32_bf16 v[220:223], a[132:135], a[100:103], 0
    v_cvt_pk_bf16_f32 v52, v200, v201
    v_fma_f32 v203, v203, s21, v240
    v_mfma_f32_16x16x32_bf16 v[220:223], a[128:131], a[96:99], v[220:223]
    v_exp_f32 v203, v203
    v_mfma_f32_16x16x32_bf16 v[220:223], a[136:139], a[104:107], v[220:223]
    buffer_load_dwordx4 v235, s[8:11], s34 offen offset:3072 nt lds
    v_fma_f32 v192, v192, s21, v238
    v_mfma_f32_16x16x32_bf16 v[220:223], a[140:143], a[108:111], v[220:223]
    v_exp_f32 v192, v192
    v_mfma_f32_16x16x32_bf16 v[216:219], a[140:143], a[76:79], v[216:219]
    v_cvt_pk_bf16_f32 v53, v202, v203
    v_fma_f32 v193, v193, s21, v238
    v_mfma_f32_16x16x32_bf16 v[216:219], a[136:139], a[72:75], v[216:219]
    v_exp_f32 v193, v193
    v_mfma_f32_16x16x32_bf16 v[212:215], a[136:139], a[40:43], v[212:215]
    v_fma_f32 v194, v194, s21, v238
    v_mfma_f32_16x16x32_bf16 v[212:215], a[140:143], a[44:47], v[212:215]
    v_exp_f32 v194, v194
    v_mfma_f32_16x16x32_bf16 v[208:211], a[140:143], a[12:15], v[208:211]
    v_cvt_pk_bf16_f32 v36, v192, v193
    v_fma_f32 v195, v195, s21, v238
    v_mfma_f32_16x16x32_bf16 v[208:211], a[136:139], a[8:11], v[208:211]
    s_waitcnt vmcnt(8) lgkmcnt(0)
    v_exp_f32 v195, v195
    v_smfmac_f32_16x16x64_bf16 a[204:207], a[208:211], v[24:31], v254
    s_barrier
L_mid:
    v_mfma_f32_16x16x32_bf16 v[208:211], a[144:147], a[16:19], v[208:211]
    s_add_u32 m0, s23, 0
    ds_read_b128 a[128:131], v226 offset:49152
    v_fma_f32 v196, v196, s21, v239
    v_mfma_f32_16x16x32_bf16 v[208:211], a[148:151], a[20:23], v[208:211]
    s_add_u32 s34, s28, 0x1c000
    ds_read_b128 a[132:135], v227 offset:49152
    v_exp_f32 v196, v196
    v_mfma_f32_16x16x32_bf16 v[212:215], a[148:151], a[52:55], v[212:215]
    v_cvt_pk_bf16_f32 v37, v194, v195
    v_fma_f32 v197, v197, s21, v239
    v_mfma_f32_16x16x32_bf16 v[212:215], a[144:147], a[48:51], v[212:215]
    v_exp_f32 v197, v197
    v_mfma_f32_16x16x32_bf16 v[216:219], a[144:147], a[80:83], v[216:219]
    ds_read_b128 a[136:139], v226 offset:53248
    v_fma_f32 v198, v198, s21, v239
    v_mfma_f32_16x16x32_bf16 v[216:219], a[148:151], a[84:87], v[216:219]
    ds_read_b128 a[140:143], v227 offset:53248
    buffer_load_dwordx4 v232, s[8:11], s34 offen nt lds
    v_exp_f32 v198, v198
    v_mfma_f32_16x16x32_bf16 v[220:223], a[148:151], a[116:119], v[220:223]
    v_cvt_pk_bf16_f32 v44, v196, v197
    v_fma_f32 v199, v199, s21, v239
    v_mfma_f32_16x16x32_bf16 v[220:223], a[144:147], a[112:115], v[220:223]
    v_exp_f32 v199, v199
    v_mfma_f32_16x16x32_bf16 v[220:223], a[152:155], a[120:123], v[220:223]
    ds_read_b128 a[144:147], v226 offset:57344
    v_fma_f32 v204, v204, s21, v241
    v_mfma_f32_16x16x32_bf16 v[220:223], a[156:159], a[124:127], v[220:223]
    v_exp_f32 v204, v204
    v_mfma_f32_16x16x32_bf16 v[216:219], a[156:159], a[92:95], v[216:219]
    v_cvt_pk_bf16_f32 v45, v198, v199
    v_fma_f32 v205, v205, s21, v241
    v_mfma_f32_16x16x32_bf16 v[216:219], a[152:155], a[88:91], v[216:219]
    v_exp_f32 v205, v205
    v_mfma_f32_16x16x32_bf16 v[212:215], a[152:155], a[56:59], v[212:215]
    ds_read_b128 a[148:151], v227 offset:57344
    v_fma_f32 v206, v206, s21, v241
    v_mfma_f32_16x16x32_bf16 v[212:215], a[156:159], a[60:63], v[212:215]
    v_exp_f32 v206, v206
    v_mfma_f32_16x16x32_bf16 v[208:211], a[156:159], a[28:31], v[208:211]
    v_cvt_pk_bf16_f32 v60, v204, v205
    v_fma_f32 v207, v207, s21, v241
    v_mfma_f32_16x16x32_bf16 v[208:211], a[152:155], a[24:27], v[208:211]
    s_waitcnt lgkmcnt(2)
    buffer_load_dwordx4 v233, s[8:11], s34 offen offset:1024 nt lds
    v_exp_f32 v207, v207
    v_mfma_f32_16x16x32_bf16 v[192:195], a[128:131], a[0:3], 0
    ds_read_b128 a[152:155], v226 offset:61440
    v_fma_f32 v216, v216, s21, v240
    v_mfma_f32_16x16x32_bf16 v[192:195], a[132:135], a[4:7], v[192:195]
    v_exp_f32 v216, v216
    v_mfma_f32_16x16x32_bf16 v[196:199], a[132:135], a[36:39], 0
    v_cvt_pk_bf16_f32 v61, v206, v207
    v_fma_f32 v217, v217, s21, v240
    v_mfma_f32_16x16x32_bf16 v[196:199], a[128:131], a[32:35], v[196:199]
    v_exp_f32 v217, v217
    v_mfma_f32_16x16x32_bf16 v[200:203], a[128:131], a[64:67], 0
    ds_read_b128 a[156:159], v227 offset:61440
    v_fma_f32 v218, v218, s21, v240
    v_mfma_f32_16x16x32_bf16 v[200:203], a[132:135], a[68:71], v[200:203]
    v_exp_f32 v218, v218
    v_mfma_f32_16x16x32_bf16 v[204:207], a[132:135], a[100:103], 0
    v_cvt_pk_bf16_f32 v54, v216, v217
    v_fma_f32 v219, v219, s21, v240
    v_mfma_f32_16x16x32_bf16 v[204:207], a[128:131], a[96:99], v[204:207]
    v_exp_f32 v219, v219
    v_mfma_f32_16x16x32_bf16 v[204:207], a[136:139], a[104:107], v[204:207]
    ds_read_b128 a[128:131], v226 offset:51200
    v_fma_f32 v208, v208, s21, v238
    v_mfma_f32_16x16x32_bf16 v[204:207], a[140:143], a[108:111], v[204:207]
    buffer_load_dwordx4 v234, s[8:11], s34 offen offset:2048 nt lds
    v_exp_f32 v208, v208
    v_mfma_f32_16x16x32_bf16 v[200:203], a[140:143], a[76:79], v[200:203]
    v_cvt_pk_bf16_f32 v55, v218, v219
    v_fma_f32 v209, v209, s21, v238
    v_mfma_f32_16x16x32_bf16 v[200:203], a[136:139], a[72:75], v[200:203]
    v_exp_f32 v209, v209
    v_mfma_f32_16x16x32_bf16 v[196:199], a[136:139], a[40:43], v[196:199]
    ds_read_b128 a[132:135], v227 offset:51200
    v_fma_f32 v210, v210, s21, v238
    v_mfma_f32_16x16x32_bf16 v[196:199], a[140:143], a[44:47], v[196:199]
    v_exp_f32 v210, v210
    v_mfma_f32_16x16x32_bf16 v[192:195], a[140:143], a[12:15], v[192:195]
    v_cvt_pk_bf16_f32 v38, v208, v209
    v_fma_f32 v211, v211, s21, v238
    v_mfma_f32_16x16x32_bf16 v[192:195], a[136:139], a[8:11], v[192:195]
    s_waitcnt lgkmcnt(2)
    v_exp_f32 v211, v211
    v_smfmac_f32_16x16x64_bf16 a[200:203], a[208:211], v[48:55], v254
    buffer_load_dwordx4 v235, s[8:11], s34 offen offset:3072 nt lds
    v_mfma_f32_16x16x32_bf16 v[192:195], a[144:147], a[16:19], v[192:195]
    ds_read_b128 a[136:139], v226 offset:55296
    v_fma_f32 v212, v212, s21, v239
    v_mfma_f32_16x16x32_bf16 v[192:195], a[148:151], a[20:23], v[192:195]
    v_exp_f32 v212, v212
    v_mfma_f32_16x16x32_bf16 v[196:199], a[148:151], a[52:55], v[196:199]
    v_cvt_pk_bf16_f32 v39, v210, v211
    v_fma_f32 v213, v213, s21, v239
    v_mfma_f32_16x16x32_bf16 v[196:199], a[144:147], a[48:51], v[196:199]
    v_exp_f32 v213, v213
    v_mfma_f32_16x16x32_bf16 v[200:203], a[144:147], a[80:83], v[200:203]
    s_add_u32 m0, s23, 0x18000
    ds_read_b128 a[140:143], v227 offset:55296
    v_fma_f32 v214, v214, s21, v239
    v_mfma_f32_16x16x32_bf16 v[200:203], a[148:151], a[84:87], v[200:203]
    s_xor_b32 s34, s30, 0
    v_exp_f32 v214, v214
    v_mfma_f32_16x16x32_bf16 v[204:207], a[148:151], a[116:119], v[204:207]
    v_cvt_pk_bf16_f32 v46, v212, v213
    v_fma_f32 v215, v215, s21, v239
    v_mfma_f32_16x16x32_bf16 v[204:207], a[144:147], a[112:115], v[204:207]
    v_exp_f32 v215, v215
    v_mfma_f32_16x16x32_bf16 v[204:207], a[152:155], a[120:123], v[204:207]
    ds_read_b128 a[144:147], v226 offset:59392
    v_fma_f32 v220, v220, s21, v241
    v_mfma_f32_16x16x32_bf16 v[204:207], a[156:159], a[124:127], v[204:207]
    buffer_load_dwordx4 v232, s[4:7], s34 offen nt lds
    v_exp_f32 v220, v220
    v_mfma_f32_16x16x32_bf16 v[200:203], a[156:159], a[92:95], v[200:203]
    v_cvt_pk_bf16_f32 v47, v214, v215
    v_fma_f32 v221, v221, s21, v241
    v_mfma_f32_16x16x32_bf16 v[200:203], a[152:155], a[88:91], v[200:203]
    v_exp_f32 v221, v221
    v_mfma_f32_16x16x32_bf16 v[196:199], a[152:155], a[56:59], v[196:199]
    ds_read_b128 a[148:151], v227 offset:59392
    v_fma_f32 v222, v222, s21, v241
    v_mfma_f32_16x16x32_bf16 v[196:199], a[156:159], a[60:63], v[196:199]
    v_exp_f32 v222, v222
    v_mfma_f32_16x16x32_bf16 v[192:195], a[156:159], a[28:31], v[192:195]
    v_cvt_pk_bf16_f32 v62, v220, v221
    v_fma_f32 v223, v223, s21, v241
    v_mfma_f32_16x16x32_bf16 v[192:195], a[152:155], a[24:27], v[192:195]
    s_waitcnt lgkmcnt(2)
    buffer_load_dwordx4 v233, s[4:7], s34 offen offset:1024 nt lds
    v_exp_f32 v223, v223
    v_mfma_f32_16x16x32_bf16 v[208:211], a[128:131], a[0:3], 0
    ds_read_b128 a[152:155], v226 offset:63488
    v_fma_f32 v200, v200, s21, v240
    v_mfma_f32_16x16x32_bf16 v[208:211], a[132:135], a[4:7], v[208:211]
    v_exp_f32 v200, v200
    v_mfma_f32_16x16x32_bf16 v[212:215], a[132:135], a[36:39], 0
    v_cvt_pk_bf16_f32 v63, v222, v223
    v_fma_f32 v201, v201, s21, v240
    v_mfma_f32_16x16x32_bf16 v[212:215], a[128:131], a[32:35], v[212:215]
    v_exp_f32 v201, v201
    v_mfma_f32_16x16x32_bf16 v[216:219], a[128:131], a[64:67], 0
    s_add_u32 m0, s23, 0x4000
    ds_read_b128 a[156:159], v227 offset:63488
    v_fma_f32 v202, v202, s21, v240
    v_mfma_f32_16x16x32_bf16 v[216:219], a[132:135], a[68:71], v[216:219]
    s_add_u32 s34, s28, 0x20000
    v_exp_f32 v202, v202
    v_mfma_f32_16x16x32_bf16 v[220:223], a[132:135], a[100:103], 0
    v_cvt_pk_bf16_f32 v80, v200, v201
    v_fma_f32 v203, v203, s21, v240
    v_mfma_f32_16x16x32_bf16 v[220:223], a[128:131], a[96:99], v[220:223]
    v_exp_f32 v203, v203
    v_mfma_f32_16x16x32_bf16 v[220:223], a[136:139], a[104:107], v[220:223]
    buffer_load_dwordx4 v232, s[8:11], s34 offen nt lds
    v_fma_f32 v192, v192, s21, v238
    v_mfma_f32_16x16x32_bf16 v[220:223], a[140:143], a[108:111], v[220:223]
    v_exp_f32 v192, v192
    v_mfma_f32_16x16x32_bf16 v[216:219], a[140:143], a[76:79], v[216:219]
    v_cvt_pk_bf16_f32 v81, v202, v203
    v_fma_f32 v193, v193, s21, v238
    v_mfma_f32_16x16x32_bf16 v[216:219], a[136:139], a[72:75], v[216:219]
    v_exp_f32 v193, v193
    v_mfma_f32_16x16x32_bf16 v[212:215], a[136:139], a[40:43], v[212:215]
    buffer_load_dwordx4 v233, s[8:11], s34 offen offset:1024 nt lds
    v_fma_f32 v194, v194, s21, v238
    v_mfma_f32_16x16x32_bf16 v[212:215], a[140:143], a[44:47], v[212:215]
    v_exp_f32 v194, v194
    v_mfma_f32_16x16x32_bf16 v[208:211], a[140:143], a[12:15], v[208:211]
    v_cvt_pk_bf16_f32 v64, v192, v193
    v_fma_f32 v195, v195, s21, v238
    v_mfma_f32_16x16x32_bf16 v[208:211], a[136:139], a[8:11], v[208:211]
    s_waitcnt vmcnt(12) lgkmcnt(0)
    v_exp_f32 v195, v195
    v_smfmac_f32_16x16x64_bf16 a[192:195], a[208:211], v[32:39], v254
    s_barrier
    v_mfma_f32_16x16x32_bf16 v[208:211], a[144:147], a[16:19], v[208:211]
    ds_read_b128 a[128:131], v224 offset:49152
    v_fma_f32 v196, v196, s21, v239
    v_mfma_f32_16x16x32_bf16 v[208:211], a[148:151], a[20:23], v[208:211]
    ds_read_b128 a[132:135], v225 offset:49152
    v_exp_f32 v196, v196
    v_mfma_f32_16x16x32_bf16 v[212:215], a[148:151], a[52:55], v[212:215]
    v_cvt_pk_bf16_f32 v65, v194, v195
    v_fma_f32 v197, v197, s21, v239
    v_mfma_f32_16x16x32_bf16 v[212:215], a[144:147], a[48:51], v[212:215]
    v_exp_f32 v197, v197
    v_mfma_f32_16x16x32_bf16 v[216:219], a[144:147], a[80:83], v[216:219]
    ds_read_b128 a[136:139], v224 offset:53248
    v_fma_f32 v198, v198, s21, v239
    v_mfma_f32_16x16x32_bf16 v[216:219], a[148:151], a[84:87], v[216:219]
    ds_read_b128 a[140:143], v225 offset:53248
    v_exp_f32 v198, v198
    v_mfma_f32_16x16x32_bf16 v[220:223], a[148:151], a[116:119], v[220:223]
    v_cvt_pk_bf16_f32 v72, v196, v197
    v_fma_f32 v199, v199, s21, v239
    v_mfma_f32_16x16x32_bf16 v[220:223], a[144:147], a[112:115], v[220:223]
    v_exp_f32 v199, v199
    v_mfma_f32_16x16x32_bf16 v[220:223], a[152:155], a[120:123], v[220:223]
    ds_read_b128 a[144:147], v224 offset:57344
    v_fma_f32 v204, v204, s21, v241
    v_mfma_f32_16x16x32_bf16 v[220:223], a[156:159], a[124:127], v[220:223]
    v_exp_f32 v204, v204
    v_mfma_f32_16x16x32_bf16 v[216:219], a[156:159], a[92:95], v[216:219]
    v_cvt_pk_bf16_f32 v73, v198, v199
    v_fma_f32 v205, v205, s21, v241
    v_mfma_f32_16x16x32_bf16 v[216:219], a[152:155], a[88:91], v[216:219]
    buffer_load_dwordx4 v234, s[8:11], s34 offen offset:2048 nt lds
    v_exp_f32 v205, v205
    v_mfma_f32_16x16x32_bf16 v[212:215], a[152:155], a[56:59], v[212:215]
    ds_read_b128 a[148:151], v225 offset:57344
    v_fma_f32 v206, v206, s21, v241
    v_mfma_f32_16x16x32_bf16 v[212:215], a[156:159], a[60:63], v[212:215]
    v_exp_f32 v206, v206
    v_mfma_f32_16x16x32_bf16 v[208:211], a[156:159], a[28:31], v[208:211]
    v_cvt_pk_bf16_f32 v88, v204, v205
    v_fma_f32 v207, v207, s21, v241
    v_mfma_f32_16x16x32_bf16 v[208:211], a[152:155], a[24:27], v[208:211]
    s_waitcnt lgkmcnt(2)
    v_exp_f32 v207, v207
    v_mfma_f32_16x16x32_bf16 v[192:195], a[128:131], a[0:3], 0
    ds_read_b128 a[152:155], v224 offset:61440
    v_fma_f32 v216, v216, s21, v240
    v_mfma_f32_16x16x32_bf16 v[192:195], a[132:135], a[4:7], v[192:195]
    v_exp_f32 v216, v216
    v_mfma_f32_16x16x32_bf16 v[196:199], a[132:135], a[36:39], 0
    v_cvt_pk_bf16_f32 v89, v206, v207
    v_fma_f32 v217, v217, s21, v240
    v_mfma_f32_16x16x32_bf16 v[196:199], a[128:131], a[32:35], v[196:199]
    buffer_load_dwordx4 v235, s[8:11], s34 offen offset:3072 nt lds
    v_exp_f32 v217, v217
    v_mfma_f32_16x16x32_bf16 v[200:203], a[128:131], a[64:67], 0
    ds_read_b128 a[156:159], v225 offset:61440
    v_fma_f32 v218, v218, s21, v240
    v_mfma_f32_16x16x32_bf16 v[200:203], a[132:135], a[68:71], v[200:203]
    v_exp_f32 v218, v218
    v_mfma_f32_16x16x32_bf16 v[204:207], a[132:135], a[100:103], 0
    v_cvt_pk_bf16_f32 v82, v216, v217
    v_fma_f32 v219, v219, s21, v240
    v_mfma_f32_16x16x32_bf16 v[204:207], a[128:131], a[96:99], v[204:207]
    v_exp_f32 v219, v219
    v_mfma_f32_16x16x32_bf16 v[204:207], a[136:139], a[104:107], v[204:207]
    s_add_u32 m0, s23, 0x14000
    ds_read_b128 a[128:131], v224 offset:51200
    v_fma_f32 v208, v208, s21, v238
    v_mfma_f32_16x16x32_bf16 v[204:207], a[140:143], a[108:111], v[204:207]
    s_add_u32 s34, s41, 0x20000
    v_exp_f32 v208, v208
    v_mfma_f32_16x16x32_bf16 v[200:203], a[140:143], a[76:79], v[200:203]
    v_cvt_pk_bf16_f32 v83, v218, v219
    v_fma_f32 v209, v209, s21, v238
    v_mfma_f32_16x16x32_bf16 v[200:203], a[136:139], a[72:75], v[200:203]
    v_exp_f32 v209, v209
    v_mfma_f32_16x16x32_bf16 v[196:199], a[136:139], a[40:43], v[196:199]
    ds_read_b128 a[132:135], v225 offset:51200
    v_fma_f32 v210, v210, s21, v238
    v_mfma_f32_16x16x32_bf16 v[196:199], a[140:143], a[44:47], v[196:199]
    v_exp_f32 v210, v210
    v_mfma_f32_16x16x32_bf16 v[192:195], a[140:143], a[12:15], v[192:195]
    v_cvt_pk_bf16_f32 v66, v208, v209
    v_fma_f32 v211, v211, s21, v238
    v_mfma_f32_16x16x32_bf16 v[192:195], a[136:139], a[8:11], v[192:195]
    s_waitcnt lgkmcnt(2)
    v_exp_f32 v211, v211
    v_smfmac_f32_16x16x64_bf16 a[196:199], a[208:211], v[40:47], v254
    buffer_load_dwordx4 v232, s[12:15], s34 offen nt lds
    v_mfma_f32_16x16x32_bf16 v[192:195], a[144:147], a[16:19], v[192:195]
    ds_read_b128 a[136:139], v224 offset:55296
    v_fma_f32 v212, v212, s21, v239
    v_mfma_f32_16x16x32_bf16 v[192:195], a[148:151], a[20:23], v[192:195]
    v_exp_f32 v212, v212
    v_mfma_f32_16x16x32_bf16 v[196:199], a[148:151], a[52:55], v[196:199]
    v_cvt_pk_bf16_f32 v67, v210, v211
    v_fma_f32 v213, v213, s21, v239
    v_mfma_f32_16x16x32_bf16 v[196:199], a[144:147], a[48:51], v[196:199]
    buffer_load_dwordx4 v233, s[12:15], s34 offen offset:1024 nt lds
    v_exp_f32 v213, v213
    v_mfma_f32_16x16x32_bf16 v[200:203], a[144:147], a[80:83], v[200:203]
    ds_read_b128 a[140:143], v225 offset:55296
    v_fma_f32 v214, v214, s21, v239
    v_mfma_f32_16x16x32_bf16 v[200:203], a[148:151], a[84:87], v[200:203]
    v_exp_f32 v214, v214
    v_mfma_f32_16x16x32_bf16 v[204:207], a[148:151], a[116:119], v[204:207]
    v_cvt_pk_bf16_f32 v74, v212, v213
    v_fma_f32 v215, v215, s21, v239
    v_mfma_f32_16x16x32_bf16 v[204:207], a[144:147], a[112:115], v[204:207]
    v_exp_f32 v215, v215
    v_mfma_f32_16x16x32_bf16 v[204:207], a[152:155], a[120:123], v[204:207]
    s_add_u32 m0, s23, 0x8000
    ds_read_b128 a[144:147], v224 offset:59392
    v_fma_f32 v220, v220, s21, v241
    v_mfma_f32_16x16x32_bf16 v[204:207], a[156:159], a[124:127], v[204:207]
    s_add_u32 s34, s28, 0x24000
    v_exp_f32 v220, v220
    v_mfma_f32_16x16x32_bf16 v[200:203], a[156:159], a[92:95], v[200:203]
    v_cvt_pk_bf16_f32 v75, v214, v215
    v_fma_f32 v221, v221, s21, v241
    v_mfma_f32_16x16x32_bf16 v[200:203], a[152:155], a[88:91], v[200:203]
    v_exp_f32 v221, v221
    v_mfma_f32_16x16x32_bf16 v[196:199], a[152:155], a[56:59], v[196:199]
    ds_read_b128 a[148:151], v225 offset:59392
    v_fma_f32 v222, v222, s21, v241
    v_mfma_f32_16x16x32_bf16 v[196:199], a[156:159], a[60:63], v[196:199]
    buffer_load_dwordx4 v232, s[8:11], s34 offen nt lds
    v_exp_f32 v222, v222
    v_mfma_f32_16x16x32_bf16 v[192:195], a[156:159], a[28:31], v[192:195]
    v_cvt_pk_bf16_f32 v90, v220, v221
    v_fma_f32 v223, v223, s21, v241
    v_mfma_f32_16x16x32_bf16 v[192:195], a[152:155], a[24:27], v[192:195]
    s_waitcnt lgkmcnt(2)
    v_exp_f32 v223, v223
    v_mfma_f32_16x16x32_bf16 v[208:211], a[128:131], a[0:3], 0
    ds_read_b128 a[152:155], v224 offset:63488
    v_fma_f32 v200, v200, s21, v240
    v_mfma_f32_16x16x32_bf16 v[208:211], a[132:135], a[4:7], v[208:211]
    v_exp_f32 v200, v200
    v_mfma_f32_16x16x32_bf16 v[212:215], a[132:135], a[36:39], 0
    v_cvt_pk_bf16_f32 v91, v222, v223
    v_fma_f32 v201, v201, s21, v240
    v_mfma_f32_16x16x32_bf16 v[212:215], a[128:131], a[32:35], v[212:215]
    v_exp_f32 v201, v201
    v_mfma_f32_16x16x32_bf16 v[216:219], a[128:131], a[64:67], 0
    ds_read_b128 a[156:159], v225 offset:63488
    v_fma_f32 v202, v202, s21, v240
    v_mfma_f32_16x16x32_bf16 v[216:219], a[132:135], a[68:71], v[216:219]
    v_exp_f32 v202, v202
    v_mfma_f32_16x16x32_bf16 v[220:223], a[132:135], a[100:103], 0
    v_cvt_pk_bf16_f32 v84, v200, v201
    v_fma_f32 v203, v203, s21, v240
    v_mfma_f32_16x16x32_bf16 v[220:223], a[128:131], a[96:99], v[220:223]
    v_exp_f32 v203, v203
    v_mfma_f32_16x16x32_bf16 v[220:223], a[136:139], a[104:107], v[220:223]
    buffer_load_dwordx4 v233, s[8:11], s34 offen offset:1024 nt lds
    v_fma_f32 v192, v192, s21, v238
    v_mfma_f32_16x16x32_bf16 v[220:223], a[140:143], a[108:111], v[220:223]
    v_exp_f32 v192, v192
    v_mfma_f32_16x16x32_bf16 v[216:219], a[140:143], a[76:79], v[216:219]
    v_cvt_pk_bf16_f32 v85, v202, v203
    v_fma_f32 v193, v193, s21, v238
    v_mfma_f32_16x16x32_bf16 v[216:219], a[136:139], a[72:75], v[216:219]
    v_exp_f32 v193, v193
    v_mfma_f32_16x16x32_bf16 v[212:215], a[136:139], a[40:43], v[212:215]
    buffer_load_dwordx4 v234, s[8:11], s34 offen offset:2048 nt lds
    v_fma_f32 v194, v194, s21, v238
    v_mfma_f32_16x16x32_bf16 v[212:215], a[140:143], a[44:47], v[212:215]
    v_exp_f32 v194, v194
    v_mfma_f32_16x16x32_bf16 v[208:211], a[140:143], a[12:15], v[208:211]
    v_cvt_pk_bf16_f32 v68, v192, v193
    v_fma_f32 v195, v195, s21, v238
    v_mfma_f32_16x16x32_bf16 v[208:211], a[136:139], a[8:11], v[208:211]
    s_waitcnt vmcnt(15) lgkmcnt(0)
    v_exp_f32 v195, v195
    v_smfmac_f32_16x16x64_bf16 a[204:207], a[208:211], v[56:63], v254
    s_barrier
    buffer_load_dwordx4 v235, s[8:11], s34 offen offset:3072 nt lds
    v_mfma_f32_16x16x32_bf16 v[208:211], a[144:147], a[16:19], v[208:211]
    ds_read_b128 a[128:131], v226 offset:0
    v_fma_f32 v196, v196, s21, v239
    v_mfma_f32_16x16x32_bf16 v[208:211], a[148:151], a[20:23], v[208:211]
    ds_read_b128 a[132:135], v227 offset:0
    v_exp_f32 v196, v196
    v_mfma_f32_16x16x32_bf16 v[212:215], a[148:151], a[52:55], v[212:215]
    v_cvt_pk_bf16_f32 v69, v194, v195
    v_fma_f32 v197, v197, s21, v239
    v_mfma_f32_16x16x32_bf16 v[212:215], a[144:147], a[48:51], v[212:215]
    v_exp_f32 v197, v197
    v_mfma_f32_16x16x32_bf16 v[216:219], a[144:147], a[80:83], v[216:219]
    ds_read_b128 a[136:139], v226 offset:4096
    v_fma_f32 v198, v198, s21, v239
    v_mfma_f32_16x16x32_bf16 v[216:219], a[148:151], a[84:87], v[216:219]
    ds_read_b128 a[140:143], v227 offset:4096
    v_exp_f32 v198, v198
    v_mfma_f32_16x16x32_bf16 v[220:223], a[148:151], a[116:119], v[220:223]
    v_cvt_pk_bf16_f32 v76, v196, v197
    v_fma_f32 v199, v199, s21, v239
    v_mfma_f32_16x16x32_bf16 v[220:223], a[144:147], a[112:115], v[220:223]
    v_exp_f32 v199, v199
    v_mfma_f32_16x16x32_bf16 v[220:223], a[152:155], a[120:123], v[220:223]
    s_add_u32 m0, s23, 0x18000
    ds_read_b128 a[144:147], v226 offset:8192
    v_fma_f32 v204, v204, s21, v241
    v_mfma_f32_16x16x32_bf16 v[220:223], a[156:159], a[124:127], v[220:223]
    s_xor_b32 s34, s30, 0
    v_exp_f32 v204, v204
    v_mfma_f32_16x16x32_bf16 v[216:219], a[156:159], a[92:95], v[216:219]
    v_cvt_pk_bf16_f32 v77, v198, v199
    v_fma_f32 v205, v205, s21, v241
    v_mfma_f32_16x16x32_bf16 v[216:219], a[152:155], a[88:91], v[216:219]
    v_exp_f32 v205, v205
    v_mfma_f32_16x16x32_bf16 v[212:215], a[152:155], a[56:59], v[212:215]
    ds_read_b128 a[148:151], v227 offset:8192
    v_fma_f32 v206, v206, s21, v241
    v_mfma_f32_16x16x32_bf16 v[212:215], a[156:159], a[60:63], v[212:215]
    v_exp_f32 v206, v206
    v_mfma_f32_16x16x32_bf16 v[208:211], a[156:159], a[28:31], v[208:211]
    v_cvt_pk_bf16_f32 v92, v204, v205
    v_fma_f32 v207, v207, s21, v241
    v_mfma_f32_16x16x32_bf16 v[208:211], a[152:155], a[24:27], v[208:211]
    s_waitcnt lgkmcnt(2)
    buffer_load_dwordx4 v234, s[4:7], s34 offen offset:2048 nt lds
    v_exp_f32 v207, v207
    v_mfma_f32_16x16x32_bf16 v[192:195], a[128:131], a[0:3], 0
    ds_read_b128 a[152:155], v226 offset:12288
    v_fma_f32 v216, v216, s21, v240
    v_mfma_f32_16x16x32_bf16 v[192:195], a[132:135], a[4:7], v[192:195]
    v_exp_f32 v216, v216
    v_mfma_f32_16x16x32_bf16 v[196:199], a[132:135], a[36:39], 0
    v_cvt_pk_bf16_f32 v93, v206, v207
    v_fma_f32 v217, v217, s21, v240
    v_mfma_f32_16x16x32_bf16 v[196:199], a[128:131], a[32:35], v[196:199]
    v_exp_f32 v217, v217
    v_mfma_f32_16x16x32_bf16 v[200:203], a[128:131], a[64:67], 0
    ds_read_b128 a[156:159], v227 offset:12288
    v_fma_f32 v218, v218, s21, v240
    v_mfma_f32_16x16x32_bf16 v[200:203], a[132:135], a[68:71], v[200:203]
    v_exp_f32 v218, v218
    v_mfma_f32_16x16x32_bf16 v[204:207], a[132:135], a[100:103], 0
    v_cvt_pk_bf16_f32 v86, v216, v217
    v_fma_f32 v219, v219, s21, v240
    v_mfma_f32_16x16x32_bf16 v[204:207], a[128:131], a[96:99], v[204:207]
    v_exp_f32 v219, v219
    v_mfma_f32_16x16x32_bf16 v[204:207], a[136:139], a[104:107], v[204:207]
    ds_read_b128 a[128:131], v226 offset:2048
    v_fma_f32 v208, v208, s21, v238
    v_mfma_f32_16x16x32_bf16 v[204:207], a[140:143], a[108:111], v[204:207]
    buffer_load_dwordx4 v235, s[4:7], s34 offen offset:3072 nt lds
    v_exp_f32 v208, v208
    v_mfma_f32_16x16x32_bf16 v[200:203], a[140:143], a[76:79], v[200:203]
    v_cvt_pk_bf16_f32 v87, v218, v219
    v_fma_f32 v209, v209, s21, v238
    v_mfma_f32_16x16x32_bf16 v[200:203], a[136:139], a[72:75], v[200:203]
    v_exp_f32 v209, v209
    v_mfma_f32_16x16x32_bf16 v[196:199], a[136:139], a[40:43], v[196:199]
    s_add_u32 m0, s23, 0xc000
    ds_read_b128 a[132:135], v227 offset:2048
    v_fma_f32 v210, v210, s21, v238
    v_mfma_f32_16x16x32_bf16 v[196:199], a[140:143], a[44:47], v[196:199]
    s_add_u32 s34, s28, 0x28000
    v_exp_f32 v210, v210
    v_mfma_f32_16x16x32_bf16 v[192:195], a[140:143], a[12:15], v[192:195]
    v_cvt_pk_bf16_f32 v70, v208, v209
    v_fma_f32 v211, v211, s21, v238
    v_mfma_f32_16x16x32_bf16 v[192:195], a[136:139], a[8:11], v[192:195]
    s_waitcnt lgkmcnt(2)
    v_exp_f32 v211, v211
    v_smfmac_f32_16x16x64_bf16 a[200:203], a[208:211], v[80:87], v254
    buffer_load_dwordx4 v232, s[8:11], s34 offen nt lds
    v_mfma_f32_16x16x32_bf16 v[192:195], a[144:147], a[16:19], v[192:195]
    ds_read_b128 a[136:139], v226 offset:6144
    v_fma_f32 v212, v212, s21, v239
    v_mfma_f32_16x16x32_bf16 v[192:195], a[148:151], a[20:23], v[192:195]
    v_exp_f32 v212, v212
    v_mfma_f32_16x16x32_bf16 v[196:199], a[148:151], a[52:55], v[196:199]
    v_cvt_pk_bf16_f32 v71, v210, v211
    v_fma_f32 v213, v213, s21, v239
    v_mfma_f32_16x16x32_bf16 v[196:199], a[144:147], a[48:51], v[196:199]
    v_exp_f32 v213, v213
    v_mfma_f32_16x16x32_bf16 v[200:203], a[144:147], a[80:83], v[200:203]
    ds_read_b128 a[140:143], v227 offset:6144
    v_fma_f32 v214, v214, s21, v239
    v_mfma_f32_16x16x32_bf16 v[200:203], a[148:151], a[84:87], v[200:203]
    v_exp_f32 v214, v214
    v_mfma_f32_16x16x32_bf16 v[204:207], a[148:151], a[116:119], v[204:207]
    v_cvt_pk_bf16_f32 v78, v212, v213
    v_fma_f32 v215, v215, s21, v239
    v_mfma_f32_16x16x32_bf16 v[204:207], a[144:147], a[112:115], v[204:207]
    v_exp_f32 v215, v215
    v_mfma_f32_16x16x32_bf16 v[204:207], a[152:155], a[120:123], v[204:207]
    ds_read_b128 a[144:147], v226 offset:10240
    v_fma_f32 v220, v220, s21, v241
    v_mfma_f32_16x16x32_bf16 v[204:207], a[156:159], a[124:127], v[204:207]
    buffer_load_dwordx4 v233, s[8:11], s34 offen offset:1024 nt lds
    v_exp_f32 v220, v220
    v_mfma_f32_16x16x32_bf16 v[200:203], a[156:159], a[92:95], v[200:203]
    v_cvt_pk_bf16_f32 v79, v214, v215
    v_fma_f32 v221, v221, s21, v241
    v_mfma_f32_16x16x32_bf16 v[200:203], a[152:155], a[88:91], v[200:203]
    v_exp_f32 v221, v221
    v_mfma_f32_16x16x32_bf16 v[196:199], a[152:155], a[56:59], v[196:199]
    ds_read_b128 a[148:151], v227 offset:10240
    v_fma_f32 v222, v222, s21, v241
    v_mfma_f32_16x16x32_bf16 v[196:199], a[156:159], a[60:63], v[196:199]
    v_exp_f32 v222, v222
    v_mfma_f32_16x16x32_bf16 v[192:195], a[156:159], a[28:31], v[192:195]
    v_cvt_pk_bf16_f32 v94, v220, v221
    v_fma_f32 v223, v223, s21, v241
    v_mfma_f32_16x16x32_bf16 v[192:195], a[152:155], a[24:27], v[192:195]
    s_waitcnt lgkmcnt(2)
    buffer_load_dwordx4 v234, s[8:11], s34 offen offset:2048 nt lds
    v_exp_f32 v223, v223
    v_mfma_f32_16x16x32_bf16 v[208:211], a[128:131], a[0:3], 0
    ds_read_b128 a[152:155], v226 offset:14336
    v_fma_f32 v200, v200, s21, v240
    v_mfma_f32_16x16x32_bf16 v[208:211], a[132:135], a[4:7], v[208:211]
    v_exp_f32 v200, v200
    v_mfma_f32_16x16x32_bf16 v[212:215], a[132:135], a[36:39], 0
    v_cvt_pk_bf16_f32 v95, v222, v223
    v_fma_f32 v201, v201, s21, v240
    v_mfma_f32_16x16x32_bf16 v[212:215], a[128:131], a[32:35], v[212:215]
    v_exp_f32 v201, v201
    v_mfma_f32_16x16x32_bf16 v[216:219], a[128:131], a[64:67], 0
    ds_read_b128 a[156:159], v227 offset:14336
    v_fma_f32 v202, v202, s21, v240
    v_mfma_f32_16x16x32_bf16 v[216:219], a[132:135], a[68:71], v[216:219]
L_hop2:
    s_cbranch_execz L_hopret0
    v_exp_f32 v202, v202
    v_mfma_f32_16x16x32_bf16 v[220:223], a[132:135], a[100:103], 0
    v_cvt_pk_bf16_f32 v112, v200, v201
    v_fma_f32 v203, v203, s21, v240
    v_mfma_f32_16x16x32_bf16 v[220:223], a[128:131], a[96:99], v[220:223]
    v_exp_f32 v203, v203
    v_mfma_f32_16x16x32_bf16 v[220:223], a[136:139], a[104:107], v[220:223]
    buffer_load_dwordx4 v235, s[8:11], s34 offen offset:3072 nt lds
    v_fma_f32 v192, v192, s21, v238
    v_mfma_f32_16x16x32_bf16 v[220:223], a[140:143], a[108:111], v[220:223]
    v_exp_f32 v192, v192
    v_mfma_f32_16x16x32_bf16 v[216:219], a[140:143], a[76:79], v[216:219]
    v_cvt_pk_bf16_f32 v113, v202, v203
    v_fma_f32 v193, v193, s21, v238
    v_mfma_f32_16x16x32_bf16 v[216:219], a[136:139], a[72:75], v[216:219]
    v_exp_f32 v193, v193
    v_mfma_f32_16x16x32_bf16 v[212:215], a[136:139], a[40:43], v[212:215]
    s_add_u32 m0, s23, 0x1c000
    v_fma_f32 v194, v194, s21, v238
    v_mfma_f32_16x16x32_bf16 v[212:215], a[140:143], a[44:47], v[212:215]
    s_xor_b32 s34, s30, 0x80
    v_exp_f32 v194, v194
    v_mfma_f32_16x16x32_bf16 v[208:211], a[140:143], a[12:15], v[208:211]
    v_cvt_pk_bf16_f32 v96, v192, v193
    v_fma_f32 v195, v195, s21, v238
    v_mfma_f32_16x16x32_bf16 v[208:211], a[136:139], a[8:11], v[208:211]
    s_waitcnt vmcnt(18) lgkmcnt(0)
    v_exp_f32 v195, v195
    v_smfmac_f32_16x16x64_bf16 a[192:195], a[208:211], v[64:71], v254
    s_barrier
    buffer_load_dwordx4 v232, s[4:7], s34 offen nt lds
    v_mfma_f32_16x16x32_bf16 v[208:211], a[144:147], a[16:19], v[208:211]
    ds_read_b128 a[128:131], v224 offset:0
    v_fma_f32 v196, v196, s21, v239
    v_mfma_f32_16x16x32_bf16 v[208:211], a[148:151], a[20:23], v[208:211]
    ds_read_b128 a[132:135], v225 offset:0
    v_exp_f32 v196, v196
    v_mfma_f32_16x16x32_bf16 v[212:215], a[148:151], a[52:55], v[212:215]
    v_cvt_pk_bf16_f32 v97, v194, v195
    v_fma_f32 v197, v197, s21, v239
    v_mfma_f32_16x16x32_bf16 v[212:215], a[144:147], a[48:51], v[212:215]
    v_exp_f32 v197, v197
    v_mfma_f32_16x16x32_bf16 v[216:219], a[144:147], a[80:83], v[216:219]
    ds_read_b128 a[136:139], v224 offset:4096
    v_fma_f32 v198, v198, s21, v239
    v_mfma_f32_16x16x32_bf16 v[216:219], a[148:151], a[84:87], v[216:219]
    ds_read_b128 a[140:143], v225 offset:4096
    v_exp_f32 v198, v198
    v_mfma_f32_16x16x32_bf16 v[220:223], a[148:151], a[116:119], v[220:223]
    v_cvt_pk_bf16_f32 v104, v196, v197
    v_fma_f32 v199, v199, s21, v239
    v_mfma_f32_16x16x32_bf16 v[220:223], a[144:147], a[112:115], v[220:223]
    v_exp_f32 v199, v199
    v_mfma_f32_16x16x32_bf16 v[220:223], a[152:155], a[120:123], v[220:223]
    ds_read_b128 a[144:147], v224 offset:8192
    v_fma_f32 v204, v204, s21, v241
    v_mfma_f32_16x16x32_bf16 v[220:223], a[156:159], a[124:127], v[220:223]
    v_exp_f32 v204, v204
    v_mfma_f32_16x16x32_bf16 v[216:219], a[156:159], a[92:95], v[216:219]
    v_cvt_pk_bf16_f32 v105, v198, v199
    v_fma_f32 v205, v205, s21, v241
    v_mfma_f32_16x16x32_bf16 v[216:219], a[152:155], a[88:91], v[216:219]
    buffer_load_dwordx4 v233, s[4:7], s34 offen offset:1024 nt lds
    v_exp_f32 v205, v205
    v_mfma_f32_16x16x32_bf16 v[212:215], a[152:155], a[56:59], v[212:215]
    ds_read_b128 a[148:151], v225 offset:8192
    v_fma_f32 v206, v206, s21, v241
    v_mfma_f32_16x16x32_bf16 v[212:215], a[156:159], a[60:63], v[212:215]
    v_exp_f32 v206, v206
    v_mfma_f32_16x16x32_bf16 v[208:211], a[156:159], a[28:31], v[208:211]
    v_cvt_pk_bf16_f32 v120, v204, v205
    v_fma_f32 v207, v207, s21, v241
    v_mfma_f32_16x16x32_bf16 v[208:211], a[152:155], a[24:27], v[208:211]
    s_waitcnt lgkmcnt(2)
    v_exp_f32 v207, v207
    v_mfma_f32_16x16x32_bf16 v[192:195], a[128:131], a[0:3], 0
    s_add_u32 m0, s23, 0x10000
    ds_read_b128 a[152:155], v224 offset:12288
    v_fma_f32 v216, v216, s21, v240
    v_mfma_f32_16x16x32_bf16 v[192:195], a[132:135], a[4:7], v[192:195]
    s_add_u32 s34, s28, 0x2c000
    v_exp_f32 v216, v216
    v_mfma_f32_16x16x32_bf16 v[196:199], a[132:135], a[36:39], 0
    v_cvt_pk_bf16_f32 v121, v206, v207
    v_fma_f32 v217, v217, s21, v240
    v_mfma_f32_16x16x32_bf16 v[196:199], a[128:131], a[32:35], v[196:199]
    v_exp_f32 v217, v217
    v_mfma_f32_16x16x32_bf16 v[200:203], a[128:131], a[64:67], 0
    ds_read_b128 a[156:159], v225 offset:12288
    v_fma_f32 v218, v218, s21, v240
    v_mfma_f32_16x16x32_bf16 v[200:203], a[132:135], a[68:71], v[200:203]
    buffer_load_dwordx4 v232, s[8:11], s34 offen nt lds
    v_exp_f32 v218, v218
    v_mfma_f32_16x16x32_bf16 v[204:207], a[132:135], a[100:103], 0
    v_cvt_pk_bf16_f32 v114, v216, v217
    v_fma_f32 v219, v219, s21, v240
    v_mfma_f32_16x16x32_bf16 v[204:207], a[128:131], a[96:99], v[204:207]
    v_exp_f32 v219, v219
    v_mfma_f32_16x16x32_bf16 v[204:207], a[136:139], a[104:107], v[204:207]
    ds_read_b128 a[128:131], v224 offset:2048
    v_fma_f32 v208, v208, s21, v238
    v_mfma_f32_16x16x32_bf16 v[204:207], a[140:143], a[108:111], v[204:207]
    v_exp_f32 v208, v208
    v_mfma_f32_16x16x32_bf16 v[200:203], a[140:143], a[76:79], v[200:203]
    v_cvt_pk_bf16_f32 v115, v218, v219
    v_fma_f32 v209, v209, s21, v238
    v_mfma_f32_16x16x32_bf16 v[200:203], a[136:139], a[72:75], v[200:203]
    v_exp_f32 v209, v209
    v_mfma_f32_16x16x32_bf16 v[196:199], a[136:139], a[40:43], v[196:199]
    ds_read_b128 a[132:135], v225 offset:2048
    v_fma_f32 v210, v210, s21, v238
    v_mfma_f32_16x16x32_bf16 v[196:199], a[140:143], a[44:47], v[196:199]
    v_exp_f32 v210, v210
    v_mfma_f32_16x16x32_bf16 v[192:195], a[140:143], a[12:15], v[192:195]
    v_cvt_pk_bf16_f32 v98, v208, v209
    v_fma_f32 v211, v211, s21, v238
    v_mfma_f32_16x16x32_bf16 v[192:195], a[136:139], a[8:11], v[192:195]
    s_waitcnt lgkmcnt(2)
    v_exp_f32 v211, v211
    v_smfmac_f32_16x16x64_bf16 a[196:199], a[208:211], v[72:79], v254
    buffer_load_dwordx4 v233, s[8:11], s34 offen offset:1024 nt lds
    v_mfma_f32_16x16x32_bf16 v[192:195], a[144:147], a[16:19], v[192:195]
    ds_read_b128 a[136:139], v224 offset:6144
    v_fma_f32 v212, v212, s21, v239
    v_mfma_f32_16x16x32_bf16 v[192:195], a[148:151], a[20:23], v[192:195]
    v_exp_f32 v212, v212
    v_mfma_f32_16x16x32_bf16 v[196:199], a[148:151], a[52:55], v[196:199]
    v_cvt_pk_bf16_f32 v99, v210, v211
    v_fma_f32 v213, v213, s21, v239
    v_mfma_f32_16x16x32_bf16 v[196:199], a[144:147], a[48:51], v[196:199]
    buffer_load_dwordx4 v234, s[8:11], s34 offen offset:2048 nt lds
    v_exp_f32 v213, v213
    v_mfma_f32_16x16x32_bf16 v[200:203], a[144:147], a[80:83], v[200:203]
    ds_read_b128 a[140:143], v225 offset:6144
    v_fma_f32 v214, v214, s21, v239
    v_mfma_f32_16x16x32_bf16 v[200:203], a[148:151], a[84:87], v[200:203]
    v_exp_f32 v214, v214
    v_mfma_f32_16x16x32_bf16 v[204:207], a[148:151], a[116:119], v[204:207]
    v_cvt_pk_bf16_f32 v106, v212, v213
    v_fma_f32 v215, v215, s21, v239
    v_mfma_f32_16x16x32_bf16 v[204:207], a[144:147], a[112:115], v[204:207]
    v_exp_f32 v215, v215
    v_mfma_f32_16x16x32_bf16 v[204:207], a[152:155], a[120:123], v[204:207]
    ds_read_b128 a[144:147], v224 offset:10240
    v_fma_f32 v220, v220, s21, v241
    v_mfma_f32_16x16x32_bf16 v[204:207], a[156:159], a[124:127], v[204:207]
    v_exp_f32 v220, v220
    v_mfma_f32_16x16x32_bf16 v[200:203], a[156:159], a[92:95], v[200:203]
    v_cvt_pk_bf16_f32 v107, v214, v215
    v_fma_f32 v221, v221, s21, v241
    v_mfma_f32_16x16x32_bf16 v[200:203], a[152:155], a[88:91], v[200:203]
    buffer_load_dwordx4 v235, s[8:11], s34 offen offset:3072 nt lds
    v_exp_f32 v221, v221
    v_mfma_f32_16x16x32_bf16 v[196:199], a[152:155], a[56:59], v[196:199]
    ds_read_b128 a[148:151], v225 offset:10240
    v_fma_f32 v222, v222, s21, v241
    v_mfma_f32_16x16x32_bf16 v[196:199], a[156:159], a[60:63], v[196:199]
    v_exp_f32 v222, v222
    v_mfma_f32_16x16x32_bf16 v[192:195], a[156:159], a[28:31], v[192:195]
    v_cvt_pk_bf16_f32 v122, v220, v221
    v_fma_f32 v223, v223, s21, v241
    v_mfma_f32_16x16x32_bf16 v[192:195], a[152:155], a[24:27], v[192:195]
    s_waitcnt lgkmcnt(2)
    v_exp_f32 v223, v223
    v_mfma_f32_16x16x32_bf16 v[208:211], a[128:131], a[0:3], 0
    s_add_u32 m0, s23, 0x1c000
    ds_read_b128 a[152:155], v224 offset:14336
    v_fma_f32 v200, v200, s21, v240
    v_mfma_f32_16x16x32_bf16 v[208:211], a[132:135], a[4:7], v[208:211]
    s_xor_b32 s34, s30, 0x80
    v_exp_f32 v200, v200
    v_mfma_f32_16x16x32_bf16 v[212:215], a[132:135], a[36:39], 0
    v_cvt_pk_bf16_f32 v123, v222, v223
    v_fma_f32 v201, v201, s21, v240
    v_mfma_f32_16x16x32_bf16 v[212:215], a[128:131], a[32:35], v[212:215]
    v_exp_f32 v201, v201
    v_mfma_f32_16x16x32_bf16 v[216:219], a[128:131], a[64:67], 0
    ds_read_b128 a[156:159], v225 offset:14336
    v_fma_f32 v202, v202, s21, v240
    v_mfma_f32_16x16x32_bf16 v[216:219], a[132:135], a[68:71], v[216:219]
    v_exp_f32 v202, v202
    v_mfma_f32_16x16x32_bf16 v[220:223], a[132:135], a[100:103], 0
    v_cvt_pk_bf16_f32 v116, v200, v201
    v_fma_f32 v203, v203, s21, v240
    v_mfma_f32_16x16x32_bf16 v[220:223], a[128:131], a[96:99], v[220:223]
    v_exp_f32 v203, v203
    v_mfma_f32_16x16x32_bf16 v[220:223], a[136:139], a[104:107], v[220:223]
    buffer_load_dwordx4 v234, s[4:7], s34 offen offset:2048 nt lds
    v_fma_f32 v192, v192, s21, v238
    v_mfma_f32_16x16x32_bf16 v[220:223], a[140:143], a[108:111], v[220:223]
    v_exp_f32 v192, v192
    v_mfma_f32_16x16x32_bf16 v[216:219], a[140:143], a[76:79], v[216:219]
    v_cvt_pk_bf16_f32 v117, v202, v203
    v_fma_f32 v193, v193, s21, v238
    v_mfma_f32_16x16x32_bf16 v[216:219], a[136:139], a[72:75], v[216:219]
    v_exp_f32 v193, v193
    v_mfma_f32_16x16x32_bf16 v[212:215], a[136:139], a[40:43], v[212:215]
    buffer_load_dwordx4 v235, s[4:7], s34 offen offset:3072 nt lds
    v_fma_f32 v194, v194, s21, v238
    v_mfma_f32_16x16x32_bf16 v[212:215], a[140:143], a[44:47], v[212:215]
    v_exp_f32 v194, v194
    v_mfma_f32_16x16x32_bf16 v[208:211], a[140:143], a[12:15], v[208:211]
    v_cvt_pk_bf16_f32 v100, v192, v193
    v_fma_f32 v195, v195, s21, v238
    v_mfma_f32_16x16x32_bf16 v[208:211], a[136:139], a[8:11], v[208:211]
    s_waitcnt vmcnt(20) lgkmcnt(0)
    v_exp_f32 v195, v195
    v_smfmac_f32_16x16x64_bf16 a[204:207], a[208:211], v[88:95], v254
    s_barrier
    v_mfma_f32_16x16x32_bf16 v[208:211], a[144:147], a[16:19], v[208:211]
    s_add_u32 m0, s23, 0
    ds_read_b128 a[128:131], v224 offset:16384
    v_fma_f32 v196, v196, s21, v239
    v_mfma_f32_16x16x32_bf16 v[208:211], a[148:151], a[20:23], v[208:211]
    s_add_u32 s34, s40, 0
    ds_read_b128 a[132:135], v225 offset:16384
    v_exp_f32 v196, v196
    v_mfma_f32_16x16x32_bf16 v[212:215], a[148:151], a[52:55], v[212:215]
    v_cvt_pk_bf16_f32 v101, v194, v195
    v_fma_f32 v197, v197, s21, v239
    v_mfma_f32_16x16x32_bf16 v[212:215], a[144:147], a[48:51], v[212:215]
    v_exp_f32 v197, v197
    v_mfma_f32_16x16x32_bf16 v[216:219], a[144:147], a[80:83], v[216:219]
    ds_read_b128 a[136:139], v224 offset:20480
    v_fma_f32 v198, v198, s21, v239
    v_mfma_f32_16x16x32_bf16 v[216:219], a[148:151], a[84:87], v[216:219]
    ds_read_b128 a[140:143], v225 offset:20480
    buffer_load_dwordx4 v232, s[12:15], s34 offen nt lds
    v_exp_f32 v198, v198
    v_mfma_f32_16x16x32_bf16 v[220:223], a[148:151], a[116:119], v[220:223]
    v_cvt_pk_bf16_f32 v108, v196, v197
    v_fma_f32 v199, v199, s21, v239
    v_mfma_f32_16x16x32_bf16 v[220:223], a[144:147], a[112:115], v[220:223]
    v_exp_f32 v199, v199
    v_mfma_f32_16x16x32_bf16 v[220:223], a[152:155], a[120:123], v[220:223]
    ds_read_b128 a[144:147], v224 offset:24576
    v_fma_f32 v204, v204, s21, v241
    v_mfma_f32_16x16x32_bf16 v[220:223], a[156:159], a[124:127], v[220:223]
    v_exp_f32 v204, v204
    v_mfma_f32_16x16x32_bf16 v[216:219], a[156:159], a[92:95], v[216:219]
    v_cvt_pk_bf16_f32 v109, v198, v199
    v_fma_f32 v205, v205, s21, v241
    v_mfma_f32_16x16x32_bf16 v[216:219], a[152:155], a[88:91], v[216:219]
    v_exp_f32 v205, v205
    v_mfma_f32_16x16x32_bf16 v[212:215], a[152:155], a[56:59], v[212:215]
    ds_read_b128 a[148:151], v225 offset:24576
    v_fma_f32 v206, v206, s21, v241
    v_mfma_f32_16x16x32_bf16 v[212:215], a[156:159], a[60:63], v[212:215]
    buffer_load_dwordx4 v233, s[12:15], s34 offen offset:1024 nt lds
    v_exp_f32 v206, v206
    v_mfma_f32_16x16x32_bf16 v[208:211], a[156:159], a[28:31], v[208:211]
    v_cvt_pk_bf16_f32 v124, v204, v205
    v_fma_f32 v207, v207, s21, v241
    v_mfma_f32_16x16x32_bf16 v[208:211], a[152:155], a[24:27], v[208:211]
    s_waitcnt lgkmcnt(2)
    v_exp_f32 v207, v207
    v_mfma_f32_16x16x32_bf16 v[192:195], a[128:131], a[0:3], 0
    ds_read_b128 a[152:155], v224 offset:28672
    v_fma_f32 v216, v216, s21, v240
    v_mfma_f32_16x16x32_bf16 v[192:195], a[132:135], a[4:7], v[192:195]
    v_exp_f32 v216, v216
    v_mfma_f32_16x16x32_bf16 v[196:199], a[132:135], a[36:39], 0
    v_cvt_pk_bf16_f32 v125, v206, v207
    v_fma_f32 v217, v217, s21, v240
    v_mfma_f32_16x16x32_bf16 v[196:199], a[128:131], a[32:35], v[196:199]
    v_exp_f32 v217, v217
    v_mfma_f32_16x16x32_bf16 v[200:203], a[128:131], a[64:67], 0
    ds_read_b128 a[156:159], v225 offset:28672
    v_fma_f32 v218, v218, s21, v240
    v_mfma_f32_16x16x32_bf16 v[200:203], a[132:135], a[68:71], v[200:203]
    buffer_load_dwordx4 v234, s[12:15], s34 offen offset:2048 nt lds
    v_exp_f32 v218, v218
    v_mfma_f32_16x16x32_bf16 v[204:207], a[132:135], a[100:103], 0
    v_cvt_pk_bf16_f32 v118, v216, v217
    v_fma_f32 v219, v219, s21, v240
    v_mfma_f32_16x16x32_bf16 v[204:207], a[128:131], a[96:99], v[204:207]
    v_exp_f32 v219, v219
    v_mfma_f32_16x16x32_bf16 v[204:207], a[136:139], a[104:107], v[204:207]
    ds_read_b128 a[128:131], v224 offset:18432
    v_fma_f32 v208, v208, s21, v238
    v_mfma_f32_16x16x32_bf16 v[204:207], a[140:143], a[108:111], v[204:207]
    v_exp_f32 v208, v208
    v_mfma_f32_16x16x32_bf16 v[200:203], a[140:143], a[76:79], v[200:203]
    v_cvt_pk_bf16_f32 v119, v218, v219
    v_fma_f32 v209, v209, s21, v238
    v_mfma_f32_16x16x32_bf16 v[200:203], a[136:139], a[72:75], v[200:203]
    v_exp_f32 v209, v209
    v_mfma_f32_16x16x32_bf16 v[196:199], a[136:139], a[40:43], v[196:199]
    ds_read_b128 a[132:135], v225 offset:18432
    v_fma_f32 v210, v210, s21, v238
    v_mfma_f32_16x16x32_bf16 v[196:199], a[140:143], a[44:47], v[196:199]
    v_exp_f32 v210, v210
    v_mfma_f32_16x16x32_bf16 v[192:195], a[140:143], a[12:15], v[192:195]
    v_cvt_pk_bf16_f32 v102, v208, v209
    v_fma_f32 v211, v211, s21, v238
    v_mfma_f32_16x16x32_bf16 v[192:195], a[136:139], a[8:11], v[192:195]
    s_waitcnt lgkmcnt(2)
    v_exp_f32 v211, v211
    v_smfmac_f32_16x16x64_bf16 a[200:203], a[208:211], v[112:119], v254
    buffer_load_dwordx4 v235, s[12:15], s34 offen offset:3072 nt lds
    v_mfma_f32_16x16x32_bf16 v[192:195], a[144:147], a[16:19], v[192:195]
    s_add_u32 m0, s23, 0x20000
    ds_read_b128 a[136:139], v224 offset:22528
    v_fma_f32 v212, v212, s21, v239
    v_mfma_f32_16x16x32_bf16 v[192:195], a[148:151], a[20:23], v[192:195]
    s_xor_b32 s34, s30, 0x100
    v_exp_f32 v212, v212
    v_mfma_f32_16x16x32_bf16 v[196:199], a[148:151], a[52:55], v[196:199]
    v_cvt_pk_bf16_f32 v103, v210, v211
    v_fma_f32 v213, v213, s21, v239
    v_mfma_f32_16x16x32_bf16 v[196:199], a[144:147], a[48:51], v[196:199]
    v_exp_f32 v213, v213
    v_mfma_f32_16x16x32_bf16 v[200:203], a[144:147], a[80:83], v[200:203]
    ds_read_b128 a[140:143], v225 offset:22528
    v_fma_f32 v214, v214, s21, v239
    v_mfma_f32_16x16x32_bf16 v[200:203], a[148:151], a[84:87], v[200:203]
    buffer_load_dwordx4 v232, s[4:7], s34 offen nt lds
    v_exp_f32 v214, v214
    v_mfma_f32_16x16x32_bf16 v[204:207], a[148:151], a[116:119], v[204:207]
    v_cvt_pk_bf16_f32 v110, v212, v213
    v_fma_f32 v215, v215, s21, v239
    v_mfma_f32_16x16x32_bf16 v[204:207], a[144:147], a[112:115], v[204:207]
    v_exp_f32 v215, v215
    v_mfma_f32_16x16x32_bf16 v[204:207], a[152:155], a[120:123], v[204:207]
    ds_read_b128 a[144:147], v224 offset:26624
    v_fma_f32 v220, v220, s21, v241
    v_mfma_f32_16x16x32_bf16 v[204:207], a[156:159], a[124:127], v[204:207]
    v_exp_f32 v220, v220
    v_mfma_f32_16x16x32_bf16 v[200:203], a[156:159], a[92:95], v[200:203]
    v_cvt_pk_bf16_f32 v111, v214, v215
    v_fma_f32 v221, v221, s21, v241
    v_mfma_f32_16x16x32_bf16 v[200:203], a[152:155], a[88:91], v[200:203]
    buffer_load_dwordx4 v233, s[4:7], s34 offen offset:1024 nt lds
    v_exp_f32 v221, v221
    v_mfma_f32_16x16x32_bf16 v[196:199], a[152:155], a[56:59], v[196:199]
    ds_read_b128 a[148:151], v225 offset:26624
    v_fma_f32 v222, v222, s21, v241
    v_mfma_f32_16x16x32_bf16 v[196:199], a[156:159], a[60:63], v[196:199]
    v_exp_f32 v222, v222
    v_mfma_f32_16x16x32_bf16 v[192:195], a[156:159], a[28:31], v[192:195]
    v_cvt_pk_bf16_f32 v126, v220, v221
    v_fma_f32 v223, v223, s21, v241
    v_mfma_f32_16x16x32_bf16 v[192:195], a[152:155], a[24:27], v[192:195]
    s_waitcnt lgkmcnt(2)
    v_exp_f32 v223, v223
    v_mfma_f32_16x16x32_bf16 v[208:211], a[128:131], a[0:3], 0
    s_add_u32 m0, s23, 0x14000
    ds_read_b128 a[152:155], v224 offset:30720
    v_fma_f32 v200, v200, s21, v240
    v_mfma_f32_16x16x32_bf16 v[208:211], a[132:135], a[4:7], v[208:211]
    s_add_u32 s34, s41, 0x20000
    v_exp_f32 v200, v200
    v_mfma_f32_16x16x32_bf16 v[212:215], a[132:135], a[36:39], 0
    v_cvt_pk_bf16_f32 v127, v222, v223
    v_fma_f32 v201, v201, s21, v240
    v_mfma_f32_16x16x32_bf16 v[212:215], a[128:131], a[32:35], v[212:215]
    v_exp_f32 v201, v201
    v_mfma_f32_16x16x32_bf16 v[216:219], a[128:131], a[64:67], 0
    ds_read_b128 a[156:159], v225 offset:30720
    v_fma_f32 v202, v202, s21, v240
    v_mfma_f32_16x16x32_bf16 v[216:219], a[132:135], a[68:71], v[216:219]
    v_exp_f32 v202, v202
    v_mfma_f32_16x16x32_bf16 v[220:223], a[132:135], a[100:103], 0
    v_cvt_pk_bf16_f32 v144, v200, v201
    v_fma_f32 v203, v203, s21, v240
    v_mfma_f32_16x16x32_bf16 v[220:223], a[128:131], a[96:99], v[220:223]
    v_exp_f32 v203, v203
    v_mfma_f32_16x16x32_bf16 v[220:223], a[136:139], a[104:107], v[220:223]
    buffer_load_dwordx4 v234, s[12:15], s34 offen offset:2048 nt lds
    v_fma_f32 v192, v192, s21, v238
    v_mfma_f32_16x16x32_bf16 v[220:223], a[140:143], a[108:111], v[220:223]
    v_exp_f32 v192, v192
    v_mfma_f32_16x16x32_bf16 v[216:219], a[140:143], a[76:79], v[216:219]
    v_cvt_pk_bf16_f32 v145, v202, v203
    v_fma_f32 v193, v193, s21, v238
    v_mfma_f32_16x16x32_bf16 v[216:219], a[136:139], a[72:75], v[216:219]
    v_exp_f32 v193, v193
    v_mfma_f32_16x16x32_bf16 v[212:215], a[136:139], a[40:43], v[212:215]
    buffer_load_dwordx4 v235, s[12:15], s34 offen offset:3072 nt lds
    v_fma_f32 v194, v194, s21, v238
    v_mfma_f32_16x16x32_bf16 v[212:215], a[140:143], a[44:47], v[212:215]
    v_exp_f32 v194, v194
    v_mfma_f32_16x16x32_bf16 v[208:211], a[140:143], a[12:15], v[208:211]
    v_cvt_pk_bf16_f32 v128, v192, v193
    v_fma_f32 v195, v195, s21, v238
    v_mfma_f32_16x16x32_bf16 v[208:211], a[136:139], a[8:11], v[208:211]
    s_waitcnt vmcnt(22) lgkmcnt(0)
    v_exp_f32 v195, v195
    v_smfmac_f32_16x16x64_bf16 a[192:195], a[208:211], v[96:103], v254
    s_barrier
    v_mfma_f32_16x16x32_bf16 v[208:211], a[144:147], a[16:19], v[208:211]
    s_add_u32 m0, s23, 0x4000
    ds_read_b128 a[128:131], v224 offset:32768
    v_fma_f32 v196, v196, s21, v239
    v_mfma_f32_16x16x32_bf16 v[208:211], a[148:151], a[20:23], v[208:211]
    s_add_u32 s34, s40, 0x10000
    ds_read_b128 a[132:135], v225 offset:32768
    v_exp_f32 v196, v196
    v_mfma_f32_16x16x32_bf16 v[212:215], a[148:151], a[52:55], v[212:215]
    v_cvt_pk_bf16_f32 v129, v194, v195
    v_fma_f32 v197, v197, s21, v239
    v_mfma_f32_16x16x32_bf16 v[212:215], a[144:147], a[48:51], v[212:215]
    v_exp_f32 v197, v197
    v_mfma_f32_16x16x32_bf16 v[216:219], a[144:147], a[80:83], v[216:219]
    ds_read_b128 a[136:139], v224 offset:36864
    v_fma_f32 v198, v198, s21, v239
    v_mfma_f32_16x16x32_bf16 v[216:219], a[148:151], a[84:87], v[216:219]
    ds_read_b128 a[140:143], v225 offset:36864
    buffer_load_dwordx4 v232, s[12:15], s34 offen nt lds
    v_exp_f32 v198, v198
    v_mfma_f32_16x16x32_bf16 v[220:223], a[148:151], a[116:119], v[220:223]
    v_cvt_pk_bf16_f32 v136, v196, v197
    v_fma_f32 v199, v199, s21, v239
    v_mfma_f32_16x16x32_bf16 v[220:223], a[144:147], a[112:115], v[220:223]
    v_exp_f32 v199, v199
    v_mfma_f32_16x16x32_bf16 v[220:223], a[152:155], a[120:123], v[220:223]
    ds_read_b128 a[144:147], v224 offset:40960
    v_fma_f32 v204, v204, s21, v241
    v_mfma_f32_16x16x32_bf16 v[220:223], a[156:159], a[124:127], v[220:223]
    v_exp_f32 v204, v204
    v_mfma_f32_16x16x32_bf16 v[216:219], a[156:159], a[92:95], v[216:219]
    v_cvt_pk_bf16_f32 v137, v198, v199
    v_fma_f32 v205, v205, s21, v241
    v_mfma_f32_16x16x32_bf16 v[216:219], a[152:155], a[88:91], v[216:219]
    v_exp_f32 v205, v205
    v_mfma_f32_16x16x32_bf16 v[212:215], a[152:155], a[56:59], v[212:215]
    ds_read_b128 a[148:151], v225 offset:40960
    v_fma_f32 v206, v206, s21, v241
    v_mfma_f32_16x16x32_bf16 v[212:215], a[156:159], a[60:63], v[212:215]
    buffer_load_dwordx4 v233, s[12:15], s34 offen offset:1024 nt lds
    v_exp_f32 v206, v206
    v_mfma_f32_16x16x32_bf16 v[208:211], a[156:159], a[28:31], v[208:211]
    v_cvt_pk_bf16_f32 v152, v204, v205
    v_fma_f32 v207, v207, s21, v241
    v_mfma_f32_16x16x32_bf16 v[208:211], a[152:155], a[24:27], v[208:211]
    s_waitcnt lgkmcnt(2)
    v_exp_f32 v207, v207
    v_mfma_f32_16x16x32_bf16 v[192:195], a[128:131], a[0:3], 0
    ds_read_b128 a[152:155], v224 offset:45056
    v_fma_f32 v216, v216, s21, v240
    v_mfma_f32_16x16x32_bf16 v[192:195], a[132:135], a[4:7], v[192:195]
    v_exp_f32 v216, v216
    v_mfma_f32_16x16x32_bf16 v[196:199], a[132:135], a[36:39], 0
    v_cvt_pk_bf16_f32 v153, v206, v207
    v_fma_f32 v217, v217, s21, v240
    v_mfma_f32_16x16x32_bf16 v[196:199], a[128:131], a[32:35], v[196:199]
    v_exp_f32 v217, v217
    v_mfma_f32_16x16x32_bf16 v[200:203], a[128:131], a[64:67], 0
    ds_read_b128 a[156:159], v225 offset:45056
    v_fma_f32 v218, v218, s21, v240
    v_mfma_f32_16x16x32_bf16 v[200:203], a[132:135], a[68:71], v[200:203]
    buffer_load_dwordx4 v234, s[12:15], s34 offen offset:2048 nt lds
    v_exp_f32 v218, v218
    v_mfma_f32_16x16x32_bf16 v[204:207], a[132:135], a[100:103], 0
    v_cvt_pk_bf16_f32 v146, v216, v217
    v_fma_f32 v219, v219, s21, v240
    v_mfma_f32_16x16x32_bf16 v[204:207], a[128:131], a[96:99], v[204:207]
    v_exp_f32 v219, v219
    v_mfma_f32_16x16x32_bf16 v[204:207], a[136:139], a[104:107], v[204:207]
    ds_read_b128 a[128:131], v224 offset:34816
    v_fma_f32 v208, v208, s21, v238
    v_mfma_f32_16x16x32_bf16 v[204:207], a[140:143], a[108:111], v[204:207]
    v_exp_f32 v208, v208
    v_mfma_f32_16x16x32_bf16 v[200:203], a[140:143], a[76:79], v[200:203]
    v_cvt_pk_bf16_f32 v147, v218, v219
    v_fma_f32 v209, v209, s21, v238
    v_mfma_f32_16x16x32_bf16 v[200:203], a[136:139], a[72:75], v[200:203]
    v_exp_f32 v209, v209
    v_mfma_f32_16x16x32_bf16 v[196:199], a[136:139], a[40:43], v[196:199]
    ds_read_b128 a[132:135], v225 offset:34816
    v_fma_f32 v210, v210, s21, v238
    v_mfma_f32_16x16x32_bf16 v[196:199], a[140:143], a[44:47], v[196:199]
    v_exp_f32 v210, v210
    v_mfma_f32_16x16x32_bf16 v[192:195], a[140:143], a[12:15], v[192:195]
    v_cvt_pk_bf16_f32 v130, v208, v209
    v_fma_f32 v211, v211, s21, v238
    v_mfma_f32_16x16x32_bf16 v[192:195], a[136:139], a[8:11], v[192:195]
    s_waitcnt lgkmcnt(2)
    v_exp_f32 v211, v211
    v_smfmac_f32_16x16x64_bf16 a[196:199], a[208:211], v[104:111], v254
    buffer_load_dwordx4 v235, s[12:15], s34 offen offset:3072 nt lds
    v_mfma_f32_16x16x32_bf16 v[192:195], a[144:147], a[16:19], v[192:195]
    s_add_u32 m0, s23, 0x20000
    ds_read_b128 a[136:139], v224 offset:38912
    v_fma_f32 v212, v212, s21, v239
    v_mfma_f32_16x16x32_bf16 v[192:195], a[148:151], a[20:23], v[192:195]
    s_xor_b32 s34, s30, 0x100
    v_exp_f32 v212, v212
    v_mfma_f32_16x16x32_bf16 v[196:199], a[148:151], a[52:55], v[196:199]
    v_cvt_pk_bf16_f32 v131, v210, v211
    v_fma_f32 v213, v213, s21, v239
    v_mfma_f32_16x16x32_bf16 v[196:199], a[144:147], a[48:51], v[196:199]
    v_exp_f32 v213, v213
    v_mfma_f32_16x16x32_bf16 v[200:203], a[144:147], a[80:83], v[200:203]
    ds_read_b128 a[140:143], v225 offset:38912
    v_fma_f32 v214, v214, s21, v239
    v_mfma_f32_16x16x32_bf16 v[200:203], a[148:151], a[84:87], v[200:203]
    buffer_load_dwordx4 v234, s[4:7], s34 offen offset:2048 nt lds
    v_exp_f32 v214, v214
    v_mfma_f32_16x16x32_bf16 v[204:207], a[148:151], a[116:119], v[204:207]
    v_cvt_pk_bf16_f32 v138, v212, v213
    v_fma_f32 v215, v215, s21, v239
    v_mfma_f32_16x16x32_bf16 v[204:207], a[144:147], a[112:115], v[204:207]
    v_exp_f32 v215, v215
    v_mfma_f32_16x16x32_bf16 v[204:207], a[152:155], a[120:123], v[204:207]
    ds_read_b128 a[144:147], v224 offset:43008
    v_fma_f32 v220, v220, s21, v241
    v_mfma_f32_16x16x32_bf16 v[204:207], a[156:159], a[124:127], v[204:207]
    v_exp_f32 v220, v220
    v_mfma_f32_16x16x32_bf16 v[200:203], a[156:159], a[92:95], v[200:203]
    v_cvt_pk_bf16_f32 v139, v214, v215
    v_fma_f32 v221, v221, s21, v241
    v_mfma_f32_16x16x32_bf16 v[200:203], a[152:155], a[88:91], v[200:203]
    buffer_load_dwordx4 v235, s[4:7], s34 offen offset:3072 nt lds
    v_exp_f32 v221, v221
    v_mfma_f32_16x16x32_bf16 v[196:199], a[152:155], a[56:59], v[196:199]
    ds_read_b128 a[148:151], v225 offset:43008
    v_fma_f32 v222, v222, s21, v241
    v_mfma_f32_16x16x32_bf16 v[196:199], a[156:159], a[60:63], v[196:199]
    v_exp_f32 v222, v222
    v_mfma_f32_16x16x32_bf16 v[192:195], a[156:159], a[28:31], v[192:195]
    v_cvt_pk_bf16_f32 v154, v220, v221
    v_fma_f32 v223, v223, s21, v241
    v_mfma_f32_16x16x32_bf16 v[192:195], a[152:155], a[24:27], v[192:195]
    s_waitcnt lgkmcnt(2)
    v_exp_f32 v223, v223
    v_mfma_f32_16x16x32_bf16 v[208:211], a[128:131], a[0:3], 0
    s_add_u32 m0, s23, 0x24000
    ds_read_b128 a[152:155], v224 offset:47104
    v_fma_f32 v200, v200, s21, v240
    v_mfma_f32_16x16x32_bf16 v[208:211], a[132:135], a[4:7], v[208:211]
    s_xor_b32 s34, s30, 0x180
    v_exp_f32 v200, v200
    v_mfma_f32_16x16x32_bf16 v[212:215], a[132:135], a[36:39], 0
    v_cvt_pk_bf16_f32 v155, v222, v223
    v_fma_f32 v201, v201, s21, v240
    v_mfma_f32_16x16x32_bf16 v[212:215], a[128:131], a[32:35], v[212:215]
    v_exp_f32 v201, v201
    v_mfma_f32_16x16x32_bf16 v[216:219], a[128:131], a[64:67], 0
    ds_read_b128 a[156:159], v225 offset:47104
    v_fma_f32 v202, v202, s21, v240
    v_mfma_f32_16x16x32_bf16 v[216:219], a[132:135], a[68:71], v[216:219]
    v_exp_f32 v202, v202
    v_mfma_f32_16x16x32_bf16 v[220:223], a[132:135], a[100:103], 0
    v_cvt_pk_bf16_f32 v148, v200, v201
    v_fma_f32 v203, v203, s21, v240
    v_mfma_f32_16x16x32_bf16 v[220:223], a[128:131], a[96:99], v[220:223]
    v_exp_f32 v203, v203
    v_mfma_f32_16x16x32_bf16 v[220:223], a[136:139], a[104:107], v[220:223]
    s_waitcnt vmcnt(14)
    buffer_load_dwordx4 v232, s[4:7], s34 offen nt lds
    v_fma_f32 v192, v192, s21, v238
    v_mfma_f32_16x16x32_bf16 v[220:223], a[140:143], a[108:111], v[220:223]
    v_exp_f32 v192, v192
    v_mfma_f32_16x16x32_bf16 v[216:219], a[140:143], a[76:79], v[216:219]
    v_cvt_pk_bf16_f32 v149, v202, v203
    v_fma_f32 v193, v193, s21, v238
    v_mfma_f32_16x16x32_bf16 v[216:219], a[136:139], a[72:75], v[216:219]
    v_exp_f32 v193, v193
    v_mfma_f32_16x16x32_bf16 v[212:215], a[136:139], a[40:43], v[212:215]
    buffer_load_dwordx4 v233, s[4:7], s34 offen offset:1024 nt lds
    v_fma_f32 v194, v194, s21, v238
    v_mfma_f32_16x16x32_bf16 v[212:215], a[140:143], a[44:47], v[212:215]
    v_exp_f32 v194, v194
    v_mfma_f32_16x16x32_bf16 v[208:211], a[140:143], a[12:15], v[208:211]
    v_cvt_pk_bf16_f32 v132, v192, v193
    v_fma_f32 v195, v195, s21, v238
    v_mfma_f32_16x16x32_bf16 v[208:211], a[136:139], a[8:11], v[208:211]
    s_waitcnt lgkmcnt(0)
    v_exp_f32 v195, v195
    v_smfmac_f32_16x16x64_bf16 a[204:207], a[208:211], v[120:127], v254
    s_barrier
    v_mfma_f32_16x16x32_bf16 v[208:211], a[144:147], a[16:19], v[208:211]
L_hop3:
    s_cbranch_execz L_hopret0
    s_add_u32 m0, s23, 0x8000
    ds_read_b128 a[128:131], v224 offset:49152
    v_fma_f32 v196, v196, s21, v239
    v_mfma_f32_16x16x32_bf16 v[208:211], a[148:151], a[20:23], v[208:211]
    s_add_u32 s34, s40, 0x20000
    ds_read_b128 a[132:135], v225 offset:49152
    v_exp_f32 v196, v196
    v_mfma_f32_16x16x32_bf16 v[212:215], a[148:151], a[52:55], v[212:215]
    v_cvt_pk_bf16_f32 v133, v194, v195
    v_fma_f32 v197, v197, s21, v239
    v_mfma_f32_16x16x32_bf16 v[212:215], a[144:147], a[48:51], v[212:215]
    v_exp_f32 v197, v197
    v_mfma_f32_16x16x32_bf16 v[216:219], a[144:147], a[80:83], v[216:219]
    ds_read_b128 a[136:139], v224 offset:53248
    v_fma_f32 v198, v198, s21, v239
    v_mfma_f32_16x16x32_bf16 v[216:219], a[148:151], a[84:87], v[216:219]
    ds_read_b128 a[140:143], v225 offset:53248
    buffer_load_dwordx4 v232, s[12:15], s34 offen nt lds
    v_exp_f32 v198, v198
    v_mfma_f32_16x16x32_bf16 v[220:223], a[148:151], a[116:119], v[220:223]
    v_cvt_pk_bf16_f32 v140, v196, v197
    v_fma_f32 v199, v199, s21, v239
    v_mfma_f32_16x16x32_bf16 v[220:223], a[144:147], a[112:115], v[220:223]
    v_exp_f32 v199, v199
    v_mfma_f32_16x16x32_bf16 v[220:223], a[152:155], a[120:123], v[220:223]
    ds_read_b128 a[144:147], v224 offset:57344
    v_fma_f32 v204, v204, s21, v241
    v_mfma_f32_16x16x32_bf16 v[220:223], a[156:159], a[124:127], v[220:223]
    ds_read_b128 a[176:179], v228 offset:16384
    v_exp_f32 v204, v204
    v_mfma_f32_16x16x32_bf16 v[216:219], a[156:159], a[92:95], v[216:219]
    v_cvt_pk_bf16_f32 v141, v198, v199
    v_fma_f32 v205, v205, s21, v241
    v_mfma_f32_16x16x32_bf16 v[216:219], a[152:155], a[88:91], v[216:219]
    ds_read_b128 a[184:187], v228 offset:18432
    v_exp_f32 v205, v205
    v_mfma_f32_16x16x32_bf16 v[212:215], a[152:155], a[56:59], v[212:215]
    ds_read_b128 a[148:151], v225 offset:57344
    v_fma_f32 v206, v206, s21, v241
    v_mfma_f32_16x16x32_bf16 v[212:215], a[156:159], a[60:63], v[212:215]
    buffer_load_dwordx4 v233, s[12:15], s34 offen offset:1024 nt lds
    v_exp_f32 v206, v206
    v_mfma_f32_16x16x32_bf16 v[208:211], a[156:159], a[28:31], v[208:211]
    v_cvt_pk_bf16_f32 v156, v204, v205
    v_fma_f32 v207, v207, s21, v241
    v_mfma_f32_16x16x32_bf16 v[208:211], a[152:155], a[24:27], v[208:211]
    s_waitcnt lgkmcnt(4)
    v_exp_f32 v207, v207
    v_mfma_f32_16x16x32_bf16 v[192:195], a[128:131], a[0:3], 0
    ds_read_b128 a[152:155], v224 offset:61440
    v_fma_f32 v216, v216, s21, v240
    v_mfma_f32_16x16x32_bf16 v[192:195], a[132:135], a[4:7], v[192:195]
    v_exp_f32 v216, v216
    v_mfma_f32_16x16x32_bf16 v[196:199], a[132:135], a[36:39], 0
    v_cvt_pk_bf16_f32 v157, v206, v207
    v_fma_f32 v217, v217, s21, v240
    v_mfma_f32_16x16x32_bf16 v[196:199], a[128:131], a[32:35], v[196:199]
    v_exp_f32 v217, v217
    v_mfma_f32_16x16x32_bf16 v[200:203], a[128:131], a[64:67], 0
    ds_read_b128 a[156:159], v225 offset:61440
    v_fma_f32 v218, v218, s21, v240
    v_mfma_f32_16x16x32_bf16 v[200:203], a[132:135], a[68:71], v[200:203]
    buffer_load_dwordx4 v234, s[12:15], s34 offen offset:2048 nt lds
    v_exp_f32 v218, v218
    v_mfma_f32_16x16x32_bf16 v[204:207], a[132:135], a[100:103], 0
    v_cvt_pk_bf16_f32 v150, v216, v217
    v_fma_f32 v219, v219, s21, v240
    v_mfma_f32_16x16x32_bf16 v[204:207], a[128:131], a[96:99], v[204:207]
    v_exp_f32 v219, v219
    v_mfma_f32_16x16x32_bf16 v[204:207], a[136:139], a[104:107], v[204:207]
    ds_read_b128 a[128:131], v224 offset:51200
    v_fma_f32 v208, v208, s21, v238
    v_mfma_f32_16x16x32_bf16 v[204:207], a[140:143], a[108:111], v[204:207]
    v_exp_f32 v208, v208
    v_mfma_f32_16x16x32_bf16 v[200:203], a[140:143], a[76:79], v[200:203]
    v_cvt_pk_bf16_f32 v151, v218, v219
    v_fma_f32 v209, v209, s21, v238
    v_mfma_f32_16x16x32_bf16 v[200:203], a[136:139], a[72:75], v[200:203]
    ds_read_b128 a[180:183], v229 offset:16384
    v_exp_f32 v209, v209
    v_mfma_f32_16x16x32_bf16 v[196:199], a[136:139], a[40:43], v[196:199]
    ds_read_b128 a[132:135], v225 offset:51200
    v_fma_f32 v210, v210, s21, v238
    v_mfma_f32_16x16x32_bf16 v[196:199], a[140:143], a[44:47], v[196:199]
    ds_read_b128 a[188:191], v229 offset:18432
    v_exp_f32 v210, v210
    v_mfma_f32_16x16x32_bf16 v[192:195], a[140:143], a[12:15], v[192:195]
    v_cvt_pk_bf16_f32 v134, v208, v209
    v_fma_f32 v211, v211, s21, v238
    v_mfma_f32_16x16x32_bf16 v[192:195], a[136:139], a[8:11], v[192:195]
    s_waitcnt lgkmcnt(4)
    v_exp_f32 v211, v211
    v_smfmac_f32_16x16x64_bf16 a[200:203], a[208:211], v[144:151], v254
    buffer_load_dwordx4 v235, s[12:15], s34 offen offset:3072 nt lds
    v_mfma_f32_16x16x32_bf16 v[192:195], a[144:147], a[16:19], v[192:195]
    s_add_u32 m0, s23, 0x24000
    ds_read_b128 a[136:139], v224 offset:55296
    v_fma_f32 v212, v212, s21, v239
    v_mfma_f32_16x16x32_bf16 v[192:195], a[148:151], a[20:23], v[192:195]
    v_exp_f32 v212, v212
    v_mfma_f32_16x16x32_bf16 v[196:199], a[148:151], a[52:55], v[196:199]
    s_xor_b32 s34, s30, 0x180
    v_cvt_pk_bf16_f32 v135, v210, v211
    v_fma_f32 v213, v213, s21, v239
    v_mfma_f32_16x16x32_bf16 v[196:199], a[144:147], a[48:51], v[196:199]
    v_exp_f32 v213, v213
    v_mfma_f32_16x16x32_bf16 v[200:203], a[144:147], a[80:83], v[200:203]
    ds_read_b128 a[140:143], v225 offset:55296
    v_fma_f32 v214, v214, s21, v239
    v_mfma_f32_16x16x32_bf16 v[200:203], a[148:151], a[84:87], v[200:203]
    v_exp_f32 v214, v214
    v_mfma_f32_16x16x32_bf16 v[204:207], a[148:151], a[116:119], v[204:207]
    v_cvt_pk_bf16_f32 v142, v212, v213
    v_fma_f32 v215, v215, s21, v239
    v_mfma_f32_16x16x32_bf16 v[204:207], a[144:147], a[112:115], v[204:207]
    v_exp_f32 v215, v215
    v_mfma_f32_16x16x32_bf16 v[204:207], a[152:155], a[120:123], v[204:207]
    ds_read_b128 a[144:147], v224 offset:59392
    v_fma_f32 v220, v220, s21, v241
    v_mfma_f32_16x16x32_bf16 v[204:207], a[156:159], a[124:127], v[204:207]
    ds_read_b128 a[160:163], v228 offset:0
    v_exp_f32 v220, v220
    v_mfma_f32_16x16x32_bf16 v[200:203], a[156:159], a[92:95], v[200:203]
    v_cvt_pk_bf16_f32 v143, v214, v215
    v_fma_f32 v221, v221, s21, v241
    v_mfma_f32_16x16x32_bf16 v[200:203], a[152:155], a[88:91], v[200:203]
    buffer_load_dwordx4 v234, s[4:7], s34 offen offset:2048 nt lds
    v_exp_f32 v221, v221
    v_mfma_f32_16x16x32_bf16 v[196:199], a[152:155], a[56:59], v[196:199]
    ds_read_b128 a[148:151], v225 offset:59392
    v_fma_f32 v222, v222, s21, v241
    v_mfma_f32_16x16x32_bf16 v[196:199], a[156:159], a[60:63], v[196:199]
    v_exp_f32 v222, v222
    v_mfma_f32_16x16x32_bf16 v[192:195], a[156:159], a[28:31], v[192:195]
    v_cvt_pk_bf16_f32 v158, v220, v221
    v_fma_f32 v223, v223, s21, v241
    v_mfma_f32_16x16x32_bf16 v[192:195], a[152:155], a[24:27], v[192:195]
    s_waitcnt lgkmcnt(3)
    v_exp_f32 v223, v223
    v_mfma_f32_16x16x32_bf16 v[208:211], a[128:131], a[0:3], 0
    ds_read_b128 a[152:155], v224 offset:63488
    v_fma_f32 v200, v200, s21, v240
    v_mfma_f32_16x16x32_bf16 v[208:211], a[132:135], a[4:7], v[208:211]
    v_exp_f32 v200, v200
    v_mfma_f32_16x16x32_bf16 v[212:215], a[132:135], a[36:39], 0
    v_cvt_pk_bf16_f32 v159, v222, v223
    v_fma_f32 v201, v201, s21, v240
    v_mfma_f32_16x16x32_bf16 v[212:215], a[128:131], a[32:35], v[212:215]
    v_exp_f32 v201, v201
    v_mfma_f32_16x16x32_bf16 v[216:219], a[128:131], a[64:67], 0
    ds_read_b128 a[156:159], v225 offset:63488
    v_fma_f32 v202, v202, s21, v240
    v_mfma_f32_16x16x32_bf16 v[216:219], a[132:135], a[68:71], v[216:219]
    v_exp_f32 v202, v202
    v_mfma_f32_16x16x32_bf16 v[220:223], a[132:135], a[100:103], 0
    v_cvt_pk_bf16_f32 v176, v200, v201
    v_fma_f32 v203, v203, s21, v240
    v_mfma_f32_16x16x32_bf16 v[220:223], a[128:131], a[96:99], v[220:223]
    v_exp_f32 v203, v203
    v_mfma_f32_16x16x32_bf16 v[220:223], a[136:139], a[104:107], v[220:223]
    buffer_load_dwordx4 v235, s[4:7], s34 offen offset:3072 nt lds
    v_fma_f32 v192, v192, s21, v238
    v_mfma_f32_16x16x32_bf16 v[220:223], a[140:143], a[108:111], v[220:223]
    v_exp_f32 v192, v192
    v_mfma_f32_16x16x32_bf16 v[216:219], a[140:143], a[76:79], v[216:219]
    v_cvt_pk_bf16_f32 v177, v202, v203
    v_fma_f32 v193, v193, s21, v238
    v_mfma_f32_16x16x32_bf16 v[216:219], a[136:139], a[72:75], v[216:219]
    v_exp_f32 v193, v193
    v_mfma_f32_16x16x32_bf16 v[212:215], a[136:139], a[40:43], v[212:215]
    ds_read_b128 a[164:167], v229 offset:0
    v_fma_f32 v194, v194, s21, v238
    v_mfma_f32_16x16x32_bf16 v[212:215], a[140:143], a[44:47], v[212:215]
    v_exp_f32 v194, v194
    v_mfma_f32_16x16x32_bf16 v[208:211], a[140:143], a[12:15], v[208:211]
    v_cvt_pk_bf16_f32 v160, v192, v193
    v_fma_f32 v195, v195, s21, v238
    v_mfma_f32_16x16x32_bf16 v[208:211], a[136:139], a[8:11], v[208:211]
    s_waitcnt lgkmcnt(1)
    v_exp_f32 v195, v195
    v_smfmac_f32_16x16x64_bf16 a[192:195], a[208:211], v[128:135], v254
    s_barrier
    ds_read_b128 a[168:171], v228 offset:2048
    v_mfma_f32_16x16x32_bf16 v[208:211], a[144:147], a[16:19], v[208:211]
    s_add_u32 m0, s23, 0xc000
    ds_read_b128 a[128:131], v226 offset:0
    v_fma_f32 v196, v196, s21, v239
    v_mfma_f32_16x16x32_bf16 v[208:211], a[148:151], a[20:23], v[208:211]
    s_add_u32 s34, s41, 0
    ds_read_b128 a[132:135], v227 offset:0
    v_exp_f32 v196, v196
    v_mfma_f32_16x16x32_bf16 v[212:215], a[148:151], a[52:55], v[212:215]
    v_cvt_pk_bf16_f32 v161, v194, v195
    v_fma_f32 v197, v197, s21, v239
    v_mfma_f32_16x16x32_bf16 v[212:215], a[144:147], a[48:51], v[212:215]
    v_exp_f32 v197, v197
    v_mfma_f32_16x16x32_bf16 v[216:219], a[144:147], a[80:83], v[216:219]
    ds_read_b128 a[136:139], v226 offset:4096
    v_fma_f32 v198, v198, s21, v239
    v_mfma_f32_16x16x32_bf16 v[216:219], a[148:151], a[84:87], v[216:219]
    ds_read_b128 a[140:143], v227 offset:4096
    buffer_load_dwordx4 v232, s[12:15], s34 offen nt lds
    v_exp_f32 v198, v198
    v_mfma_f32_16x16x32_bf16 v[220:223], a[148:151], a[116:119], v[220:223]
    v_cvt_pk_bf16_f32 v168, v196, v197
    v_fma_f32 v199, v199, s21, v239
    v_mfma_f32_16x16x32_bf16 v[220:223], a[144:147], a[112:115], v[220:223]
    v_exp_f32 v199, v199
    v_mfma_f32_16x16x32_bf16 v[220:223], a[152:155], a[120:123], v[220:223]
    ds_read_b128 a[144:147], v226 offset:8192
    v_fma_f32 v204, v204, s21, v241
    v_mfma_f32_16x16x32_bf16 v[220:223], a[156:159], a[124:127], v[220:223]
    v_exp_f32 v204, v204
    v_mfma_f32_16x16x32_bf16 v[216:219], a[156:159], a[92:95], v[216:219]
    v_cvt_pk_bf16_f32 v169, v198, v199
    v_fma_f32 v205, v205, s21, v241
    v_mfma_f32_16x16x32_bf16 v[216:219], a[152:155], a[88:91], v[216:219]
    ds_read_b128 a[172:175], v229 offset:2048
    v_exp_f32 v205, v205
    v_mfma_f32_16x16x32_bf16 v[212:215], a[152:155], a[56:59], v[212:215]
    ds_read_b128 a[148:151], v227 offset:8192
    v_fma_f32 v206, v206, s21, v241
    v_mfma_f32_16x16x32_bf16 v[212:215], a[156:159], a[60:63], v[212:215]
    buffer_load_dwordx4 v233, s[12:15], s34 offen offset:1024 nt lds
    v_exp_f32 v206, v206
    v_mfma_f32_16x16x32_bf16 v[208:211], a[156:159], a[28:31], v[208:211]
    v_cvt_pk_bf16_f32 v184, v204, v205
    v_fma_f32 v207, v207, s21, v241
    v_mfma_f32_16x16x32_bf16 v[208:211], a[152:155], a[24:27], v[208:211]
    s_waitcnt lgkmcnt(3)
    v_exp_f32 v207, v207
    v_mfma_f32_16x16x32_bf16 v[192:195], a[128:131], a[0:3], 0
    ds_read_b128 a[152:155], v226 offset:12288
    v_fma_f32 v216, v216, s21, v240
    v_mfma_f32_16x16x32_bf16 v[192:195], a[132:135], a[4:7], v[192:195]
    v_exp_f32 v216, v216
    v_mfma_f32_16x16x32_bf16 v[196:199], a[132:135], a[36:39], 0
    v_cvt_pk_bf16_f32 v185, v206, v207
    v_fma_f32 v217, v217, s21, v240
    v_mfma_f32_16x16x32_bf16 v[196:199], a[128:131], a[32:35], v[196:199]
    v_exp_f32 v217, v217
    v_mfma_f32_16x16x32_bf16 v[200:203], a[128:131], a[64:67], 0
    ds_read_b128 a[156:159], v227 offset:12288
    v_fma_f32 v218, v218, s21, v240
    v_mfma_f32_16x16x32_bf16 v[200:203], a[132:135], a[68:71], v[200:203]
    buffer_load_dwordx4 v234, s[12:15], s34 offen offset:2048 nt lds
    v_exp_f32 v218, v218
    v_mfma_f32_16x16x32_bf16 v[204:207], a[132:135], a[100:103], 0
    v_cvt_pk_bf16_f32 v178, v216, v217
    v_fma_f32 v219, v219, s21, v240
    v_mfma_f32_16x16x32_bf16 v[204:207], a[128:131], a[96:99], v[204:207]
    v_exp_f32 v219, v219
    v_mfma_f32_16x16x32_bf16 v[204:207], a[136:139], a[104:107], v[204:207]
    ds_read_b128 a[128:131], v226 offset:2048
    v_fma_f32 v208, v208, s21, v238
    v_mfma_f32_16x16x32_bf16 v[204:207], a[140:143], a[108:111], v[204:207]
    v_exp_f32 v208, v208
    v_mfma_f32_16x16x32_bf16 v[200:203], a[140:143], a[76:79], v[200:203]
    v_cvt_pk_bf16_f32 v179, v218, v219
    v_fma_f32 v209, v209, s21, v238
    v_mfma_f32_16x16x32_bf16 v[200:203], a[136:139], a[72:75], v[200:203]
    v_exp_f32 v209, v209
    v_mfma_f32_16x16x32_bf16 v[196:199], a[136:139], a[40:43], v[196:199]
    ds_read_b128 a[132:135], v227 offset:2048
    v_fma_f32 v210, v210, s21, v238
    v_mfma_f32_16x16x32_bf16 v[196:199], a[140:143], a[44:47], v[196:199]
    v_exp_f32 v210, v210
    v_mfma_f32_16x16x32_bf16 v[192:195], a[140:143], a[12:15], v[192:195]
    v_cvt_pk_bf16_f32 v162, v208, v209
    v_fma_f32 v211, v211, s21, v238
    v_mfma_f32_16x16x32_bf16 v[192:195], a[136:139], a[8:11], v[192:195]
    s_waitcnt lgkmcnt(2)
    v_exp_f32 v211, v211
    v_smfmac_f32_16x16x64_bf16 a[196:199], a[208:211], v[136:143], v254
    buffer_load_dwordx4 v235, s[12:15], s34 offen offset:3072 nt lds
    v_mfma_f32_16x16x32_bf16 v[192:195], a[144:147], a[16:19], v[192:195]
    s_add_u32 m0, s23, 0x18000
    ds_read_b128 a[136:139], v226 offset:6144
    v_fma_f32 v212, v212, s21, v239
    v_mfma_f32_16x16x32_bf16 v[192:195], a[148:151], a[20:23], v[192:195]
    s_xor_b32 s34, s30, 0x4000
    v_exp_f32 v212, v212
    v_mfma_f32_16x16x32_bf16 v[196:199], a[148:151], a[52:55], v[196:199]
    v_cvt_pk_bf16_f32 v163, v210, v211
    v_fma_f32 v213, v213, s21, v239
    v_mfma_f32_16x16x32_bf16 v[196:199], a[144:147], a[48:51], v[196:199]
    v_exp_f32 v213, v213
    v_mfma_f32_16x16x32_bf16 v[200:203], a[144:147], a[80:83], v[200:203]
    ds_read_b128 a[140:143], v227 offset:6144
    v_fma_f32 v214, v214, s21, v239
    v_mfma_f32_16x16x32_bf16 v[200:203], a[148:151], a[84:87], v[200:203]
    buffer_load_dwordx4 v232, s[4:7], s34 offen nt lds
    v_exp_f32 v214, v214
    v_mfma_f32_16x16x32_bf16 v[204:207], a[148:151], a[116:119], v[204:207]
    v_cvt_pk_bf16_f32 v170, v212, v213
    v_fma_f32 v215, v215, s21, v239
    v_mfma_f32_16x16x32_bf16 v[204:207], a[144:147], a[112:115], v[204:207]
    v_exp_f32 v215, v215
    v_mfma_f32_16x16x32_bf16 v[204:207], a[152:155], a[120:123], v[204:207]
    ds_read_b128 a[144:147], v226 offset:10240
    v_fma_f32 v220, v220, s21, v241
    v_mfma_f32_16x16x32_bf16 v[204:207], a[156:159], a[124:127], v[204:207]
    v_exp_f32 v220, v220
    v_mfma_f32_16x16x32_bf16 v[200:203], a[156:159], a[92:95], v[200:203]
    v_cvt_pk_bf16_f32 v171, v214, v215
    v_fma_f32 v221, v221, s21, v241
    v_mfma_f32_16x16x32_bf16 v[200:203], a[152:155], a[88:91], v[200:203]
    buffer_load_dwordx4 v233, s[4:7], s34 offen offset:1024 nt lds
    v_exp_f32 v221, v221
    v_mfma_f32_16x16x32_bf16 v[196:199], a[152:155], a[56:59], v[196:199]
    ds_read_b128 a[148:151], v227 offset:10240
    v_fma_f32 v222, v222, s21, v241
    v_mfma_f32_16x16x32_bf16 v[196:199], a[156:159], a[60:63], v[196:199]
    v_exp_f32 v222, v222
    v_mfma_f32_16x16x32_bf16 v[192:195], a[156:159], a[28:31], v[192:195]
    v_cvt_pk_bf16_f32 v186, v220, v221
    v_fma_f32 v223, v223, s21, v241
    v_mfma_f32_16x16x32_bf16 v[192:195], a[152:155], a[24:27], v[192:195]
    s_waitcnt lgkmcnt(2)
    v_exp_f32 v223, v223
    v_mfma_f32_16x16x32_bf16 v[208:211], a[128:131], a[0:3], 0
    s_add_u32 m0, s23, 0x18000
    ds_read_b128 a[152:155], v226 offset:14336
    v_fma_f32 v200, v200, s21, v240
    v_mfma_f32_16x16x32_bf16 v[208:211], a[132:135], a[4:7], v[208:211]
    s_xor_b32 s34, s30, 0x4000
    v_exp_f32 v200, v200
    v_mfma_f32_16x16x32_bf16 v[212:215], a[132:135], a[36:39], 0
    v_cvt_pk_bf16_f32 v187, v222, v223
    v_fma_f32 v201, v201, s21, v240
    v_mfma_f32_16x16x32_bf16 v[212:215], a[128:131], a[32:35], v[212:215]
    v_exp_f32 v201, v201
    v_mfma_f32_16x16x32_bf16 v[216:219], a[128:131], a[64:67], 0
    ds_read_b128 a[156:159], v227 offset:14336
    v_fma_f32 v202, v202, s21, v240
    v_mfma_f32_16x16x32_bf16 v[216:219], a[132:135], a[68:71], v[216:219]
    buffer_load_dwordx4 v234, s[4:7], s34 offen offset:2048 nt lds
    v_exp_f32 v202, v202
    v_mfma_f32_16x16x32_bf16 v[220:223], a[132:135], a[100:103], 0
    v_cvt_pk_bf16_f32 v180, v200, v201
    v_fma_f32 v203, v203, s21, v240
    v_mfma_f32_16x16x32_bf16 v[220:223], a[128:131], a[96:99], v[220:223]
    v_exp_f32 v203, v203
    v_mfma_f32_16x16x32_bf16 v[220:223], a[136:139], a[104:107], v[220:223]
    v_fma_f32 v192, v192, s21, v238
    v_xor_b32 v230, 0x60, v230
    v_mfma_f32_16x16x32_bf16 v[220:223], a[140:143], a[108:111], v[220:223]
    v_exp_f32 v192, v192
    v_mfma_f32_16x16x32_bf16 v[216:219], a[140:143], a[76:79], v[216:219]
    v_cvt_pk_bf16_f32 v181, v202, v203
    v_fma_f32 v193, v193, s21, v238
    v_mfma_f32_16x16x32_bf16 v[216:219], a[136:139], a[72:75], v[216:219]
    v_exp_f32 v193, v193
    v_mfma_f32_16x16x32_bf16 v[212:215], a[136:139], a[40:43], v[212:215]
    v_fma_f32 v194, v194, s21, v238
    v_xor_b32 v231, 0x60, v231
    v_mfma_f32_16x16x32_bf16 v[212:215], a[140:143], a[44:47], v[212:215]
    v_exp_f32 v194, v194
    v_mfma_f32_16x16x32_bf16 v[208:211], a[140:143], a[12:15], v[208:211]
    v_cvt_pk_bf16_f32 v164, v192, v193
    v_fma_f32 v195, v195, s21, v238
    v_mfma_f32_16x16x32_bf16 v[208:211], a[136:139], a[8:11], v[208:211]
    s_waitcnt vmcnt(9) lgkmcnt(0)
    v_exp_f32 v195, v195
    v_smfmac_f32_16x16x64_bf16 a[204:207], a[208:211], v[152:159], v254
    s_barrier
    buffer_load_dwordx4 v235, s[4:7], s34 offen offset:3072 nt lds
    v_mfma_f32_16x16x32_bf16 v[208:211], a[144:147], a[16:19], v[208:211]
    s_add_u32 m0, s23, 0x10000
    ds_read_b64_tr_b16 a[128:129], v230 offset:0
    v_fma_f32 v196, v196, s21, v239
    v_mfma_f32_16x16x32_bf16 v[208:211], a[148:151], a[20:23], v[208:211]
    ds_read_b64_tr_b16 a[130:131], v230 offset:2048
    v_exp_f32 v196, v196
    v_mfma_f32_16x16x32_bf16 v[212:215], a[148:151], a[52:55], v[212:215]
    s_add_u32 s34, s41, 0x10000
    ds_read_b64_tr_b16 a[132:133], v230 offset:4096
    v_cvt_pk_bf16_f32 v165, v194, v195
    v_fma_f32 v197, v197, s21, v239
    v_mfma_f32_16x16x32_bf16 v[212:215], a[144:147], a[48:51], v[212:215]
    ds_read_b64_tr_b16 a[134:135], v230 offset:6144
    v_exp_f32 v197, v197
    v_mfma_f32_16x16x32_bf16 v[216:219], a[144:147], a[80:83], v[216:219]
    ds_read_b64_tr_b16 a[136:137], v230 offset:8192
    v_fma_f32 v198, v198, s21, v239
    v_mfma_f32_16x16x32_bf16 v[216:219], a[148:151], a[84:87], v[216:219]
    ds_read_b64_tr_b16 a[138:139], v230 offset:10240
    v_exp_f32 v198, v198
    v_mfma_f32_16x16x32_bf16 v[220:223], a[148:151], a[116:119], v[220:223]
    ds_read_b64_tr_b16 a[140:141], v230 offset:12288
    v_cvt_pk_bf16_f32 v172, v196, v197
    v_fma_f32 v199, v199, s21, v239
    v_mfma_f32_16x16x32_bf16 v[220:223], a[144:147], a[112:115], v[220:223]
    ds_read_b64_tr_b16 a[142:143], v230 offset:14336
    v_exp_f32 v199, v199
    v_mfma_f32_16x16x32_bf16 v[220:223], a[152:155], a[120:123], v[220:223]
    ds_read_b64_tr_b16 a[144:145], v230 offset:16384
    v_fma_f32 v204, v204, s21, v241
    v_mfma_f32_16x16x32_bf16 v[220:223], a[156:159], a[124:127], v[220:223]
    ds_read_b64_tr_b16 a[146:147], v230 offset:18432
    buffer_load_dwordx4 v232, s[12:15], s34 offen nt lds
    v_exp_f32 v204, v204
    v_mfma_f32_16x16x32_bf16 v[216:219], a[156:159], a[92:95], v[216:219]
    v_cvt_pk_bf16_f32 v173, v198, v199
    v_fma_f32 v205, v205, s21, v241
    v_mfma_f32_16x16x32_bf16 v[216:219], a[152:155], a[88:91], v[216:219]
    v_exp_f32 v205, v205
    v_mfma_f32_16x16x32_bf16 v[212:215], a[152:155], a[56:59], v[212:215]
    ds_read_b64_tr_b16 a[148:149], v230 offset:20480
    v_fma_f32 v206, v206, s21, v241
    v_mfma_f32_16x16x32_bf16 v[212:215], a[156:159], a[60:63], v[212:215]
    ds_read_b64_tr_b16 a[150:151], v230 offset:22528
    v_exp_f32 v206, v206
    v_mfma_f32_16x16x32_bf16 v[208:211], a[156:159], a[28:31], v[208:211]
    v_cvt_pk_bf16_f32 v188, v204, v205
    v_fma_f32 v207, v207, s21, v241
    v_mfma_f32_16x16x32_bf16 v[208:211], a[152:155], a[24:27], v[208:211]
    s_waitcnt lgkmcnt(4)
    v_exp_f32 v207, v207
    v_mfma_f32_16x16x32_bf16 v[192:195], a[128:131], v[0:3], 0
    ds_read_b64_tr_b16 a[152:153], v230 offset:24576
    v_fma_f32 v216, v216, s21, v240
    v_mfma_f32_16x16x32_bf16 v[192:195], a[132:135], v[4:7], v[192:195]
    v_fma_f32 v217, v217, s21, v240
    v_exp_f32 v216, v216
    v_mfma_f32_16x16x32_bf16 v[196:199], a[132:135], v[12:15], 0
    ds_read_b64_tr_b16 a[154:155], v230 offset:26624
    v_cvt_pk_bf16_f32 v189, v206, v207
    v_mfma_f32_16x16x32_bf16 v[196:199], a[128:131], v[8:11], v[196:199]
    v_exp_f32 v217, v217
    v_mfma_f32_16x16x32_bf16 v[200:203], a[128:131], v[16:19], 0
    ds_read_b64_tr_b16 a[156:157], v230 offset:28672
    v_fma_f32 v218, v218, s21, v240
    v_mfma_f32_16x16x32_bf16 v[200:203], a[132:135], v[20:23], v[200:203]
    buffer_load_dwordx4 v233, s[12:15], s34 offen offset:1024 nt lds
    v_mfma_f32_16x16x32_bf16 v[204:207], a[132:135], v[28:31], 0
    ds_read_b64_tr_b16 a[158:159], v230 offset:30720
    v_fma_f32 v219, v219, s21, v240
    v_mfma_f32_16x16x32_bf16 v[204:207], a[128:131], v[24:27], v[204:207]
    v_exp_f32 v218, v218
    v_mfma_f32_16x16x32_bf16 v[204:207], a[136:139], v[56:59], v[204:207]
    ds_read_b64_tr_b16 a[128:129], v230 offset:32768
    v_mfma_f32_16x16x32_bf16 v[204:207], a[140:143], v[60:63], v[204:207]
    v_exp_f32 v219, v219
    v_cvt_pk_bf16_f32 v182, v216, v217
    v_mfma_f32_16x16x32_bf16 v[200:203], a[140:143], v[52:55], v[200:203]
    ds_read_b64_tr_b16 a[130:131], v230 offset:34816
    v_cvt_pk_bf16_f32 v183, v218, v219
    v_mfma_f32_16x16x32_bf16 v[200:203], a[136:139], v[48:51], v[200:203]
    buffer_load_dwordx4 v234, s[12:15], s34 offen offset:2048 nt lds
    v_fma_f32 v208, v208, s21, v238
    v_mfma_f32_16x16x32_bf16 v[196:199], a[136:139], v[40:43], v[196:199]
    ds_read_b64_tr_b16 a[132:133], v230 offset:36864
    v_fma_f32 v209, v209, s21, v238
    v_mfma_f32_16x16x32_bf16 v[196:199], a[140:143], v[44:47], v[196:199]
    v_exp_f32 v208, v208
    v_mfma_f32_16x16x32_bf16 v[192:195], a[140:143], v[36:39], v[192:195]
    ds_read_b64_tr_b16 a[134:135], v230 offset:38912
    v_mfma_f32_16x16x32_bf16 v[192:195], a[136:139], v[32:35], v[192:195]
    s_waitcnt lgkmcnt(4)
    v_exp_f32 v209, v209
    v_smfmac_f32_16x16x64_bf16 a[200:203], a[208:211], v[176:183], v254
    v_fma_f32 v210, v210, s21, v238
    v_mfma_f32_16x16x32_bf16 v[192:195], a[144:147], v[64:67], v[192:195]
    ds_read_b64_tr_b16 a[136:137], v230 offset:40960
    v_fma_f32 v211, v211, s21, v238
    v_mfma_f32_16x16x32_bf16 v[192:195], a[148:151], v[68:71], v[192:195]
    v_exp_f32 v210, v210
    v_mfma_f32_16x16x32_bf16 v[196:199], a[148:151], v[76:79], v[196:199]
    ds_read_b64_tr_b16 a[138:139], v230 offset:43008
    v_exp_f32 v211, v211
    v_mfma_f32_16x16x32_bf16 v[196:199], a[144:147], v[72:75], v[196:199]
    v_cvt_pk_bf16_f32 v166, v208, v209
    v_cvt_pk_bf16_f32 v167, v210, v211
    v_mfma_f32_16x16x32_bf16 v[200:203], a[144:147], v[80:83], v[200:203]
    ds_read_b64_tr_b16 a[140:141], v230 offset:45056
    v_fma_f32 v212, v212, s21, v239
    v_mfma_f32_16x16x32_bf16 v[200:203], a[148:151], v[84:87], v[200:203]
    v_fma_f32 v213, v213, s21, v239
    v_exp_f32 v212, v212
    v_mfma_f32_16x16x32_bf16 v[204:207], a[148:151], v[92:95], v[204:207]
    ds_read_b64_tr_b16 a[142:143], v230 offset:47104
    v_xor_b32 v230, 32, v230
    v_mfma_f32_16x16x32_bf16 v[204:207], a[144:147], v[88:91], v[204:207]
    v_exp_f32 v213, v213
    v_smfmac_f32_16x16x64_bf16 a[192:195], a[208:211], v[160:167], v254
    v_xor_b32 v231, 32, v231
    v_fma_f32 v214, v214, s21, v239
    v_mfma_f32_16x16x32_bf16 v[204:207], a[152:155], v[120:123], v[204:207]
    ds_read_b64_tr_b16 a[144:145], v230 offset:0
    v_fma_f32 v215, v215, s21, v239
    v_mfma_f32_16x16x32_bf16 v[204:207], a[156:159], v[124:127], v[204:207]
    v_exp_f32 v214, v214
    v_mfma_f32_16x16x32_bf16 v[200:203], a[156:159], v[116:119], v[200:203]
    ds_read_b64_tr_b16 a[146:147], v230 offset:2048
    buffer_load_dwordx4 v235, s[12:15], s34 offen offset:3072 nt lds
    v_mfma_f32_16x16x32_bf16 v[200:203], a[152:155], v[112:115], v[200:203]
    v_exp_f32 v215, v215
    v_cvt_pk_bf16_f32 v174, v212, v213
    v_mfma_f32_16x16x32_bf16 v[196:199], a[152:155], v[104:107], v[196:199]
    ds_read_b64_tr_b16 a[148:149], v230 offset:4096
    v_cvt_pk_bf16_f32 v175, v214, v215
    v_mfma_f32_16x16x32_bf16 v[196:199], a[156:159], v[108:111], v[196:199]
    v_fma_f32 v220, v220, s21, v241
    v_fma_f32 v221, v221, s21, v241
    v_mfma_f32_16x16x32_bf16 v[192:195], a[156:159], v[100:103], v[192:195]
    ds_read_b64_tr_b16 a[150:151], v230 offset:6144
    v_exp_f32 v220, v220
    v_mfma_f32_16x16x32_bf16 v[192:195], a[152:155], v[96:99], v[192:195]
    s_waitcnt lgkmcnt(4)
    v_exp_f32 v221, v221
    v_smfmac_f32_16x16x64_bf16 a[196:199], a[208:211], v[168:175], v254
    v_fma_f32 v222, v222, s21, v241
    v_mfma_f32_16x16x32_bf16 v[192:195], a[128:131], v[128:131], v[192:195]
    ds_read_b64_tr_b16 a[152:153], v230 offset:8192
    v_fma_f32 v223, v223, s21, v241
    v_mfma_f32_16x16x32_bf16 v[192:195], a[132:135], v[132:135], v[192:195]
    v_exp_f32 v222, v222
    v_mfma_f32_16x16x32_bf16 v[196:199], a[132:135], v[140:143], v[196:199]
    ds_read_b64_tr_b16 a[154:155], v230 offset:10240
    v_mfma_f32_16x16x32_bf16 v[196:199], a[128:131], v[136:139], v[196:199]
    v_exp_f32 v223, v223
    v_mfma_f32_16x16x32_bf16 v[200:203], a[128:131], v[144:147], v[200:203]
    ds_read_b64_tr_b16 a[156:157], v230 offset:12288
    v_cvt_pk_bf16_f32 v190, v220, v221
    v_mfma_f32_16x16x32_bf16 v[200:203], a[132:135], v[148:151], v[200:203]
    v_cvt_pk_bf16_f32 v191, v222, v223
    v_mfma_f32_16x16x32_bf16 v[204:207], a[132:135], v[156:159], v[204:207]
    ds_read_b64_tr_b16 a[158:159], v230 offset:14336
    v_accvgpr_read_b32 v248, a200
    v_mfma_f32_16x16x32_bf16 v[204:207], a[128:131], v[152:155], v[204:207]
    v_accvgpr_read_b32 v244, a201
    v_add_f32 v248, v248, v244
    v_accvgpr_read_b32 v246, a192
    v_accvgpr_read_b32 v242, a193
    v_add_f32 v246, v246, v242
    v_smfmac_f32_16x16x64_bf16 a[204:207], a[208:211], v[184:191], v254
    v_rcp_f32 v244, v248
    v_rcp_f32 v242, v246
    v_mfma_f32_16x16x32_bf16 v[204:207], a[136:139], v[184:187], v[204:207]
    s_add_u32 m0, s23, 0x1c000
    ds_read_b64_tr_b16 a[128:129], v230 offset:16384
    v_accvgpr_read_b32 v247, a196
    v_mfma_f32_16x16x32_bf16 v[204:207], a[140:143], v[188:191], v[204:207]
    v_accvgpr_read_b32 v243, a197
    v_add_f32 v247, v247, v243
    v_rcp_f32 v243, v247
    v_max3_f32 v250, v246, v247, v248
    v_mfma_f32_16x16x32_bf16 v[200:203], a[140:143], v[180:183], v[200:203]
    s_xor_b32 s34, s30, 0x4080
    ds_read_b64_tr_b16 a[130:131], v230 offset:18432
    v_max3_f32 v246, v242, v243, v244
    v_mfma_f32_16x16x32_bf16 v[200:203], a[136:139], v[176:179], v[200:203]
    v_accvgpr_read_b32 v249, a204
    v_accvgpr_read_b32 v245, a205
    v_mfma_f32_16x16x32_bf16 v[196:199], a[136:139], v[168:171], v[196:199]
    ds_read_b64_tr_b16 a[132:133], v230 offset:20480
    v_add_f32 v249, v249, v245
    v_mfma_f32_16x16x32_bf16 v[196:199], a[140:143], v[172:175], v[196:199]
    v_rcp_f32 v245, v249
    v_max_f32 v250, v250, v249
    v_mul_f32 v250, s22, v250
    v_max3_f32 v246, v246, v245, v250
    v_mfma_f32_16x16x32_bf16 v[192:195], a[140:143], v[164:167], v[192:195]
    ds_read_b64_tr_b16 a[134:135], v230 offset:22528
    v_cmp_lt_f32 vcc, 4.0, v246
    v_mfma_f32_16x16x32_bf16 v[192:195], a[136:139], v[160:163], v[192:195]
    s_waitcnt lgkmcnt(4)
    s_cbranch_vccnz L_slow
L_back_mid:
    v_mfma_f32_16x16x32_bf16 v[208:211], a[144:147], v[0:3], 0
L_hop4:
    s_cbranch_execz L_hopret1
    ds_read_b64_tr_b16 a[136:137], v230 offset:24576
    v_mfma_f32_16x16x32_bf16 v[208:211], a[148:151], v[4:7], v[208:211]
    s_waitcnt vmcnt(12)
    ds_read_b128 a[24:27], v228 offset:49152
    buffer_load_dwordx4 v232, s[4:7], s34 offen nt lds
    v_mfma_f32_16x16x32_bf16 v[212:215], a[148:151], v[12:15], 0
    ds_read_b64_tr_b16 a[138:139], v230 offset:26624
    v_mfma_f32_16x16x32_bf16 v[212:215], a[144:147], v[8:11], v[212:215]
    ds_read_b128 a[28:31], v229 offset:49152
    v_mfma_f32_16x16x32_bf16 v[216:219], a[144:147], v[16:19], 0
    ds_read_b64_tr_b16 a[140:141], v230 offset:28672
    v_xor_b32 v236, 0x60, v236
    v_mfma_f32_16x16x32_bf16 v[216:219], a[148:151], v[20:23], v[216:219]
    v_mul_f32 v200, v244, v200
    v_mul_f32 v201, v244, v201
    v_mfma_f32_16x16x32_bf16 v[220:223], a[148:151], v[28:31], 0
    ds_read_b64_tr_b16 a[142:143], v230 offset:30720
    v_cvt_pk_bf16_f32 v200, v200, v201
    v_mfma_f32_16x16x32_bf16 v[220:223], a[144:147], v[24:27], v[220:223]
    ds_write_b32 v236, v200 offset:16384
    v_mfma_f32_16x16x32_bf16 v[220:223], a[152:155], v[56:59], v[220:223]
    ds_read_b64_tr_b16 a[144:145], v230 offset:32768
    v_mfma_f32_16x16x32_bf16 v[220:223], a[156:159], v[60:63], v[220:223]
    v_mul_f32 v202, v244, v202
    v_mul_f32 v203, v244, v203
    v_mfma_f32_16x16x32_bf16 v[216:219], a[156:159], v[52:55], v[216:219]
    ds_read_b64_tr_b16 a[146:147], v230 offset:34816
    v_cvt_pk_bf16_f32 v202, v202, v203
    v_mfma_f32_16x16x32_bf16 v[216:219], a[152:155], v[48:51], v[216:219]
    ds_write_b32 v236, v202 offset:16388
    v_mfma_f32_16x16x32_bf16 v[212:215], a[152:155], v[40:43], v[212:215]
    ds_read_b64_tr_b16 a[148:149], v230 offset:36864
    v_mfma_f32_16x16x32_bf16 v[212:215], a[156:159], v[44:47], v[212:215]
    ds_read_b128 a[16:19], v228 offset:32768
    buffer_load_dwordx4 v233, s[4:7], s34 offen offset:1024 nt lds
    v_mfma_f32_16x16x32_bf16 v[208:211], a[156:159], v[36:39], v[208:211]
    ds_read_b64_tr_b16 a[150:151], v230 offset:38912
    v_mfma_f32_16x16x32_bf16 v[208:211], a[152:155], v[32:35], v[208:211]
    s_waitcnt lgkmcnt(7)
    ds_read_b128 a[20:23], v229 offset:32768
    v_mul_f32 v192, v242, v192
    v_mfma_f32_16x16x32_bf16 v[208:211], a[128:131], v[64:67], v[208:211]
    ds_read_b64_tr_b16 a[152:153], v230 offset:40960
    v_mul_f32 v193, v242, v193
    v_cvt_pk_bf16_f32 v192, v192, v193
    v_mfma_f32_16x16x32_bf16 v[208:211], a[132:135], v[68:71], v[208:211]
    ds_write_b32 v236, v192 offset:0
    v_mfma_f32_16x16x32_bf16 v[212:215], a[132:135], v[76:79], v[212:215]
    ds_read_b64_tr_b16 a[154:155], v230 offset:43008
    v_mfma_f32_16x16x32_bf16 v[212:215], a[128:131], v[72:75], v[212:215]
    v_mul_f32 v194, v242, v194
    v_mul_f32 v195, v242, v195
    v_mfma_f32_16x16x32_bf16 v[216:219], a[128:131], v[80:83], v[216:219]
    ds_read_b64_tr_b16 a[156:157], v230 offset:45056
    v_cvt_pk_bf16_f32 v194, v194, v195
    v_mfma_f32_16x16x32_bf16 v[216:219], a[132:135], v[84:87], v[216:219]
    ds_write_b32 v236, v194 offset:4
    v_mfma_f32_16x16x32_bf16 v[220:223], a[132:135], v[92:95], v[220:223]
    ds_read_b64_tr_b16 a[158:159], v230 offset:47104
    v_xor_b32 v230, 0x60, v230
    v_mfma_f32_16x16x32_bf16 v[220:223], a[128:131], v[88:91], v[220:223]
    ds_read_b128 a[48:51], v228 offset:34816
    v_xor_b32 v231, 0x60, v231
    v_mfma_f32_16x16x32_bf16 v[220:223], a[136:139], v[120:123], v[220:223]
    ds_read_b64_tr_b16 a[128:129], v230 offset:0
    v_mfma_f32_16x16x32_bf16 v[220:223], a[140:143], v[124:127], v[220:223]
    ds_read_b128 a[52:55], v229 offset:34816
    v_mul_f32 v196, v243, v196
    v_mfma_f32_16x16x32_bf16 v[216:219], a[140:143], v[116:119], v[216:219]
    ds_read_b64_tr_b16 a[130:131], v230 offset:2048
    v_mul_f32 v197, v243, v197
    v_mfma_f32_16x16x32_bf16 v[216:219], a[136:139], v[112:115], v[216:219]
    buffer_load_dwordx4 v234, s[4:7], s34 offen offset:2048 nt lds
    v_mfma_f32_16x16x32_bf16 v[212:215], a[136:139], v[104:107], v[212:215]
    ds_read_b64_tr_b16 a[132:133], v230 offset:4096
    v_cvt_pk_bf16_f32 v196, v196, v197
    v_mfma_f32_16x16x32_bf16 v[212:215], a[140:143], v[108:111], v[212:215]
    ds_write_b32 v236, v196 offset:2048
    v_mfma_f32_16x16x32_bf16 v[208:211], a[140:143], v[100:103], v[208:211]
    ds_read_b64_tr_b16 a[134:135], v230 offset:6144
    v_mfma_f32_16x16x32_bf16 v[208:211], a[136:139], v[96:99], v[208:211]
    s_waitcnt lgkmcnt(7)
    v_mul_f32 v198, v243, v198
    v_mfma_f32_16x16x32_bf16 v[208:211], a[144:147], v[128:131], v[208:211]
    ds_read_b64_tr_b16 a[136:137], v230 offset:8192
    v_mul_f32 v199, v243, v199
    v_mfma_f32_16x16x32_bf16 v[208:211], a[148:151], v[132:135], v[208:211]
    s_waitcnt vmcnt(7)
    ds_read_b128 a[64:67], v228 offset:0
    v_mfma_f32_16x16x32_bf16 v[212:215], a[148:151], v[140:143], v[212:215]
    ds_read_b64_tr_b16 a[138:139], v230 offset:10240
    v_cvt_pk_bf16_f32 v198, v198, v199
    v_mfma_f32_16x16x32_bf16 v[212:215], a[144:147], v[136:139], v[212:215]
    ds_write_b32 v236, v198 offset:2052
    v_mfma_f32_16x16x32_bf16 v[216:219], a[144:147], v[144:147], v[216:219]
    ds_read_b64_tr_b16 a[140:141], v230 offset:12288
    v_mfma_f32_16x16x32_bf16 v[216:219], a[148:151], v[148:151], v[216:219]
    ds_read_b128 a[56:59], v228 offset:51200
    v_mfma_f32_16x16x32_bf16 v[220:223], a[148:151], v[156:159], v[220:223]
    ds_read_b64_tr_b16 a[142:143], v230 offset:14336
    v_mfma_f32_16x16x32_bf16 v[220:223], a[144:147], v[152:155], v[220:223]
    ds_read_b128 a[60:63], v229 offset:51200
    v_mul_f32 v204, v245, v204
    v_mfma_f32_16x16x32_bf16 v[220:223], a[152:155], v[184:187], v[220:223]
    ds_read_b64_tr_b16 a[144:145], v230 offset:16384
    v_mul_f32 v205, v245, v205
    v_mfma_f32_16x16x32_bf16 v[220:223], a[156:159], v[188:191], v[220:223]
    ds_read_b128 a[68:71], v229 offset:0
    buffer_load_dwordx4 v235, s[4:7], s34 offen offset:3072 nt lds
    v_mfma_f32_16x16x32_bf16 v[216:219], a[156:159], v[180:183], v[216:219]
    ds_read_b64_tr_b16 a[146:147], v230 offset:18432
    v_cvt_pk_bf16_f32 v204, v204, v205
    v_mfma_f32_16x16x32_bf16 v[216:219], a[152:155], v[176:179], v[216:219]
    ds_read_b128 a[96:99], v228 offset:2048
    ds_write_b32 v236, v204 offset:18432
    v_mfma_f32_16x16x32_bf16 v[212:215], a[152:155], v[168:171], v[212:215]
    ds_read_b64_tr_b16 a[148:149], v230 offset:20480
    v_mul_f32 v206, v245, v206
    v_mfma_f32_16x16x32_bf16 v[212:215], a[156:159], v[172:175], v[212:215]
    ds_read_b128 a[100:103], v229 offset:2048
    v_mul_f32 v207, v245, v207
    v_mfma_f32_16x16x32_bf16 v[208:211], a[156:159], v[164:167], v[208:211]
    ds_read_b64_tr_b16 a[150:151], v230 offset:22528
    v_cvt_pk_bf16_f32 v206, v206, v207
    v_mfma_f32_16x16x32_bf16 v[208:211], a[152:155], v[160:163], v[208:211]
    s_waitcnt lgkmcnt(9)
    ds_write_b32 v236, v206 offset:18436
    v_mfma_f32_16x16x32_bf16 v[192:195], a[128:131], v[0:3], 0
    ds_read_b64_tr_b16 a[152:153], v230 offset:24576
    v_xor_b32 v236, 32, v236
    v_mfma_f32_16x16x32_bf16 v[192:195], a[132:135], v[4:7], v[192:195]
    v_mfma_f32_16x16x32_bf16 v[196:199], a[132:135], v[12:15], 0
    ds_read_b64_tr_b16 a[154:155], v230 offset:26624
    v_mul_f32 v216, v244, v216
    v_mfma_f32_16x16x32_bf16 v[196:199], a[128:131], v[8:11], v[196:199]
    v_accvgpr_mov_b32 a0, a160
    v_accvgpr_mov_b32 a1, a161
    v_mfma_f32_16x16x32_bf16 v[200:203], a[128:131], v[16:19], 0
    ds_read_b64_tr_b16 a[156:157], v230 offset:28672
    v_mul_f32 v217, v244, v217
    v_mfma_f32_16x16x32_bf16 v[200:203], a[132:135], v[20:23], v[200:203]
    v_mfma_f32_16x16x32_bf16 v[204:207], a[132:135], v[28:31], 0
    ds_read_b64_tr_b16 a[158:159], v230 offset:30720
    v_cvt_pk_bf16_f32 v216, v216, v217
    v_mfma_f32_16x16x32_bf16 v[204:207], a[128:131], v[24:27], v[204:207]
    ds_write_b32 v236, v216 offset:16384
    v_mfma_f32_16x16x32_bf16 v[204:207], a[136:139], v[56:59], v[204:207]
    ds_read_b64_tr_b16 a[128:129], v230 offset:32768
    v_mul_f32 v218, v244, v218
    v_mfma_f32_16x16x32_bf16 v[204:207], a[140:143], v[60:63], v[204:207]
    v_accvgpr_mov_b32 a2, a162
    v_accvgpr_mov_b32 a3, a163
    v_mfma_f32_16x16x32_bf16 v[200:203], a[140:143], v[52:55], v[200:203]
    ds_read_b64_tr_b16 a[130:131], v230 offset:34816
    v_mul_f32 v219, v244, v219
    v_mfma_f32_16x16x32_bf16 v[200:203], a[136:139], v[48:51], v[200:203]
    v_mfma_f32_16x16x32_bf16 v[196:199], a[136:139], v[40:43], v[196:199]
    ds_read_b64_tr_b16 a[132:133], v230 offset:36864
    v_cvt_pk_bf16_f32 v218, v218, v219
    v_mfma_f32_16x16x32_bf16 v[196:199], a[140:143], v[44:47], v[196:199]
    ds_write_b32 v236, v218 offset:16388
    v_mfma_f32_16x16x32_bf16 v[192:195], a[140:143], v[36:39], v[192:195]
    ds_read_b64_tr_b16 a[134:135], v230 offset:38912
    v_mul_f32 v208, v242, v208
    v_mfma_f32_16x16x32_bf16 v[192:195], a[136:139], v[32:35], v[192:195]
    s_waitcnt lgkmcnt(6)
    v_mul_f32 v209, v242, v209
    v_accvgpr_mov_b32 a4, a164
    v_mfma_f32_16x16x32_bf16 v[192:195], a[144:147], v[64:67], v[192:195]
    ds_read_b64_tr_b16 a[136:137], v230 offset:40960
    v_cvt_pk_bf16_f32 v208, v208, v209
    v_mfma_f32_16x16x32_bf16 v[192:195], a[148:151], v[68:71], v[192:195]
    ds_write_b32 v236, v208 offset:0
    v_mfma_f32_16x16x32_bf16 v[196:199], a[148:151], v[76:79], v[196:199]
    ds_read_b64_tr_b16 a[138:139], v230 offset:43008
    v_mul_f32 v210, v242, v210
    v_mfma_f32_16x16x32_bf16 v[196:199], a[144:147], v[72:75], v[196:199]
    v_accvgpr_mov_b32 a5, a165
    v_accvgpr_mov_b32 a6, a166
    v_mfma_f32_16x16x32_bf16 v[200:203], a[144:147], v[80:83], v[200:203]
    ds_read_b64_tr_b16 a[140:141], v230 offset:45056
    v_mul_f32 v211, v242, v211
    v_mfma_f32_16x16x32_bf16 v[200:203], a[148:151], v[84:87], v[200:203]
    v_mfma_f32_16x16x32_bf16 v[204:207], a[148:151], v[92:95], v[204:207]
    ds_read_b64_tr_b16 a[142:143], v230 offset:47104
    v_xor_b32 v230, 32, v230
    v_mfma_f32_16x16x32_bf16 v[204:207], a[144:147], v[88:91], v[204:207]
    v_xor_b32 v231, 32, v231
    v_cvt_pk_bf16_f32 v210, v210, v211
    v_mfma_f32_16x16x32_bf16 v[204:207], a[152:155], v[120:123], v[204:207]
    s_add_u32 m0, s23, 0x18000
    ds_read_b64_tr_b16 a[144:145], v230 offset:0
    v_accvgpr_mov_b32 a7, a167
    v_mfma_f32_16x16x32_bf16 v[204:207], a[156:159], v[124:127], v[204:207]
    ds_write_b32 v236, v210 offset:4
    v_mfma_f32_16x16x32_bf16 v[200:203], a[156:159], v[116:119], v[200:203]
    s_xor_b32 s34, s30, 0x4100
    ds_read_b64_tr_b16 a[146:147], v230 offset:2048
    v_mul_f32 v212, v243, v212
    v_mfma_f32_16x16x32_bf16 v[200:203], a[152:155], v[112:115], v[200:203]
    v_mul_f32 v213, v243, v213
    v_accvgpr_mov_b32 a32, a168
    v_mfma_f32_16x16x32_bf16 v[196:199], a[152:155], v[104:107], v[196:199]
    ds_read_b64_tr_b16 a[148:149], v230 offset:4096
    v_cvt_pk_bf16_f32 v212, v212, v213
    v_mfma_f32_16x16x32_bf16 v[196:199], a[156:159], v[108:111], v[196:199]
    ds_write_b32 v236, v212 offset:2048
    v_mfma_f32_16x16x32_bf16 v[192:195], a[156:159], v[100:103], v[192:195]
    ds_read_b64_tr_b16 a[150:151], v230 offset:6144
    v_accvgpr_mov_b32 a33, a169
    v_mfma_f32_16x16x32_bf16 v[192:195], a[152:155], v[96:99], v[192:195]
    s_waitcnt lgkmcnt(6)
    v_mul_f32 v214, v243, v214
    v_accvgpr_mov_b32 a34, a170
    v_mfma_f32_16x16x32_bf16 v[192:195], a[128:131], v[128:131], v[192:195]
    ds_read_b64_tr_b16 a[152:153], v230 offset:8192
    v_mul_f32 v215, v243, v215
    v_mfma_f32_16x16x32_bf16 v[192:195], a[132:135], v[132:135], v[192:195]
    buffer_load_dwordx4 v232, s[4:7], s34 offen nt lds
    v_mfma_f32_16x16x32_bf16 v[196:199], a[132:135], v[140:143], v[196:199]
    ds_read_b64_tr_b16 a[154:155], v230 offset:10240
    v_cvt_pk_bf16_f32 v214, v214, v215
    v_mfma_f32_16x16x32_bf16 v[196:199], a[128:131], v[136:139], v[196:199]
    ds_write_b32 v236, v214 offset:2052
    v_mfma_f32_16x16x32_bf16 v[200:203], a[128:131], v[144:147], v[200:203]
    ds_read_b64_tr_b16 a[156:157], v230 offset:12288
    v_mul_f32 v220, v245, v220
    v_mfma_f32_16x16x32_bf16 v[200:203], a[132:135], v[148:151], v[200:203]
    v_accvgpr_mov_b32 a35, a171
    v_accvgpr_mov_b32 a36, a172
    v_mfma_f32_16x16x32_bf16 v[204:207], a[132:135], v[156:159], v[204:207]
    ds_read_b64_tr_b16 a[158:159], v230 offset:14336
    v_mul_f32 v221, v245, v221
    v_mfma_f32_16x16x32_bf16 v[204:207], a[128:131], v[152:155], v[204:207]
    v_accvgpr_mov_b32 a37, a173
    v_accvgpr_mov_b32 a38, a174
    v_mfma_f32_16x16x32_bf16 v[204:207], a[136:139], v[184:187], v[204:207]
    ds_read_b64_tr_b16 a[128:129], v230 offset:16384
    v_cvt_pk_bf16_f32 v220, v220, v221
    v_mfma_f32_16x16x32_bf16 v[204:207], a[140:143], v[188:191], v[204:207]
    ds_write_b32 v236, v220 offset:18432
    v_mfma_f32_16x16x32_bf16 v[200:203], a[140:143], v[180:183], v[200:203]
    ds_read_b64_tr_b16 a[130:131], v230 offset:18432
    v_mul_f32 v222, v245, v222
    v_mfma_f32_16x16x32_bf16 v[200:203], a[136:139], v[176:179], v[200:203]
    buffer_load_dwordx4 v233, s[4:7], s34 offen offset:1024 nt lds
    v_mfma_f32_16x16x32_bf16 v[196:199], a[136:139], v[168:171], v[196:199]
    ds_read_b64_tr_b16 a[132:133], v230 offset:20480
    v_mul_f32 v223, v245, v223
    v_mfma_f32_16x16x32_bf16 v[196:199], a[140:143], v[172:175], v[196:199]
    v_mfma_f32_16x16x32_bf16 v[192:195], a[140:143], v[164:167], v[192:195]
    ds_read_b64_tr_b16 a[134:135], v230 offset:22528
    v_cvt_pk_bf16_f32 v222, v222, v223
    v_mfma_f32_16x16x32_bf16 v[192:195], a[136:139], v[160:163], v[192:195]
    s_waitcnt lgkmcnt(5)
    ds_write_b32 v236, v222 offset:18436
    v_mfma_f32_16x16x32_bf16 v[208:211], a[144:147], v[0:3], 0
    ds_read_b64_tr_b16 a[136:137], v230 offset:24576
    v_xor_b32 v236, 0x60, v236
    v_mfma_f32_16x16x32_bf16 v[208:211], a[148:151], v[4:7], v[208:211]
    v_accvgpr_mov_b32 a39, a175
    v_accvgpr_mov_b32 a8, a176
    v_mfma_f32_16x16x32_bf16 v[212:215], a[148:151], v[12:15], 0
    ds_read_b64_tr_b16 a[138:139], v230 offset:26624
    v_mul_f32 v200, v244, v200
    v_mfma_f32_16x16x32_bf16 v[212:215], a[144:147], v[8:11], v[212:215]
    v_accvgpr_mov_b32 a9, a177
    v_accvgpr_mov_b32 a10, a178
    v_mfma_f32_16x16x32_bf16 v[216:219], a[144:147], v[16:19], 0
    ds_read_b64_tr_b16 a[140:141], v230 offset:28672
    v_mul_f32 v201, v244, v201
    v_mfma_f32_16x16x32_bf16 v[216:219], a[148:151], v[20:23], v[216:219]
    buffer_load_dwordx4 v234, s[4:7], s34 offen offset:2048 nt lds
    v_mfma_f32_16x16x32_bf16 v[220:223], a[148:151], v[28:31], 0
    ds_read_b64_tr_b16 a[142:143], v230 offset:30720
    v_cvt_pk_bf16_f32 v200, v200, v201
    v_mfma_f32_16x16x32_bf16 v[220:223], a[144:147], v[24:27], v[220:223]
    ds_write_b32 v236, v200 offset:16384
    v_mfma_f32_16x16x32_bf16 v[220:223], a[152:155], v[56:59], v[220:223]
    ds_read_b64_tr_b16 a[144:145], v230 offset:32768
    v_mul_f32 v202, v244, v202
    v_mfma_f32_16x16x32_bf16 v[220:223], a[156:159], v[60:63], v[220:223]
    v_mfma_f32_16x16x32_bf16 v[216:219], a[156:159], v[52:55], v[216:219]
    ds_read_b64_tr_b16 a[146:147], v230 offset:34816
    v_mul_f32 v203, v244, v203
    v_mfma_f32_16x16x32_bf16 v[216:219], a[152:155], v[48:51], v[216:219]
    v_accvgpr_mov_b32 a11, a179
    v_accvgpr_mov_b32 a12, a180
    v_mfma_f32_16x16x32_bf16 v[212:215], a[152:155], v[40:43], v[212:215]
    ds_read_b64_tr_b16 a[148:149], v230 offset:36864
    v_cvt_pk_bf16_f32 v202, v202, v203
    v_mfma_f32_16x16x32_bf16 v[212:215], a[156:159], v[44:47], v[212:215]
    ds_write_b32 v236, v202 offset:16388
    v_mfma_f32_16x16x32_bf16 v[208:211], a[156:159], v[36:39], v[208:211]
    ds_read_b64_tr_b16 a[150:151], v230 offset:38912
    v_mul_f32 v192, v242, v192
    v_mfma_f32_16x16x32_bf16 v[208:211], a[152:155], v[32:35], v[208:211]
    s_waitcnt lgkmcnt(6)
    v_mul_f32 v193, v242, v193
    v_accvgpr_mov_b32 a13, a181
    v_mfma_f32_16x16x32_bf16 v[208:211], a[128:131], v[64:67], v[208:211]
    ds_read_b64_tr_b16 a[152:153], v230 offset:40960
    v_cvt_pk_bf16_f32 v192, v192, v193
    v_mfma_f32_16x16x32_bf16 v[208:211], a[132:135], v[68:71], v[208:211]
    buffer_load_dwordx4 v235, s[4:7], s34 offen offset:3072 nt lds
    v_mfma_f32_16x16x32_bf16 v[212:215], a[132:135], v[76:79], v[212:215]
    ds_read_b64_tr_b16 a[154:155], v230 offset:43008
    v_accvgpr_mov_b32 a14, a182
    v_mfma_f32_16x16x32_bf16 v[212:215], a[128:131], v[72:75], v[212:215]
    ds_write_b32 v236, v192 offset:0
    v_mfma_f32_16x16x32_bf16 v[216:219], a[128:131], v[80:83], v[216:219]
    ds_read_b64_tr_b16 a[156:157], v230 offset:45056
    v_mul_f32 v194, v242, v194
    v_mfma_f32_16x16x32_bf16 v[216:219], a[132:135], v[84:87], v[216:219]
    v_mul_f32 v195, v242, v195
    v_accvgpr_mov_b32 a15, a183
    v_mfma_f32_16x16x32_bf16 v[220:223], a[132:135], v[92:95], v[220:223]
    ds_read_b64_tr_b16 a[158:159], v230 offset:47104
    v_xor_b32 v230, 0x60, v230
    v_mfma_f32_16x16x32_bf16 v[220:223], a[128:131], v[88:91], v[220:223]
    v_xor_b32 v231, 0x60, v231
    v_cvt_pk_bf16_f32 v194, v194, v195
    v_mfma_f32_16x16x32_bf16 v[220:223], a[136:139], v[120:123], v[220:223]
    ds_write_b32 v236, v194 offset:4
    v_mfma_f32_16x16x32_bf16 v[220:223], a[140:143], v[124:127], v[220:223]
    v_mul_f32 v196, v243, v196
    v_accvgpr_mov_b32 a40, a184
    v_mfma_f32_16x16x32_bf16 v[216:219], a[140:143], v[116:119], v[216:219]
    v_mfma_f32_16x16x32_bf16 v[216:219], a[136:139], v[112:115], v[216:219]
    v_mul_f32 v197, v243, v197
    v_cvt_pk_bf16_f32 v196, v196, v197
    v_mfma_f32_16x16x32_bf16 v[212:215], a[136:139], v[104:107], v[212:215]
    v_accvgpr_mov_b32 a41, a185
    v_accvgpr_mov_b32 a42, a186
    v_mfma_f32_16x16x32_bf16 v[212:215], a[140:143], v[108:111], v[212:215]
    ds_write_b32 v236, v196 offset:2048
    v_mfma_f32_16x16x32_bf16 v[208:211], a[140:143], v[100:103], v[208:211]
    v_mul_f32 v198, v243, v198
    v_mul_f32 v199, v243, v199
    v_mfma_f32_16x16x32_bf16 v[208:211], a[136:139], v[96:99], v[208:211]
    s_waitcnt vmcnt(8) lgkmcnt(2)
    s_barrier
    v_mfma_f32_16x16x32_bf16 v[208:211], a[144:147], v[128:131], v[208:211]
    s_add_u32 m0, s23, 0
    ds_read_b64_tr_b16 a[128:129], v230 offset:49152
    v_cvt_pk_bf16_f32 v198, v198, v199
    v_mfma_f32_16x16x32_bf16 v[208:211], a[148:151], v[132:135], v[208:211]
    s_add_u32 s34, s42, 0
    ds_read_b64_tr_b16 a[130:131], v230 offset:51200
    ds_write_b32 v236, v198 offset:2052
    v_mfma_f32_16x16x32_bf16 v[212:215], a[148:151], v[140:143], v[212:215]
    ds_read_b64_tr_b16 a[132:133], v230 offset:53248
    v_mul_f32 v204, v245, v204
    v_mfma_f32_16x16x32_bf16 v[212:215], a[144:147], v[136:139], v[212:215]
    ds_read_b64_tr_b16 a[134:135], v230 offset:55296
    v_mul_f32 v205, v245, v205
    v_mfma_f32_16x16x32_bf16 v[216:219], a[144:147], v[144:147], v[216:219]
    ds_read_b64_tr_b16 a[136:137], v230 offset:57344
    v_cvt_pk_bf16_f32 v204, v204, v205
    v_mfma_f32_16x16x32_bf16 v[216:219], a[148:151], v[148:151], v[216:219]
    ds_read_b64_tr_b16 a[138:139], v230 offset:59392
    ds_write_b32 v236, v204 offset:18432
    v_mfma_f32_16x16x32_bf16 v[220:223], a[148:151], v[156:159], v[220:223]
    ds_read_b64_tr_b16 a[140:141], v230 offset:61440
    v_accvgpr_mov_b32 a43, a187
    v_mfma_f32_16x16x32_bf16 v[220:223], a[144:147], v[152:155], v[220:223]
    ds_read_b64_tr_b16 a[142:143], v230 offset:63488
    v_accvgpr_mov_b32 a44, a188
    v_mfma_f32_16x16x32_bf16 v[220:223], a[152:155], v[184:187], v[220:223]
    ds_read_b64_tr_b16 a[144:145], v231 offset:0
    v_mul_f32 v206, v245, v206
    v_mfma_f32_16x16x32_bf16 v[220:223], a[156:159], v[188:191], v[220:223]
    buffer_load_dwordx4 v232, s[12:15], s34 offen nt lds
    v_mfma_f32_16x16x32_bf16 v[216:219], a[156:159], v[180:183], v[216:219]
    ds_read_b64_tr_b16 a[146:147], v231 offset:2048
    v_mul_f32 v207, v245, v207
    v_mfma_f32_16x16x32_bf16 v[216:219], a[152:155], v[176:179], v[216:219]
    v_accvgpr_mov_b32 a45, a189
    v_accvgpr_mov_b32 a46, a190
    v_mfma_f32_16x16x32_bf16 v[212:215], a[152:155], v[168:171], v[212:215]
    ds_read_b64_tr_b16 a[148:149], v231 offset:4096
    v_cvt_pk_bf16_f32 v206, v206, v207
    v_mfma_f32_16x16x32_bf16 v[212:215], a[156:159], v[172:175], v[212:215]
    ds_write_b32 v236, v206 offset:18436
    v_mfma_f32_16x16x32_bf16 v[208:211], a[156:159], v[164:167], v[208:211]
    ds_read_b64_tr_b16 a[150:151], v231 offset:6144
    v_accvgpr_mov_b32 a47, a191
    v_mfma_f32_16x16x32_bf16 v[208:211], a[152:155], v[160:163], v[208:211]
    s_waitcnt lgkmcnt(5)
    buffer_load_dwordx4 v233, s[12:15], s34 offen offset:1024 nt lds
    v_mfma_f32_16x16x32_bf16 v[192:195], a[128:131], v[0:3], 0
    ds_read_b64_tr_b16 a[152:153], v231 offset:8192
    v_xor_b32 v236, 32, v236
    v_mfma_f32_16x16x32_bf16 v[192:195], a[132:135], v[4:7], v[192:195]
    v_mfma_f32_16x16x32_bf16 v[196:199], a[132:135], v[12:15], 0
    ds_read_b64_tr_b16 a[154:155], v231 offset:10240
    v_mul_f32 v216, v244, v216
    v_mfma_f32_16x16x32_bf16 v[196:199], a[128:131], v[8:11], v[196:199]
    v_mul_f32 v217, v244, v217
    v_mul_f32 v218, v244, v218
    v_mfma_f32_16x16x32_bf16 v[200:203], a[128:131], v[16:19], 0
    ds_read_b64_tr_b16 a[156:157], v231 offset:12288
    v_mul_f32 v219, v244, v219
    v_mfma_f32_16x16x32_bf16 v[200:203], a[132:135], v[20:23], v[200:203]
    buffer_load_dwordx4 v234, s[12:15], s34 offen offset:2048 nt lds
    v_mfma_f32_16x16x32_bf16 v[204:207], a[132:135], v[28:31], 0
    ds_read_b64_tr_b16 a[158:159], v231 offset:14336
    v_cvt_pk_bf16_f32 v216, v216, v217
    v_mfma_f32_16x16x32_bf16 v[204:207], a[128:131], v[24:27], v[204:207]
    v_mfma_f32_16x16x32_bf16 v[204:207], a[136:139], v[56:59], v[204:207]
    ds_read_b64_tr_b16 a[128:129], v231 offset:16384
    v_cvt_pk_bf16_f32 v217, v218, v219
    v_mfma_f32_16x16x32_bf16 v[204:207], a[140:143], v[60:63], v[204:207]
    s_mov_b32 s29, s45
    ds_write_b64 v236, v[216:217] offset:16384
    v_mfma_f32_16x16x32_bf16 v[200:203], a[140:143], v[52:55], v[200:203]
    ds_read_b64_tr_b16 a[130:131], v231 offset:18432
    v_mul_f32 v208, v242, v208
    v_mfma_f32_16x16x32_bf16 v[200:203], a[136:139], v[48:51], v[200:203]
    v_mfma_f32_16x16x32_bf16 v[196:199], a[136:139], v[40:43], v[196:199]
    ds_read_b64_tr_b16 a[132:133], v231 offset:20480
    v_mul_f32 v209, v242, v209
    v_mfma_f32_16x16x32_bf16 v[196:199], a[140:143], v[44:47], v[196:199]
    v_mfma_f32_16x16x32_bf16 v[192:195], a[140:143], v[36:39], v[192:195]
    ds_read_b64_tr_b16 a[134:135], v231 offset:22528
    v_mul_f32 v210, v242, v210
    v_mfma_f32_16x16x32_bf16 v[192:195], a[136:139], v[32:35], v[192:195]
    s_waitcnt lgkmcnt(5)
    v_mul_f32 v211, v242, v211
    v_mfma_f32_16x16x32_bf16 v[192:195], a[144:147], v[64:67], v[192:195]
    ds_read_b64_tr_b16 a[136:137], v231 offset:24576
    v_cvt_pk_bf16_f32 v208, v208, v209
    v_mfma_f32_16x16x32_bf16 v[192:195], a[148:151], v[68:71], v[192:195]
    buffer_load_dwordx4 v235, s[12:15], s34 offen offset:3072 nt lds
    v_mfma_f32_16x16x32_bf16 v[196:199], a[148:151], v[76:79], v[196:199]
    ds_read_b64_tr_b16 a[138:139], v231 offset:26624
    v_cvt_pk_bf16_f32 v209, v210, v211
    v_mfma_f32_16x16x32_bf16 v[196:199], a[144:147], v[72:75], v[196:199]
    ds_write_b64 v236, v[208:209] offset:0
    v_mfma_f32_16x16x32_bf16 v[200:203], a[144:147], v[80:83], v[200:203]
    s_add_u32 m0, s23, 0x4000
    ds_read_b64_tr_b16 a[140:141], v231 offset:28672
    v_mul_f32 v212, v243, v212
    v_mfma_f32_16x16x32_bf16 v[200:203], a[148:151], v[84:87], v[200:203]
    s_add_u32 s34, s42, 0x10000
    v_mul_f32 v213, v243, v213
    v_mul_f32 v214, v243, v214
    v_mfma_f32_16x16x32_bf16 v[204:207], a[148:151], v[92:95], v[204:207]
    ds_read_b64_tr_b16 a[142:143], v231 offset:30720
    v_xor_b32 v230, 32, v230
    v_mfma_f32_16x16x32_bf16 v[204:207], a[144:147], v[88:91], v[204:207]
    v_xor_b32 v231, 32, v231
    v_mul_f32 v215, v243, v215
    v_mfma_f32_16x16x32_bf16 v[204:207], a[152:155], v[120:123], v[204:207]
    ds_read_b64_tr_b16 a[144:145], v230 offset:49152
    v_cvt_pk_bf16_f32 v212, v212, v213
    v_mfma_f32_16x16x32_bf16 v[204:207], a[156:159], v[124:127], v[204:207]
    buffer_load_dwordx4 v232, s[12:15], s34 offen nt lds
    v_mfma_f32_16x16x32_bf16 v[200:203], a[156:159], v[116:119], v[200:203]
    ds_read_b64_tr_b16 a[146:147], v230 offset:51200
    v_cvt_pk_bf16_f32 v213, v214, v215
    v_mfma_f32_16x16x32_bf16 v[200:203], a[152:155], v[112:115], v[200:203]
    ds_write_b64 v236, v[212:213] offset:2048
    v_mfma_f32_16x16x32_bf16 v[196:199], a[152:155], v[104:107], v[196:199]
    s_mov_b32 s32, s46
    ds_read_b64_tr_b16 a[148:149], v230 offset:53248
    v_mfma_f32_16x16x32_bf16 v[196:199], a[156:159], v[108:111], v[196:199]
    v_mul_f32 v220, v245, v220
    v_mul_f32 v221, v245, v221
    v_mfma_f32_16x16x32_bf16 v[192:195], a[156:159], v[100:103], v[192:195]
    ds_read_b64_tr_b16 a[150:151], v230 offset:55296
    v_mul_f32 v222, v245, v222
    v_mfma_f32_16x16x32_bf16 v[192:195], a[152:155], v[96:99], v[192:195]
    s_waitcnt lgkmcnt(5)
    v_mul_f32 v223, v245, v223
    v_cvt_pk_bf16_f32 v220, v220, v221
    v_mfma_f32_16x16x32_bf16 v[192:195], a[128:131], v[128:131], v[192:195]
    ds_read_b64_tr_b16 a[152:153], v230 offset:57344
    v_cvt_pk_bf16_f32 v221, v222, v223
    v_mfma_f32_16x16x32_bf16 v[192:195], a[132:135], v[132:135], v[192:195]
    ds_write_b64 v236, v[220:221] offset:18432
    v_mfma_f32_16x16x32_bf16 v[196:199], a[132:135], v[140:143], v[196:199]
    ds_read_b64_tr_b16 a[154:155], v230 offset:59392
    v_mfma_f32_16x16x32_bf16 v[196:199], a[128:131], v[136:139], v[196:199]
    ds_read_b128 a[212:215], v237 offset:0
    buffer_load_dwordx4 v233, s[12:15], s34 offen offset:1024 nt lds
    v_mfma_f32_16x16x32_bf16 v[200:203], a[128:131], v[144:147], v[200:203]
    ds_read_b64_tr_b16 a[156:157], v230 offset:61440
    v_mfma_f32_16x16x32_bf16 v[200:203], a[132:135], v[148:151], v[200:203]
    ds_read_b128 a[216:219], v237 offset:1024
    v_mfma_f32_16x16x32_bf16 v[204:207], a[132:135], v[156:159], v[204:207]
    ds_read_b64_tr_b16 a[158:159], v230 offset:63488
    v_mfma_f32_16x16x32_bf16 v[204:207], a[128:131], v[152:155], v[204:207]
    ds_read_b128 a[220:223], v237 offset:2048
    v_mfma_f32_16x16x32_bf16 v[204:207], a[136:139], v[184:187], v[204:207]
    ds_read_b64_tr_b16 a[128:129], v231 offset:0
    v_mfma_f32_16x16x32_bf16 v[204:207], a[140:143], v[188:191], v[204:207]
    ds_read_b128 a[224:227], v237 offset:3072
    v_mfma_f32_16x16x32_bf16 v[200:203], a[140:143], v[180:183], v[200:203]
    s_waitcnt vmcnt(10)
    ds_read_b64_tr_b16 a[130:131], v231 offset:2048
    v_mfma_f32_16x16x32_bf16 v[200:203], a[136:139], v[176:179], v[200:203]
    ds_read_b128 a[228:231], v237 offset:16384
    buffer_load_dwordx4 v234, s[12:15], s34 offen offset:2048 nt lds
    v_mfma_f32_16x16x32_bf16 v[196:199], a[136:139], v[168:171], v[196:199]
    ds_read_b64_tr_b16 a[132:133], v231 offset:4096
    v_mfma_f32_16x16x32_bf16 v[196:199], a[140:143], v[172:175], v[196:199]
    ds_read_b128 a[232:235], v237 offset:17408
    ds_read_b128 a[236:239], v237 offset:18432
    v_mfma_f32_16x16x32_bf16 v[192:195], a[140:143], v[164:167], v[192:195]
    s_mov_b32 s33, s47
    ds_read_b64_tr_b16 a[134:135], v231 offset:6144
    v_mfma_f32_16x16x32_bf16 v[192:195], a[136:139], v[160:163], v[192:195]
    s_waitcnt lgkmcnt(9)
    ds_read_b128 a[240:243], v237 offset:19456
    v_mfma_f32_16x16x32_bf16 v[208:211], a[144:147], v[0:3], 0
    ds_read_b64_tr_b16 a[136:137], v231 offset:8192
    v_xor_b32 v236, 0x60, v236
    v_mfma_f32_16x16x32_bf16 v[208:211], a[148:151], v[4:7], v[208:211]
    ds_read_b128 a[72:75], v228 offset:16384
    v_mfma_f32_16x16x32_bf16 v[212:215], a[148:151], v[12:15], 0
    ds_read_b64_tr_b16 a[138:139], v231 offset:10240
    v_mul_f32 v200, v244, v200
    v_mfma_f32_16x16x32_bf16 v[212:215], a[144:147], v[8:11], v[212:215]
    buffer_load_dwordx4 v235, s[12:15], s34 offen offset:3072 nt lds
    v_mfma_f32_16x16x32_bf16 v[216:219], a[144:147], v[16:19], 0
    ds_read_b64_tr_b16 a[140:141], v231 offset:12288
    v_mul_f32 v201, v244, v201
    v_mfma_f32_16x16x32_bf16 v[216:219], a[148:151], v[20:23], v[216:219]
    ds_read_b128 a[76:79], v229 offset:16384
    v_mfma_f32_16x16x32_bf16 v[220:223], a[148:151], v[28:31], 0
    ds_read_b64_tr_b16 a[142:143], v231 offset:14336
    v_cvt_pk_bf16_f32 v200, v200, v201
    v_mfma_f32_16x16x32_bf16 v[220:223], a[144:147], v[24:27], v[220:223]
    ds_write_b32 v236, v200 offset:16384
    v_mfma_f32_16x16x32_bf16 v[220:223], a[152:155], v[56:59], v[220:223]
    s_add_u32 m0, s23, 0x8000
    ds_read_b64_tr_b16 a[144:145], v231 offset:16384
    v_mul_f32 v202, v244, v202
    v_mfma_f32_16x16x32_bf16 v[220:223], a[156:159], v[60:63], v[220:223]
    s_add_u32 s34, s42, 0x20000
    ds_read_b128 a[104:107], v228 offset:18432
    v_mul_f32 v203, v244, v203
    v_mfma_f32_16x16x32_bf16 v[216:219], a[156:159], v[52:55], v[216:219]
    ds_read_b64_tr_b16 a[146:147], v231 offset:18432
    v_cvt_pk_bf16_f32 v202, v202, v203
    v_mfma_f32_16x16x32_bf16 v[216:219], a[152:155], v[48:51], v[216:219]
    ds_write_b32 v236, v202 offset:16388
    v_mfma_f32_16x16x32_bf16 v[212:215], a[152:155], v[40:43], v[212:215]
    ds_read_b64_tr_b16 a[148:149], v231 offset:20480
    v_mfma_f32_16x16x32_bf16 v[212:215], a[156:159], v[44:47], v[212:215]
    buffer_load_dwordx4 v232, s[12:15], s34 offen nt lds
    v_mfma_f32_16x16x32_bf16 v[208:211], a[156:159], v[36:39], v[208:211]
    ds_read_b64_tr_b16 a[150:151], v231 offset:22528
    v_mul_f32 v192, v242, v192
    v_mfma_f32_16x16x32_bf16 v[208:211], a[152:155], v[32:35], v[208:211]
    s_waitcnt lgkmcnt(7)
    ds_read_b128 a[108:111], v229 offset:18432
    v_mul_f32 v193, v242, v193
    v_mfma_f32_16x16x32_bf16 v[208:211], a[128:131], v[64:67], v[208:211]
    ds_read_b64_tr_b16 a[152:153], v231 offset:24576
    v_cvt_pk_bf16_f32 v192, v192, v193
    v_mfma_f32_16x16x32_bf16 v[208:211], a[132:135], v[68:71], v[208:211]
    s_add_u32 s25, s25, 1
    ds_write_b32 v236, v192 offset:0
    v_mfma_f32_16x16x32_bf16 v[212:215], a[132:135], v[76:79], v[212:215]
    ds_read_b64_tr_b16 a[154:155], v231 offset:26624
    v_mfma_f32_16x16x32_bf16 v[212:215], a[128:131], v[72:75], v[212:215]
    buffer_store_dwordx4 a[212:215], v232, s[16:19], s44 offen sc1
    v_mul_f32 v194, v242, v194
    v_mul_f32 v195, v242, v195
    v_mfma_f32_16x16x32_bf16 v[216:219], a[128:131], v[80:83], v[216:219]
    ds_read_b64_tr_b16 a[156:157], v231 offset:28672
    v_cvt_pk_bf16_f32 v194, v194, v195
    v_mfma_f32_16x16x32_bf16 v[216:219], a[132:135], v[84:87], v[216:219]
    ds_write_b32 v236, v194 offset:4
    v_mfma_f32_16x16x32_bf16 v[220:223], a[132:135], v[92:95], v[220:223]
L_hop5:
    s_cbranch_execz L_hopret1
    ds_read_b64_tr_b16 a[158:159], v231 offset:30720
    v_xor_b32 v230, 0x60, v230
    v_mfma_f32_16x16x32_bf16 v[220:223], a[128:131], v[88:91], v[220:223]
    v_xor_b32 v231, 0x60, v231
    v_mul_f32 v196, v243, v196
    v_mfma_f32_16x16x32_bf16 v[220:223], a[136:139], v[120:123], v[220:223]
    ds_read_b64_tr_b16 a[128:129], v230 offset:49152
    v_mul_f32 v197, v243, v197
    v_mfma_f32_16x16x32_bf16 v[220:223], a[140:143], v[124:127], v[220:223]
    buffer_load_dwordx4 v233, s[12:15], s34 offen offset:1024 nt lds
    v_mfma_f32_16x16x32_bf16 v[216:219], a[140:143], v[116:119], v[216:219]
    ds_read_b64_tr_b16 a[130:131], v230 offset:51200
    v_cvt_pk_bf16_f32 v196, v196, v197
    v_mfma_f32_16x16x32_bf16 v[216:219], a[136:139], v[112:115], v[216:219]
    ds_write_b32 v236, v196 offset:2048
    v_mfma_f32_16x16x32_bf16 v[212:215], a[136:139], v[104:107], v[212:215]
    ds_read_b64_tr_b16 a[132:133], v230 offset:53248
    v_mfma_f32_16x16x32_bf16 v[212:215], a[140:143], v[108:111], v[212:215]
    buffer_load_dwordx4 v234, s[12:15], s34 offen offset:2048 nt lds
    v_mfma_f32_16x16x32_bf16 v[208:211], a[140:143], v[100:103], v[208:211]
    ds_read_b64_tr_b16 a[134:135], v230 offset:55296
    v_mfma_f32_16x16x32_bf16 v[208:211], a[136:139], v[96:99], v[208:211]
    s_waitcnt lgkmcnt(5)
    v_mul_f32 v198, v243, v198
    v_mfma_f32_16x16x32_bf16 v[208:211], a[144:147], v[128:131], v[208:211]
    ds_read_b64_tr_b16 a[136:137], v230 offset:57344
    v_mul_f32 v199, v243, v199
    v_mfma_f32_16x16x32_bf16 v[208:211], a[148:151], v[132:135], v[208:211]
    v_mfma_f32_16x16x32_bf16 v[212:215], a[148:151], v[140:143], v[212:215]
    ds_read_b64_tr_b16 a[138:139], v230 offset:59392
    v_cvt_pk_bf16_f32 v198, v198, v199
    v_mfma_f32_16x16x32_bf16 v[212:215], a[144:147], v[136:139], v[212:215]
    ds_write_b32 v236, v198 offset:2052
    v_mfma_f32_16x16x32_bf16 v[216:219], a[144:147], v[144:147], v[216:219]
    s_mov_b32 s26, s54
    ds_read_b64_tr_b16 a[140:141], v230 offset:61440
    v_mul_f32 v204, v245, v204
    v_mfma_f32_16x16x32_bf16 v[216:219], a[148:151], v[148:151], v[216:219]
    buffer_load_dwordx4 v235, s[12:15], s34 offen offset:3072 nt lds
    v_mfma_f32_16x16x32_bf16 v[220:223], a[148:151], v[156:159], v[220:223]
    ds_read_b64_tr_b16 a[142:143], v230 offset:63488
    v_mul_f32 v205, v245, v205
    v_mfma_f32_16x16x32_bf16 v[220:223], a[144:147], v[152:155], v[220:223]
    v_mfma_f32_16x16x32_bf16 v[220:223], a[152:155], v[184:187], v[220:223]
    ds_read_b64_tr_b16 a[144:145], v231 offset:0
    v_cvt_pk_bf16_f32 v204, v204, v205
    v_mfma_f32_16x16x32_bf16 v[220:223], a[156:159], v[188:191], v[220:223]
    ds_write_b32 v236, v204 offset:18432
    v_mfma_f32_16x16x32_bf16 v[216:219], a[156:159], v[180:183], v[216:219]
    ds_read_b64_tr_b16 a[146:147], v231 offset:2048
    v_mul_f32 v206, v245, v206
    v_mfma_f32_16x16x32_bf16 v[216:219], a[152:155], v[176:179], v[216:219]
    buffer_store_dwordx4 a[216:219], v233, s[16:19], s44 offen offset:1024 sc1
    v_mfma_f32_16x16x32_bf16 v[212:215], a[152:155], v[168:171], v[212:215]
    ds_read_b64_tr_b16 a[148:149], v231 offset:4096
    v_mul_f32 v207, v245, v207
    v_mfma_f32_16x16x32_bf16 v[212:215], a[156:159], v[172:175], v[212:215]
    v_mfma_f32_16x16x32_bf16 v[208:211], a[156:159], v[164:167], v[208:211]
    ds_read_b64_tr_b16 a[150:151], v231 offset:6144
    v_cvt_pk_bf16_f32 v206, v206, v207
    v_mfma_f32_16x16x32_bf16 v[208:211], a[152:155], v[160:163], v[208:211]
    s_waitcnt lgkmcnt(5)
    ds_write_b32 v236, v206 offset:18436
    v_mfma_f32_16x16x32_bf16 v[192:195], a[128:131], v[0:3], 0
    ds_read_b64_tr_b16 a[152:153], v231 offset:8192
    v_xor_b32 v236, 32, v236
    v_mfma_f32_16x16x32_bf16 v[192:195], a[132:135], v[4:7], v[192:195]
    v_mfma_f32_16x16x32_bf16 v[196:199], a[132:135], v[12:15], 0
    ds_read_b64_tr_b16 a[154:155], v231 offset:10240
    v_mul_f32 v216, v244, v216
    v_mfma_f32_16x16x32_bf16 v[196:199], a[128:131], v[8:11], v[196:199]
    v_mfma_f32_16x16x32_bf16 v[200:203], a[128:131], v[16:19], 0
    ds_read_b64_tr_b16 a[156:157], v231 offset:12288
    v_mul_f32 v217, v244, v217
    v_mfma_f32_16x16x32_bf16 v[200:203], a[132:135], v[20:23], v[200:203]
    v_mfma_f32_16x16x32_bf16 v[204:207], a[132:135], v[28:31], 0
    ds_read_b64_tr_b16 a[158:159], v231 offset:14336
    v_cvt_pk_bf16_f32 v216, v216, v217
    v_mfma_f32_16x16x32_bf16 v[204:207], a[128:131], v[24:27], v[204:207]
    s_mov_b32 s54, s55
    ds_write_b32 v236, v216 offset:16384
    v_mfma_f32_16x16x32_bf16 v[204:207], a[136:139], v[56:59], v[204:207]
    ds_read_b64_tr_b16 a[128:129], v231 offset:16384
    v_mul_f32 v218, v244, v218
    v_mfma_f32_16x16x32_bf16 v[204:207], a[140:143], v[60:63], v[204:207]
    v_mul_f32 v219, v244, v219
    v_mfma_f32_16x16x32_bf16 v[200:203], a[140:143], v[52:55], v[200:203]
    ds_read_b64_tr_b16 a[130:131], v231 offset:18432
    v_cvt_pk_bf16_f32 v218, v218, v219
    v_mfma_f32_16x16x32_bf16 v[200:203], a[136:139], v[48:51], v[200:203]
    ds_write_b32 v236, v218 offset:16388
    v_mfma_f32_16x16x32_bf16 v[196:199], a[136:139], v[40:43], v[196:199]
    ds_read_b64_tr_b16 a[132:133], v231 offset:20480
    v_mfma_f32_16x16x32_bf16 v[196:199], a[140:143], v[44:47], v[196:199]
    v_mul_f32 v208, v242, v208
    v_mul_f32 v209, v242, v209
    v_mfma_f32_16x16x32_bf16 v[192:195], a[140:143], v[36:39], v[192:195]
    ds_read_b64_tr_b16 a[134:135], v231 offset:22528
    v_cvt_pk_bf16_f32 v208, v208, v209
    v_mfma_f32_16x16x32_bf16 v[192:195], a[136:139], v[32:35], v[192:195]
    s_waitcnt lgkmcnt(6)
    ds_write_b32 v236, v208 offset:0
    v_mfma_f32_16x16x32_bf16 v[192:195], a[144:147], v[64:67], v[192:195]
    s_add_u32 m0, s23, 0x1c000
    ds_read_b64_tr_b16 a[136:137], v231 offset:24576
    v_mfma_f32_16x16x32_bf16 v[192:195], a[148:151], v[68:71], v[192:195]
    buffer_store_dwordx4 a[220:223], v234, s[16:19], s44 offen offset:2048 sc1
    v_mul_f32 v210, v242, v210
    v_mfma_f32_16x16x32_bf16 v[196:199], a[148:151], v[76:79], v[196:199]
    s_add_u32 s34, s43, 0
    ds_read_b64_tr_b16 a[138:139], v231 offset:26624
    v_mul_f32 v211, v242, v211
    v_mfma_f32_16x16x32_bf16 v[196:199], a[144:147], v[72:75], v[196:199]
    v_mfma_f32_16x16x32_bf16 v[200:203], a[144:147], v[80:83], v[200:203]
    ds_read_b64_tr_b16 a[140:141], v231 offset:28672
    v_cvt_pk_bf16_f32 v210, v210, v211
    v_mfma_f32_16x16x32_bf16 v[200:203], a[148:151], v[84:87], v[200:203]
    ds_write_b32 v236, v210 offset:4
    v_mfma_f32_16x16x32_bf16 v[204:207], a[148:151], v[92:95], v[204:207]
    ds_read_b64_tr_b16 a[142:143], v231 offset:30720
    v_xor_b32 v230, 32, v230
    v_mfma_f32_16x16x32_bf16 v[204:207], a[144:147], v[88:91], v[204:207]
    v_xor_b32 v231, 32, v231
    v_mfma_f32_16x16x32_bf16 v[204:207], a[152:155], v[120:123], v[204:207]
    ds_read_b64_tr_b16 a[144:145], v230 offset:49152
    v_mul_f32 v212, v243, v212
    v_mfma_f32_16x16x32_bf16 v[204:207], a[156:159], v[124:127], v[204:207]
    buffer_load_dwordx4 v232, s[12:15], s34 offen nt lds
    v_mfma_f32_16x16x32_bf16 v[200:203], a[156:159], v[116:119], v[200:203]
    s_mul_hi_u32 s31, s26, 0x55555556
    ds_read_b64_tr_b16 a[146:147], v230 offset:51200
    v_mul_f32 v213, v243, v213
    v_mfma_f32_16x16x32_bf16 v[200:203], a[152:155], v[112:115], v[200:203]
    s_waitcnt vmcnt(16)
    ds_read_b128 a[80:83], v228 offset:0
    v_mfma_f32_16x16x32_bf16 v[196:199], a[152:155], v[104:107], v[196:199]
    ds_read_b64_tr_b16 a[148:149], v230 offset:53248
    v_cvt_pk_bf16_f32 v212, v212, v213
    v_mfma_f32_16x16x32_bf16 v[196:199], a[156:159], v[108:111], v[196:199]
    ds_write_b32 v236, v212 offset:2048
    v_mfma_f32_16x16x32_bf16 v[192:195], a[156:159], v[100:103], v[192:195]
    ds_read_b64_tr_b16 a[150:151], v230 offset:55296
    v_mfma_f32_16x16x32_bf16 v[192:195], a[152:155], v[96:99], v[192:195]
    s_waitcnt lgkmcnt(6)
    v_mul_f32 v214, v243, v214
    v_mul_f32 v215, v243, v215
    v_mfma_f32_16x16x32_bf16 v[192:195], a[128:131], v[128:131], v[192:195]
    ds_read_b64_tr_b16 a[152:153], v230 offset:57344
    v_cvt_pk_bf16_f32 v214, v214, v215
    v_mfma_f32_16x16x32_bf16 v[192:195], a[132:135], v[132:135], v[192:195]
    ds_write_b32 v236, v214 offset:2052
    v_mfma_f32_16x16x32_bf16 v[196:199], a[132:135], v[140:143], v[196:199]
    ds_read_b64_tr_b16 a[154:155], v230 offset:59392
    v_mul_f32 v220, v245, v220
    v_mfma_f32_16x16x32_bf16 v[196:199], a[128:131], v[136:139], v[196:199]
    ds_read_b128 a[84:87], v229 offset:0
    v_mfma_f32_16x16x32_bf16 v[200:203], a[128:131], v[144:147], v[200:203]
    ds_read_b64_tr_b16 a[156:157], v230 offset:61440
    v_mul_f32 v221, v245, v221
    v_mfma_f32_16x16x32_bf16 v[200:203], a[132:135], v[148:151], v[200:203]
    buffer_load_dwordx4 v233, s[12:15], s34 offen offset:1024 nt lds
    v_mfma_f32_16x16x32_bf16 v[204:207], a[132:135], v[156:159], v[204:207]
    ds_read_b64_tr_b16 a[158:159], v230 offset:63488
    v_cvt_pk_bf16_f32 v220, v220, v221
    v_mfma_f32_16x16x32_bf16 v[204:207], a[128:131], v[152:155], v[204:207]
    ds_write_b32 v236, v220 offset:18432
    v_mfma_f32_16x16x32_bf16 v[204:207], a[136:139], v[184:187], v[204:207]
    ds_read_b64_tr_b16 a[128:129], v231 offset:0
    v_mfma_f32_16x16x32_bf16 v[204:207], a[140:143], v[188:191], v[204:207]
    buffer_store_dwordx4 a[224:227], v235, s[16:19], s44 offen offset:3072 sc1
    v_mfma_f32_16x16x32_bf16 v[200:203], a[140:143], v[180:183], v[200:203]
    ds_read_b64_tr_b16 a[130:131], v231 offset:2048
    v_mul_f32 v222, v245, v222
    v_mfma_f32_16x16x32_bf16 v[200:203], a[136:139], v[176:179], v[200:203]
    ds_read_b128 a[112:115], v228 offset:2048
    v_mfma_f32_16x16x32_bf16 v[196:199], a[136:139], v[168:171], v[196:199]
    s_mul_i32 s27, s31, 196608
    ds_read_b64_tr_b16 a[132:133], v231 offset:4096
    v_mul_f32 v223, v245, v223
    v_mfma_f32_16x16x32_bf16 v[196:199], a[140:143], v[172:175], v[196:199]
    v_mfma_f32_16x16x32_bf16 v[192:195], a[140:143], v[164:167], v[192:195]
    ds_read_b64_tr_b16 a[134:135], v231 offset:6144
    v_cvt_pk_bf16_f32 v222, v222, v223
    v_mfma_f32_16x16x32_bf16 v[192:195], a[136:139], v[160:163], v[192:195]
    s_waitcnt lgkmcnt(6)
    ds_write_b32 v236, v222 offset:18436
    v_mfma_f32_16x16x32_bf16 v[208:211], a[144:147], v[0:3], 0
    ds_read_b64_tr_b16 a[136:137], v231 offset:8192
    v_xor_b32 v236, 0x60, v236
    v_mfma_f32_16x16x32_bf16 v[208:211], a[148:151], v[4:7], v[208:211]
    ds_read_b128 a[116:119], v229 offset:2048
    v_mfma_f32_16x16x32_bf16 v[212:215], a[148:151], v[12:15], 0
    ds_read_b64_tr_b16 a[138:139], v231 offset:10240
    v_mul_f32 v200, v244, v200
    v_mfma_f32_16x16x32_bf16 v[212:215], a[144:147], v[8:11], v[212:215]
    buffer_load_dwordx4 v234, s[12:15], s34 offen offset:2048 nt lds
    v_mfma_f32_16x16x32_bf16 v[216:219], a[144:147], v[16:19], 0
    ds_read_b64_tr_b16 a[140:141], v231 offset:12288
    v_mul_f32 v201, v244, v201
    v_mfma_f32_16x16x32_bf16 v[216:219], a[148:151], v[20:23], v[216:219]
    v_mfma_f32_16x16x32_bf16 v[220:223], a[148:151], v[28:31], 0
    s_add_u32 s35, s44, 0x4000
    ds_read_b64_tr_b16 a[142:143], v231 offset:14336
    v_cvt_pk_bf16_f32 v200, v200, v201
    v_mfma_f32_16x16x32_bf16 v[220:223], a[144:147], v[24:27], v[220:223]
    ds_write_b32 v236, v200 offset:16384
    v_mfma_f32_16x16x32_bf16 v[220:223], a[152:155], v[56:59], v[220:223]
    ds_read_b64_tr_b16 a[144:145], v231 offset:16384
    v_mul_f32 v202, v244, v202
    v_mfma_f32_16x16x32_bf16 v[220:223], a[156:159], v[60:63], v[220:223]
    v_mul_f32 v203, v244, v203
    v_mfma_f32_16x16x32_bf16 v[216:219], a[156:159], v[52:55], v[216:219]
    ds_read_b64_tr_b16 a[146:147], v231 offset:18432
    v_cvt_pk_bf16_f32 v202, v202, v203
    v_mfma_f32_16x16x32_bf16 v[216:219], a[152:155], v[48:51], v[216:219]
    ds_write_b32 v236, v202 offset:16388
    v_mfma_f32_16x16x32_bf16 v[212:215], a[152:155], v[40:43], v[212:215]
    ds_read_b64_tr_b16 a[148:149], v231 offset:20480
    v_mfma_f32_16x16x32_bf16 v[212:215], a[156:159], v[44:47], v[212:215]
    buffer_load_dwordx4 v235, s[12:15], s34 offen offset:3072 nt lds
    v_mfma_f32_16x16x32_bf16 v[208:211], a[156:159], v[36:39], v[208:211]
    ds_read_b64_tr_b16 a[150:151], v231 offset:22528
    v_mul_f32 v192, v242, v192
    v_mfma_f32_16x16x32_bf16 v[208:211], a[152:155], v[32:35], v[208:211]
    s_waitcnt lgkmcnt(6)
    s_lshr_b32 s28, s23, 5
    v_mul_f32 v193, v242, v193
    v_mfma_f32_16x16x32_bf16 v[208:211], a[128:131], v[64:67], v[208:211]
    ds_read_b64_tr_b16 a[152:153], v231 offset:24576
    v_cvt_pk_bf16_f32 v192, v192, v193
    v_mfma_f32_16x16x32_bf16 v[208:211], a[132:135], v[68:71], v[208:211]
    ds_write_b32 v236, v192 offset:0
    v_mfma_f32_16x16x32_bf16 v[212:215], a[132:135], v[76:79], v[212:215]
    ds_read_b64_tr_b16 a[154:155], v231 offset:26624
    v_mfma_f32_16x16x32_bf16 v[212:215], a[128:131], v[72:75], v[212:215]
    buffer_store_dwordx4 a[228:231], v232, s[16:19], s35 offen sc1
    v_mul_f32 v194, v242, v194
    v_mul_f32 v195, v242, v195
    v_mfma_f32_16x16x32_bf16 v[216:219], a[128:131], v[80:83], v[216:219]
    ds_read_b64_tr_b16 a[156:157], v231 offset:28672
    v_cvt_pk_bf16_f32 v194, v194, v195
    v_mfma_f32_16x16x32_bf16 v[216:219], a[132:135], v[84:87], v[216:219]
    ds_write_b32 v236, v194 offset:4
    v_mfma_f32_16x16x32_bf16 v[220:223], a[132:135], v[92:95], v[220:223]
    ds_read_b64_tr_b16 a[158:159], v231 offset:30720
    v_xor_b32 v230, 0x60, v230
    v_mfma_f32_16x16x32_bf16 v[220:223], a[128:131], v[88:91], v[220:223]
    v_xor_b32 v231, 0x60, v231
    v_mul_f32 v196, v243, v196
    v_mfma_f32_16x16x32_bf16 v[220:223], a[136:139], v[120:123], v[220:223]
    v_mfma_f32_16x16x32_bf16 v[220:223], a[140:143], v[124:127], v[220:223]
    v_mfma_f32_16x16x32_bf16 v[216:219], a[140:143], v[116:119], v[216:219]
    v_mfma_f32_16x16x32_bf16 v[216:219], a[136:139], v[112:115], v[216:219]
    v_mul_f32 v197, v243, v197
    v_cvt_pk_bf16_f32 v196, v196, v197
    v_mfma_f32_16x16x32_bf16 v[212:215], a[136:139], v[104:107], v[212:215]
    v_mfma_f32_16x16x32_bf16 v[212:215], a[140:143], v[108:111], v[212:215]
    ds_write_b32 v236, v196 offset:2048
    v_mfma_f32_16x16x32_bf16 v[208:211], a[140:143], v[100:103], v[208:211]
    v_mfma_f32_16x16x32_bf16 v[208:211], a[136:139], v[96:99], v[208:211]
    s_waitcnt vmcnt(8) lgkmcnt(1)
    s_barrier
    v_mfma_f32_16x16x32_bf16 v[208:211], a[144:147], v[128:131], v[208:211]
    s_add_u32 m0, s23, 0xc000
    ds_read_b64_tr_b16 a[128:129], v230 offset:0
    v_mul_f32 v198, v243, v198
    v_mfma_f32_16x16x32_bf16 v[208:211], a[148:151], v[132:135], v[208:211]
    s_add_u32 s34, s43, 0x10000
    ds_read_b64_tr_b16 a[130:131], v230 offset:2048
    v_mul_f32 v199, v243, v199
    v_mfma_f32_16x16x32_bf16 v[212:215], a[148:151], v[140:143], v[212:215]
    s_xor_b32 s28, s28, s96
    ds_read_b64_tr_b16 a[132:133], v230 offset:4096
    v_cvt_pk_bf16_f32 v198, v198, v199
    v_mfma_f32_16x16x32_bf16 v[212:215], a[144:147], v[136:139], v[212:215]
    ds_read_b64_tr_b16 a[134:135], v230 offset:6144
    ds_write_b32 v236, v198 offset:2052
    v_mfma_f32_16x16x32_bf16 v[216:219], a[144:147], v[144:147], v[216:219]
    ds_read_b64_tr_b16 a[136:137], v230 offset:8192
    v_mfma_f32_16x16x32_bf16 v[216:219], a[148:151], v[148:151], v[216:219]
    ds_read_b64_tr_b16 a[138:139], v230 offset:10240
    v_mul_f32 v204, v245, v204
    v_mfma_f32_16x16x32_bf16 v[220:223], a[148:151], v[156:159], v[220:223]
    ds_read_b64_tr_b16 a[140:141], v230 offset:12288
    v_mul_f32 v205, v245, v205
    v_mfma_f32_16x16x32_bf16 v[220:223], a[144:147], v[152:155], v[220:223]
    ds_read_b64_tr_b16 a[142:143], v230 offset:14336
    v_mfma_f32_16x16x32_bf16 v[220:223], a[152:155], v[184:187], v[220:223]
    ds_read_b64_tr_b16 a[144:145], v230 offset:16384
    v_cvt_pk_bf16_f32 v204, v204, v205
    v_mfma_f32_16x16x32_bf16 v[220:223], a[156:159], v[188:191], v[220:223]
    buffer_store_dwordx4 a[232:235], v233, s[16:19], s35 offen offset:1024 sc1
    v_mfma_f32_16x16x32_bf16 v[216:219], a[156:159], v[180:183], v[216:219]
    ds_read_b64_tr_b16 a[146:147], v230 offset:18432
    v_mfma_f32_16x16x32_bf16 v[216:219], a[152:155], v[176:179], v[216:219]
    ds_write_b32 v236, v204 offset:18432
    v_mul_f32 v206, v245, v206
    v_mfma_f32_16x16x32_bf16 v[212:215], a[152:155], v[168:171], v[212:215]
    ds_read_b64_tr_b16 a[148:149], v230 offset:20480
    v_mul_f32 v207, v245, v207
    v_mfma_f32_16x16x32_bf16 v[212:215], a[156:159], v[172:175], v[212:215]
    buffer_load_dwordx4 v232, s[12:15], s34 offen nt lds
    v_mfma_f32_16x16x32_bf16 v[208:211], a[156:159], v[164:167], v[208:211]
    ds_read_b64_tr_b16 a[150:151], v230 offset:22528
    v_cvt_pk_bf16_f32 v206, v206, v207
    v_mfma_f32_16x16x32_bf16 v[208:211], a[152:155], v[160:163], v[208:211]
    s_waitcnt lgkmcnt(5)
    ds_write_b32 v236, v206 offset:18436
    v_mfma_f32_16x16x32_bf16 v[192:195], a[128:131], v[0:3], 0
    ds_read_b64_tr_b16 a[152:153], v230 offset:24576
    v_xor_b32 v236, 32, v236
    v_mfma_f32_16x16x32_bf16 v[192:195], a[132:135], v[4:7], v[192:195]
    buffer_load_dwordx4 v233, s[12:15], s34 offen offset:1024 nt lds
    v_mfma_f32_16x16x32_bf16 v[196:199], a[132:135], v[12:15], 0
    ds_read_b64_tr_b16 a[154:155], v230 offset:26624
    v_mul_f32 v216, v244, v216
    v_mfma_f32_16x16x32_bf16 v[196:199], a[128:131], v[8:11], v[196:199]
    v_mfma_f32_16x16x32_bf16 v[200:203], a[128:131], v[16:19], 0
    ds_read_b64_tr_b16 a[156:157], v230 offset:28672
    v_mul_f32 v217, v244, v217
    v_mfma_f32_16x16x32_bf16 v[200:203], a[132:135], v[20:23], v[200:203]
    s_add_u32 s28, s28, s27
    v_mul_f32 v218, v244, v218
    v_mul_f32 v219, v244, v219
    v_mfma_f32_16x16x32_bf16 v[204:207], a[132:135], v[28:31], 0
    ds_read_b64_tr_b16 a[158:159], v230 offset:30720
    v_cvt_pk_bf16_f32 v216, v216, v217
    v_mfma_f32_16x16x32_bf16 v[204:207], a[128:131], v[24:27], v[204:207]
    v_mfma_f32_16x16x32_bf16 v[204:207], a[136:139], v[56:59], v[204:207]
    ds_read_b64_tr_b16 a[128:129], v230 offset:32768
    v_cvt_pk_bf16_f32 v217, v218, v219
    v_mfma_f32_16x16x32_bf16 v[204:207], a[140:143], v[60:63], v[204:207]
    ds_write_b64 v236, v[216:217] offset:16384
    v_mfma_f32_16x16x32_bf16 v[200:203], a[140:143], v[52:55], v[200:203]
    ds_read_b64_tr_b16 a[130:131], v230 offset:34816
    v_mul_f32 v208, v242, v208
    v_mfma_f32_16x16x32_bf16 v[200:203], a[136:139], v[48:51], v[200:203]
    buffer_load_dwordx4 v234, s[12:15], s34 offen offset:2048 nt lds
    v_mfma_f32_16x16x32_bf16 v[196:199], a[136:139], v[40:43], v[196:199]
    ds_read_b64_tr_b16 a[132:133], v230 offset:36864
    v_mul_f32 v209, v242, v209
    v_mfma_f32_16x16x32_bf16 v[196:199], a[140:143], v[44:47], v[196:199]
    v_mfma_f32_16x16x32_bf16 v[192:195], a[140:143], v[36:39], v[192:195]
    ds_read_b64_tr_b16 a[134:135], v230 offset:38912
    v_mul_f32 v210, v242, v210
    v_mfma_f32_16x16x32_bf16 v[192:195], a[136:139], v[32:35], v[192:195]
    s_waitcnt lgkmcnt(5)
    v_mul_f32 v211, v242, v211
    v_mfma_f32_16x16x32_bf16 v[192:195], a[144:147], v[64:67], v[192:195]
    ds_read_b64_tr_b16 a[136:137], v230 offset:40960
    v_cvt_pk_bf16_f32 v208, v208, v209
    v_mfma_f32_16x16x32_bf16 v[192:195], a[148:151], v[68:71], v[192:195]
    buffer_store_dwordx4 a[236:239], v234, s[16:19], s35 offen offset:2048 sc1
    v_cvt_pk_bf16_f32 v209, v210, v211
    v_mfma_f32_16x16x32_bf16 v[196:199], a[148:151], v[76:79], v[196:199]
    ds_read_b64_tr_b16 a[138:139], v230 offset:43008
    v_mfma_f32_16x16x32_bf16 v[196:199], a[144:147], v[72:75], v[196:199]
    ds_write_b64 v236, v[208:209] offset:0
    v_mfma_f32_16x16x32_bf16 v[200:203], a[144:147], v[80:83], v[200:203]
    ds_read_b64_tr_b16 a[140:141], v230 offset:45056
    v_mul_f32 v212, v243, v212
    v_mfma_f32_16x16x32_bf16 v[200:203], a[148:151], v[84:87], v[200:203]
    buffer_load_dwordx4 v235, s[12:15], s34 offen offset:3072 nt lds
    v_mfma_f32_16x16x32_bf16 v[204:207], a[148:151], v[92:95], v[204:207]
    ds_read_b64_tr_b16 a[142:143], v230 offset:47104
    v_xor_b32 v230, 32, v230
    v_mfma_f32_16x16x32_bf16 v[204:207], a[144:147], v[88:91], v[204:207]
    s_lshl_b32 s37, s26, 17
    v_xor_b32 v231, 32, v231
    v_mul_f32 v213, v243, v213
    v_mfma_f32_16x16x32_bf16 v[204:207], a[152:155], v[120:123], v[204:207]
    ds_read_b64_tr_b16 a[144:145], v230 offset:0
    v_mul_f32 v214, v243, v214
    v_mfma_f32_16x16x32_bf16 v[204:207], a[156:159], v[124:127], v[204:207]
    v_mul_f32 v215, v243, v215
    v_cvt_pk_bf16_f32 v212, v212, v213
    v_mfma_f32_16x16x32_bf16 v[200:203], a[156:159], v[116:119], v[200:203]
    ds_read_b64_tr_b16 a[146:147], v230 offset:2048
    v_cvt_pk_bf16_f32 v213, v214, v215
    v_mfma_f32_16x16x32_bf16 v[200:203], a[152:155], v[112:115], v[200:203]
    ds_write_b64 v236, v[212:213] offset:2048
    v_mfma_f32_16x16x32_bf16 v[196:199], a[152:155], v[104:107], v[196:199]
    s_add_u32 m0, s23, 0x10000
    ds_read_b64_tr_b16 a[148:149], v230 offset:4096
    v_mfma_f32_16x16x32_bf16 v[196:199], a[156:159], v[108:111], v[196:199]
    s_add_u32 s34, s43, 0x20000
    v_mul_f32 v220, v245, v220
    v_mul_f32 v221, v245, v221
    v_mfma_f32_16x16x32_bf16 v[192:195], a[156:159], v[100:103], v[192:195]
    ds_read_b64_tr_b16 a[150:151], v230 offset:6144
    v_mul_f32 v222, v245, v222
    v_mfma_f32_16x16x32_bf16 v[192:195], a[152:155], v[96:99], v[192:195]
    s_waitcnt lgkmcnt(5)
    v_mul_f32 v223, v245, v223
    v_cvt_pk_bf16_f32 v220, v220, v221
    v_mfma_f32_16x16x32_bf16 v[192:195], a[128:131], v[128:131], v[192:195]
    ds_read_b64_tr_b16 a[152:153], v230 offset:8192
    v_cvt_pk_bf16_f32 v221, v222, v223
    v_mfma_f32_16x16x32_bf16 v[192:195], a[132:135], v[132:135], v[192:195]
    ds_write_b64 v236, v[220:221] offset:18432
    v_mfma_f32_16x16x32_bf16 v[196:199], a[132:135], v[140:143], v[196:199]
    ds_read_b64_tr_b16 a[154:155], v230 offset:10240
    v_mfma_f32_16x16x32_bf16 v[196:199], a[128:131], v[136:139], v[196:199]
    ds_read_b128 a[160:163], v237 offset:0
    buffer_load_dwordx4 v232, s[12:15], s34 offen nt lds
    v_mfma_f32_16x16x32_bf16 v[200:203], a[128:131], v[144:147], v[200:203]
    ds_read_b64_tr_b16 a[156:157], v230 offset:12288
    v_mfma_f32_16x16x32_bf16 v[200:203], a[132:135], v[148:151], v[200:203]
    ds_read_b128 a[164:167], v237 offset:1024
    v_mfma_f32_16x16x32_bf16 v[204:207], a[132:135], v[156:159], v[204:207]
    ds_read_b64_tr_b16 a[158:159], v230 offset:14336
    v_mfma_f32_16x16x32_bf16 v[204:207], a[128:131], v[152:155], v[204:207]
    ds_read_b128 a[168:171], v237 offset:2048
    v_mfma_f32_16x16x32_bf16 v[204:207], a[136:139], v[184:187], v[204:207]
    ds_read_b64_tr_b16 a[128:129], v230 offset:16384
    v_mfma_f32_16x16x32_bf16 v[204:207], a[140:143], v[188:191], v[204:207]
    buffer_store_dwordx4 a[240:243], v235, s[16:19], s35 offen offset:3072 sc1
    v_mfma_f32_16x16x32_bf16 v[200:203], a[140:143], v[180:183], v[200:203]
    s_lshl3_add_u32 s37, s23, s37
    ds_read_b64_tr_b16 a[130:131], v230 offset:18432
    v_mfma_f32_16x16x32_bf16 v[200:203], a[136:139], v[176:179], v[200:203]
    ds_read_b128 a[172:175], v237 offset:3072
    ds_read_b128 a[176:179], v237 offset:16384
    v_mfma_f32_16x16x32_bf16 v[196:199], a[136:139], v[168:171], v[196:199]
    ds_read_b64_tr_b16 a[132:133], v230 offset:20480
    v_mfma_f32_16x16x32_bf16 v[196:199], a[140:143], v[172:175], v[196:199]
    ds_read_b128 a[180:183], v237 offset:17408
    buffer_load_dwordx4 v233, s[12:15], s34 offen offset:1024 nt lds
    v_mfma_f32_16x16x32_bf16 v[192:195], a[140:143], v[164:167], v[192:195]
    ds_read_b64_tr_b16 a[134:135], v230 offset:22528
    v_mfma_f32_16x16x32_bf16 v[192:195], a[136:139], v[160:163], v[192:195]
    s_waitcnt lgkmcnt(8)
    ds_read_b128 a[184:187], v237 offset:18432
    ds_read_b128 a[188:191], v237 offset:19456
    v_mfma_f32_16x16x32_bf16 v[208:211], a[144:147], v[0:3], 0
    ds_read_b64_tr_b16 a[136:137], v230 offset:24576
    v_xor_b32 v236, 0x60, v236
    v_mfma_f32_16x16x32_bf16 v[208:211], a[148:151], v[4:7], v[208:211]
    v_mfma_f32_16x16x32_bf16 v[212:215], a[148:151], v[12:15], 0
    ds_read_b64_tr_b16 a[138:139], v230 offset:26624
    v_mul_f32 v200, v244, v200
    v_mfma_f32_16x16x32_bf16 v[212:215], a[144:147], v[8:11], v[212:215]
    v_mul_f32 v201, v244, v201
    v_mfma_f32_16x16x32_bf16 v[216:219], a[144:147], v[16:19], 0
    ds_read_b64_tr_b16 a[140:141], v230 offset:28672
    v_cvt_pk_bf16_f32 v200, v200, v201
    v_mfma_f32_16x16x32_bf16 v[216:219], a[148:151], v[20:23], v[216:219]
    ds_write_b32 v236, v200 offset:16384
    v_mfma_f32_16x16x32_bf16 v[220:223], a[148:151], v[28:31], 0
    ds_read_b64_tr_b16 a[142:143], v230 offset:30720
    v_mul_f32 v202, v244, v202
    v_mfma_f32_16x16x32_bf16 v[220:223], a[144:147], v[24:27], v[220:223]
    v_mfma_f32_16x16x32_bf16 v[220:223], a[152:155], v[56:59], v[220:223]
    ds_read_b64_tr_b16 a[144:145], v230 offset:32768
    v_mul_f32 v203, v244, v203
    v_mfma_f32_16x16x32_bf16 v[220:223], a[156:159], v[60:63], v[220:223]
    buffer_load_dwordx4 v234, s[12:15], s34 offen offset:2048 nt lds
    v_mfma_f32_16x16x32_bf16 v[216:219], a[156:159], v[52:55], v[216:219]
    ds_read_b64_tr_b16 a[146:147], v230 offset:34816
    v_cvt_pk_bf16_f32 v202, v202, v203
    v_mfma_f32_16x16x32_bf16 v[216:219], a[152:155], v[48:51], v[216:219]
    ds_write_b32 v236, v202 offset:16388
    v_mfma_f32_16x16x32_bf16 v[212:215], a[152:155], v[40:43], v[212:215]
    ds_read_b64_tr_b16 a[148:149], v230 offset:36864
    v_mfma_f32_16x16x32_bf16 v[212:215], a[156:159], v[44:47], v[212:215]
    buffer_load_dwordx4 v235, s[12:15], s34 offen offset:3072 nt lds
    v_mfma_f32_16x16x32_bf16 v[208:211], a[156:159], v[36:39], v[208:211]
    ds_read_b64_tr_b16 a[150:151], v230 offset:38912
    v_mul_f32 v192, v242, v192
    v_mfma_f32_16x16x32_bf16 v[208:211], a[152:155], v[32:35], v[208:211]
    s_waitcnt lgkmcnt(5)
    v_mul_f32 v193, v242, v193
    v_mfma_f32_16x16x32_bf16 v[208:211], a[128:131], v[64:67], v[208:211]
    ds_read_b64_tr_b16 a[152:153], v230 offset:40960
    v_cvt_pk_bf16_f32 v192, v192, v193
    v_mfma_f32_16x16x32_bf16 v[208:211], a[132:135], v[68:71], v[208:211]
    ds_write_b32 v236, v192 offset:0
    v_mfma_f32_16x16x32_bf16 v[212:215], a[132:135], v[76:79], v[212:215]
    ds_read_b64_tr_b16 a[154:155], v230 offset:43008
    v_mfma_f32_16x16x32_bf16 v[212:215], a[128:131], v[72:75], v[212:215]
    buffer_store_dwordx4 a[160:163], v232, s[16:19], s29 offen sc1
    v_mul_f32 v194, v242, v194
    v_mul_f32 v195, v242, v195
    v_mfma_f32_16x16x32_bf16 v[216:219], a[128:131], v[80:83], v[216:219]
    ds_read_b64_tr_b16 a[156:157], v230 offset:45056
    v_cvt_pk_bf16_f32 v194, v194, v195
    v_mfma_f32_16x16x32_bf16 v[216:219], a[132:135], v[84:87], v[216:219]
    ds_write_b32 v236, v194 offset:4
    v_mfma_f32_16x16x32_bf16 v[220:223], a[132:135], v[92:95], v[220:223]
    ds_read_b64_tr_b16 a[158:159], v230 offset:47104
    v_xor_b32 v230, 0x60, v230
    v_mfma_f32_16x16x32_bf16 v[220:223], a[128:131], v[88:91], v[220:223]
    v_xor_b32 v231, 0x60, v231
    v_mfma_f32_16x16x32_bf16 v[220:223], a[136:139], v[120:123], v[220:223]
    ds_read_b64_tr_b16 a[128:129], v230 offset:0
    v_mul_f32 v196, v243, v196
    v_mfma_f32_16x16x32_bf16 v[220:223], a[140:143], v[124:127], v[220:223]
    v_mfma_f32_16x16x32_bf16 v[216:219], a[140:143], v[116:119], v[216:219]
    ds_read_b64_tr_b16 a[130:131], v230 offset:2048
    v_mul_f32 v197, v243, v197
    v_mfma_f32_16x16x32_bf16 v[216:219], a[136:139], v[112:115], v[216:219]
    v_mfma_f32_16x16x32_bf16 v[212:215], a[136:139], v[104:107], v[212:215]
    ds_read_b64_tr_b16 a[132:133], v230 offset:4096
    v_cvt_pk_bf16_f32 v196, v196, v197
    v_mfma_f32_16x16x32_bf16 v[212:215], a[140:143], v[108:111], v[212:215]
    ds_write_b32 v236, v196 offset:2048
    v_mfma_f32_16x16x32_bf16 v[208:211], a[140:143], v[100:103], v[208:211]
    ds_read_b64_tr_b16 a[134:135], v230 offset:6144
    v_mfma_f32_16x16x32_bf16 v[208:211], a[136:139], v[96:99], v[208:211]
    s_waitcnt lgkmcnt(5)
    v_mul_f32 v198, v243, v198
    v_mfma_f32_16x16x32_bf16 v[208:211], a[144:147], v[128:131], v[208:211]
    ds_read_b64_tr_b16 a[136:137], v230 offset:8192
    v_mul_f32 v199, v243, v199
    v_mfma_f32_16x16x32_bf16 v[208:211], a[148:151], v[132:135], v[208:211]
    v_mfma_f32_16x16x32_bf16 v[212:215], a[148:151], v[140:143], v[212:215]
    ds_read_b64_tr_b16 a[138:139], v230 offset:10240
    v_cvt_pk_bf16_f32 v198, v198, v199
    v_mfma_f32_16x16x32_bf16 v[212:215], a[144:147], v[136:139], v[212:215]
    ds_write_b32 v236, v198 offset:2052
    v_mfma_f32_16x16x32_bf16 v[216:219], a[144:147], v[144:147], v[216:219]
    ds_read_b64_tr_b16 a[140:141], v230 offset:12288
    v_mul_f32 v204, v245, v204
    v_mfma_f32_16x16x32_bf16 v[216:219], a[148:151], v[148:151], v[216:219]
    v_mfma_f32_16x16x32_bf16 v[220:223], a[148:151], v[156:159], v[220:223]
    ds_read_b64_tr_b16 a[142:143], v230 offset:14336
    v_mul_f32 v205, v245, v205
    v_mfma_f32_16x16x32_bf16 v[220:223], a[144:147], v[152:155], v[220:223]
    v_mfma_f32_16x16x32_bf16 v[220:223], a[152:155], v[184:187], v[220:223]
    ds_read_b64_tr_b16 a[144:145], v230 offset:16384
    v_cvt_pk_bf16_f32 v204, v204, v205
    v_mfma_f32_16x16x32_bf16 v[220:223], a[156:159], v[188:191], v[220:223]
    ds_write_b32 v236, v204 offset:18432
    v_mfma_f32_16x16x32_bf16 v[216:219], a[156:159], v[180:183], v[216:219]
    ds_read_b64_tr_b16 a[146:147], v230 offset:18432
    v_mul_f32 v206, v245, v206
    v_mfma_f32_16x16x32_bf16 v[216:219], a[152:155], v[176:179], v[216:219]
    buffer_store_dwordx4 a[164:167], v233, s[16:19], s29 offen offset:1024 sc1
    v_accvgpr_write_b32 a192, 0
    v_accvgpr_write_b32 a193, 0
    v_mfma_f32_16x16x32_bf16 v[212:215], a[152:155], v[168:171], v[212:215]
    ds_read_b64_tr_b16 a[148:149], v230 offset:20480
    v_mul_f32 v207, v245, v207
    v_mfma_f32_16x16x32_bf16 v[212:215], a[156:159], v[172:175], v[212:215]
    v_mfma_f32_16x16x32_bf16 v[208:211], a[156:159], v[164:167], v[208:211]
    s_and_b32 s36, s31, 3
    ds_read_b64_tr_b16 a[150:151], v230 offset:22528
    v_cvt_pk_bf16_f32 v206, v206, v207
    v_mfma_f32_16x16x32_bf16 v[208:211], a[152:155], v[160:163], v[208:211]
    s_waitcnt lgkmcnt(5)
    ds_write_b32 v236, v206 offset:18436
    v_mfma_f32_16x16x32_bf16 v[192:195], a[128:131], v[0:3], 0
    s_add_u32 m0, s23, 0x18000
    ds_read_b64_tr_b16 a[152:153], v230 offset:24576
    v_xor_b32 v236, 32, v236
    v_mfma_f32_16x16x32_bf16 v[192:195], a[132:135], v[4:7], v[192:195]
    v_mul_f32 v216, v244, v216
    v_mul_f32 v217, v244, v217
    v_mfma_f32_16x16x32_bf16 v[196:199], a[132:135], v[12:15], 0
    s_xor_b32 s34, s30, 0x4180
    ds_read_b64_tr_b16 a[154:155], v230 offset:26624
    v_cvt_pk_bf16_f32 v216, v216, v217
    v_mfma_f32_16x16x32_bf16 v[196:199], a[128:131], v[8:11], v[196:199]
    ds_write_b32 v236, v216 offset:16384
    v_mfma_f32_16x16x32_bf16 v[200:203], a[128:131], v[16:19], 0
L_hop6:
    s_cbranch_execz L_hopret1
    ds_read_b64_tr_b16 a[156:157], v230 offset:28672
    v_mul_f32 v218, v244, v218
    v_mfma_f32_16x16x32_bf16 v[200:203], a[132:135], v[20:23], v[200:203]
    v_mfma_f32_16x16x32_bf16 v[204:207], a[132:135], v[28:31], 0
    ds_read_b64_tr_b16 a[158:159], v230 offset:30720
    v_mul_f32 v219, v244, v219
    v_mfma_f32_16x16x32_bf16 v[204:207], a[128:131], v[24:27], v[204:207]
    v_accvgpr_write_b32 a194, 0
    v_accvgpr_write_b32 a195, 0
    v_mfma_f32_16x16x32_bf16 v[204:207], a[136:139], v[56:59], v[204:207]
    ds_read_b64_tr_b16 a[128:129], v230 offset:32768
    v_cvt_pk_bf16_f32 v218, v218, v219
    v_mfma_f32_16x16x32_bf16 v[204:207], a[140:143], v[60:63], v[204:207]
    ds_write_b32 v236, v218 offset:16388
    v_mfma_f32_16x16x32_bf16 v[200:203], a[140:143], v[52:55], v[200:203]
    ds_read_b64_tr_b16 a[130:131], v230 offset:34816
    v_mul_f32 v208, v242, v208
    v_mfma_f32_16x16x32_bf16 v[200:203], a[136:139], v[48:51], v[200:203]
    buffer_load_dwordx4 v232, s[4:7], s34 offen nt lds
    v_mfma_f32_16x16x32_bf16 v[196:199], a[136:139], v[40:43], v[196:199]
    ds_read_b64_tr_b16 a[132:133], v230 offset:36864
    v_mul_f32 v209, v242, v209
    v_mfma_f32_16x16x32_bf16 v[196:199], a[140:143], v[44:47], v[196:199]
    v_mfma_f32_16x16x32_bf16 v[192:195], a[140:143], v[36:39], v[192:195]
    s_lshl_b32 s36, s36, 7
    ds_read_b64_tr_b16 a[134:135], v230 offset:38912
    v_cvt_pk_bf16_f32 v208, v208, v209
    v_mfma_f32_16x16x32_bf16 v[192:195], a[136:139], v[32:35], v[192:195]
    s_waitcnt lgkmcnt(5)
    ds_write_b32 v236, v208 offset:0
    v_mfma_f32_16x16x32_bf16 v[192:195], a[144:147], v[64:67], v[192:195]
    ds_read_b64_tr_b16 a[136:137], v230 offset:40960
    v_accvgpr_write_b32 a196, 0
    v_mfma_f32_16x16x32_bf16 v[192:195], a[148:151], v[68:71], v[192:195]
    buffer_store_dwordx4 a[168:171], v234, s[16:19], s29 offen offset:2048 sc1
    v_mul_f32 v210, v242, v210
    v_accvgpr_write_b32 a197, 0
    v_mfma_f32_16x16x32_bf16 v[196:199], a[148:151], v[76:79], v[196:199]
    ds_read_b64_tr_b16 a[138:139], v230 offset:43008
    v_mul_f32 v211, v242, v211
    v_mfma_f32_16x16x32_bf16 v[196:199], a[144:147], v[72:75], v[196:199]
    v_mfma_f32_16x16x32_bf16 v[200:203], a[144:147], v[80:83], v[200:203]
    ds_read_b64_tr_b16 a[140:141], v230 offset:45056
    v_cvt_pk_bf16_f32 v210, v210, v211
    v_mfma_f32_16x16x32_bf16 v[200:203], a[148:151], v[84:87], v[200:203]
    ds_write_b32 v236, v210 offset:4
    v_mfma_f32_16x16x32_bf16 v[204:207], a[148:151], v[92:95], v[204:207]
    ds_read_b64_tr_b16 a[142:143], v230 offset:47104
    v_xor_b32 v230, 32, v230
    v_mfma_f32_16x16x32_bf16 v[204:207], a[144:147], v[88:91], v[204:207]
    v_xor_b32 v231, 32, v231
    v_accvgpr_write_b32 a198, 0
    v_mfma_f32_16x16x32_bf16 v[204:207], a[152:155], v[120:123], v[204:207]
    ds_read_b64_tr_b16 a[144:145], v230 offset:0
    v_mul_f32 v212, v243, v212
    v_mfma_f32_16x16x32_bf16 v[204:207], a[156:159], v[124:127], v[204:207]
    buffer_load_dwordx4 v233, s[4:7], s34 offen offset:1024 nt lds
    v_mfma_f32_16x16x32_bf16 v[200:203], a[156:159], v[116:119], v[200:203]
    ds_read_b64_tr_b16 a[146:147], v230 offset:2048
    v_mul_f32 v213, v243, v213
    v_mfma_f32_16x16x32_bf16 v[200:203], a[152:155], v[112:115], v[200:203]
    v_mfma_f32_16x16x32_bf16 v[196:199], a[152:155], v[104:107], v[196:199]
    ds_read_b64_tr_b16 a[148:149], v230 offset:4096
    v_cvt_pk_bf16_f32 v212, v212, v213
    v_mfma_f32_16x16x32_bf16 v[196:199], a[156:159], v[108:111], v[196:199]
    ds_write_b32 v236, v212 offset:2048
    v_mfma_f32_16x16x32_bf16 v[192:195], a[156:159], v[100:103], v[192:195]
    s_lshl2_add_u32 s38, s23, s27
    ds_read_b64_tr_b16 a[150:151], v230 offset:6144
    v_accvgpr_write_b32 a199, 0
    v_mfma_f32_16x16x32_bf16 v[192:195], a[152:155], v[96:99], v[192:195]
    s_waitcnt lgkmcnt(5)
    v_mul_f32 v214, v243, v214
    v_mul_f32 v215, v243, v215
    v_mfma_f32_16x16x32_bf16 v[192:195], a[128:131], v[128:131], v[192:195]
    ds_read_b64_tr_b16 a[152:153], v230 offset:8192
    v_cvt_pk_bf16_f32 v214, v214, v215
    v_mfma_f32_16x16x32_bf16 v[192:195], a[132:135], v[132:135], v[192:195]
    ds_write_b32 v236, v214 offset:2052
    v_mfma_f32_16x16x32_bf16 v[196:199], a[132:135], v[140:143], v[196:199]
    ds_read_b64_tr_b16 a[154:155], v230 offset:10240
    v_mul_f32 v220, v245, v220
    v_mfma_f32_16x16x32_bf16 v[196:199], a[128:131], v[136:139], v[196:199]
    v_mfma_f32_16x16x32_bf16 v[200:203], a[128:131], v[144:147], v[200:203]
    ds_read_b64_tr_b16 a[156:157], v230 offset:12288
    v_mul_f32 v221, v245, v221
    v_mfma_f32_16x16x32_bf16 v[200:203], a[132:135], v[148:151], v[200:203]
    v_mfma_f32_16x16x32_bf16 v[204:207], a[132:135], v[156:159], v[204:207]
    ds_read_b64_tr_b16 a[158:159], v230 offset:14336
    v_cvt_pk_bf16_f32 v220, v220, v221
    v_mfma_f32_16x16x32_bf16 v[204:207], a[128:131], v[152:155], v[204:207]
    ds_write_b32 v236, v220 offset:18432
    v_mfma_f32_16x16x32_bf16 v[204:207], a[136:139], v[184:187], v[204:207]
    s_add_u32 m0, s23, 0x14000
    ds_read_b64_tr_b16 a[128:129], v230 offset:16384
    v_accvgpr_write_b32 a200, 0
    v_mfma_f32_16x16x32_bf16 v[204:207], a[140:143], v[188:191], v[204:207]
    buffer_store_dwordx4 a[172:175], v235, s[16:19], s29 offen offset:3072 sc1
    v_accvgpr_write_b32 a201, 0
    v_mfma_f32_16x16x32_bf16 v[200:203], a[140:143], v[180:183], v[200:203]
    s_add_u32 s34, s28, 0
    ds_read_b64_tr_b16 a[130:131], v230 offset:18432
    v_mul_f32 v222, v245, v222
    v_mfma_f32_16x16x32_bf16 v[200:203], a[136:139], v[176:179], v[200:203]
    v_mfma_f32_16x16x32_bf16 v[196:199], a[136:139], v[168:171], v[196:199]
    ds_read_b64_tr_b16 a[132:133], v230 offset:20480
    v_mul_f32 v223, v245, v223
    v_mfma_f32_16x16x32_bf16 v[196:199], a[140:143], v[172:175], v[196:199]
    s_add_u32 s40, s38, s36
    v_accvgpr_write_b32 a202, 0
    v_mfma_f32_16x16x32_bf16 v[192:195], a[140:143], v[164:167], v[192:195]
    ds_read_b64_tr_b16 a[134:135], v230 offset:22528
    v_cvt_pk_bf16_f32 v222, v222, v223
    v_mfma_f32_16x16x32_bf16 v[192:195], a[136:139], v[160:163], v[192:195]
    s_waitcnt lgkmcnt(5)
    ds_write_b32 v236, v222 offset:18436
    v_mfma_f32_16x16x32_bf16 v[208:211], a[144:147], v[0:3], 0
    ds_read_b64_tr_b16 a[136:137], v230 offset:24576
    v_xor_b32 v236, 0x60, v236
    v_mfma_f32_16x16x32_bf16 v[208:211], a[148:151], v[4:7], v[208:211]
    buffer_load_dwordx4 v232, s[8:11], s34 offen nt lds
    v_mfma_f32_16x16x32_bf16 v[212:215], a[148:151], v[12:15], 0
    ds_read_b64_tr_b16 a[138:139], v230 offset:26624
    v_mul_f32 v200, v244, v200
    v_mfma_f32_16x16x32_bf16 v[212:215], a[144:147], v[8:11], v[212:215]
    v_mfma_f32_16x16x32_bf16 v[216:219], a[144:147], v[16:19], 0
    ds_read_b64_tr_b16 a[140:141], v230 offset:28672
    v_mul_f32 v201, v244, v201
    v_mfma_f32_16x16x32_bf16 v[216:219], a[148:151], v[20:23], v[216:219]
    v_mfma_f32_16x16x32_bf16 v[220:223], a[148:151], v[28:31], 0
    s_add_u32 s35, s29, 0x4000
    ds_read_b64_tr_b16 a[142:143], v230 offset:30720
    v_cvt_pk_bf16_f32 v200, v200, v201
    v_mfma_f32_16x16x32_bf16 v[220:223], a[144:147], v[24:27], v[220:223]
    ds_write_b32 v236, v200 offset:16384
    v_mfma_f32_16x16x32_bf16 v[220:223], a[152:155], v[56:59], v[220:223]
    ds_read_b64_tr_b16 a[144:145], v230 offset:32768
    v_mul_f32 v202, v244, v202
    v_mfma_f32_16x16x32_bf16 v[220:223], a[156:159], v[60:63], v[220:223]
    v_mul_f32 v203, v244, v203
    v_accvgpr_write_b32 a203, 0
    v_mfma_f32_16x16x32_bf16 v[216:219], a[156:159], v[52:55], v[216:219]
    ds_read_b64_tr_b16 a[146:147], v230 offset:34816
    v_cvt_pk_bf16_f32 v202, v202, v203
    v_mfma_f32_16x16x32_bf16 v[216:219], a[152:155], v[48:51], v[216:219]
    ds_write_b32 v236, v202 offset:16388
    v_mfma_f32_16x16x32_bf16 v[212:215], a[152:155], v[40:43], v[212:215]
    s_add_u32 s44, s37, s36
    ds_read_b64_tr_b16 a[148:149], v230 offset:36864
    v_accvgpr_write_b32 a204, 0
    v_mfma_f32_16x16x32_bf16 v[212:215], a[156:159], v[44:47], v[212:215]
    buffer_load_dwordx4 v233, s[8:11], s34 offen offset:1024 nt lds
    v_mfma_f32_16x16x32_bf16 v[208:211], a[156:159], v[36:39], v[208:211]
    ds_read_b64_tr_b16 a[150:151], v230 offset:38912
    v_mul_f32 v192, v242, v192
    v_mfma_f32_16x16x32_bf16 v[208:211], a[152:155], v[32:35], v[208:211]
    s_waitcnt lgkmcnt(6)
    v_mul_f32 v193, v242, v193
    v_accvgpr_write_b32 a205, 0
    v_mfma_f32_16x16x32_bf16 v[208:211], a[128:131], v[64:67], v[208:211]
    ds_read_b64_tr_b16 a[152:153], v230 offset:40960
    v_cvt_pk_bf16_f32 v192, v192, v193
    v_mfma_f32_16x16x32_bf16 v[208:211], a[132:135], v[68:71], v[208:211]
    ds_write_b32 v236, v192 offset:0
    v_mfma_f32_16x16x32_bf16 v[212:215], a[132:135], v[76:79], v[212:215]
    ds_read_b64_tr_b16 a[154:155], v230 offset:43008
    v_mfma_f32_16x16x32_bf16 v[212:215], a[128:131], v[72:75], v[212:215]
    buffer_store_dwordx4 a[176:179], v232, s[16:19], s35 offen sc1
    v_mul_f32 v194, v242, v194
    v_mul_f32 v195, v242, v195
    v_accvgpr_write_b32 a206, 0
    v_accvgpr_write_b32 a207, 0
    v_mfma_f32_16x16x32_bf16 v[216:219], a[128:131], v[80:83], v[216:219]
    ds_read_b64_tr_b16 a[156:157], v230 offset:45056
    v_cvt_pk_bf16_f32 v194, v194, v195
    v_mfma_f32_16x16x32_bf16 v[216:219], a[132:135], v[84:87], v[216:219]
    ds_write_b32 v236, v194 offset:4
    v_mfma_f32_16x16x32_bf16 v[220:223], a[132:135], v[92:95], v[220:223]
    ds_read_b64_tr_b16 a[158:159], v230 offset:47104
    v_xor_b32 v230, 0x60, v230
    v_mfma_f32_16x16x32_bf16 v[220:223], a[128:131], v[88:91], v[220:223]
    v_xor_b32 v231, 0x60, v231
    v_mul_f32 v196, v243, v196
    v_mfma_f32_16x16x32_bf16 v[220:223], a[136:139], v[120:123], v[220:223]
    v_mfma_f32_16x16x32_bf16 v[220:223], a[140:143], v[124:127], v[220:223]
    v_mfma_f32_16x16x32_bf16 v[216:219], a[140:143], v[116:119], v[216:219]
    v_mfma_f32_16x16x32_bf16 v[216:219], a[136:139], v[112:115], v[216:219]
    buffer_load_dwordx4 v234, s[8:11], s34 offen offset:2048 nt lds
    v_mfma_f32_16x16x32_bf16 v[212:215], a[136:139], v[104:107], v[212:215]
    s_xor_b32 s41, s40, 0x80
    v_mul_f32 v197, v243, v197
    v_cvt_pk_bf16_f32 v196, v196, v197
    v_mfma_f32_16x16x32_bf16 v[212:215], a[140:143], v[108:111], v[212:215]
    ds_write_b32 v236, v196 offset:2048
    v_mfma_f32_16x16x32_bf16 v[208:211], a[140:143], v[100:103], v[208:211]
    v_mfma_f32_16x16x32_bf16 v[208:211], a[136:139], v[96:99], v[208:211]
    s_waitcnt vmcnt(10) lgkmcnt(1)
    s_barrier
    v_mfma_f32_16x16x32_bf16 v[208:211], a[144:147], v[128:131], v[208:211]
    ds_read_b64_tr_b16 a[128:129], v231 offset:49152
    v_mul_f32 v198, v243, v198
    v_mfma_f32_16x16x32_bf16 v[208:211], a[148:151], v[132:135], v[208:211]
    ds_read_b64_tr_b16 a[130:131], v231 offset:51200
    v_mul_f32 v199, v243, v199
    v_mfma_f32_16x16x32_bf16 v[212:215], a[148:151], v[140:143], v[212:215]
    ds_read_b64_tr_b16 a[132:133], v231 offset:53248
    v_cvt_pk_bf16_f32 v198, v198, v199
    v_mfma_f32_16x16x32_bf16 v[212:215], a[144:147], v[136:139], v[212:215]
    ds_read_b64_tr_b16 a[134:135], v231 offset:55296
    ds_write_b32 v236, v198 offset:2052
    v_mfma_f32_16x16x32_bf16 v[216:219], a[144:147], v[144:147], v[216:219]
    ds_read_b64_tr_b16 a[136:137], v231 offset:57344
    v_mfma_f32_16x16x32_bf16 v[216:219], a[148:151], v[148:151], v[216:219]
    ds_read_b64_tr_b16 a[138:139], v231 offset:59392
    v_mul_f32 v204, v245, v204
    v_mfma_f32_16x16x32_bf16 v[220:223], a[148:151], v[156:159], v[220:223]
    ds_read_b64_tr_b16 a[140:141], v231 offset:61440
    v_mul_f32 v205, v245, v205
    v_mfma_f32_16x16x32_bf16 v[220:223], a[144:147], v[152:155], v[220:223]
    ds_read_b64_tr_b16 a[142:143], v231 offset:63488
    v_mfma_f32_16x16x32_bf16 v[220:223], a[152:155], v[184:187], v[220:223]
    ds_read_b64_tr_b16 a[144:145], v230 offset:49152
    v_cvt_pk_bf16_f32 v204, v204, v205
    v_mfma_f32_16x16x32_bf16 v[220:223], a[156:159], v[188:191], v[220:223]
    buffer_store_dwordx4 a[180:183], v233, s[16:19], s35 offen offset:1024 sc1
    v_mfma_f32_16x16x32_bf16 v[216:219], a[156:159], v[180:183], v[216:219]
    ds_read_b64_tr_b16 a[146:147], v230 offset:51200
    v_mfma_f32_16x16x32_bf16 v[216:219], a[152:155], v[176:179], v[216:219]
    s_xor_b32 s45, s44, 0x80
    ds_write_b32 v236, v204 offset:18432
    v_mul_f32 v206, v245, v206
    v_mfma_f32_16x16x32_bf16 v[212:215], a[152:155], v[168:171], v[212:215]
    ds_read_b64_tr_b16 a[148:149], v230 offset:53248
    v_mul_f32 v207, v245, v207
    v_mfma_f32_16x16x32_bf16 v[212:215], a[156:159], v[172:175], v[212:215]
    buffer_load_dwordx4 v235, s[8:11], s34 offen offset:3072 nt lds
    v_mfma_f32_16x16x32_bf16 v[208:211], a[156:159], v[164:167], v[208:211]
    ds_read_b64_tr_b16 a[150:151], v230 offset:55296
    v_cvt_pk_bf16_f32 v206, v206, v207
    v_mfma_f32_16x16x32_bf16 v[208:211], a[152:155], v[160:163], v[208:211]
    s_waitcnt lgkmcnt(5)
    ds_write_b32 v236, v206 offset:18436
    v_mfma_f32_16x16x32_bf16 v[192:195], a[128:131], v[0:3], 0
    ds_read_b64_tr_b16 a[152:153], v230 offset:57344
    v_xor_b32 v236, 32, v236
    v_mfma_f32_16x16x32_bf16 v[192:195], a[132:135], v[4:7], v[192:195]
    v_mfma_f32_16x16x32_bf16 v[196:199], a[132:135], v[12:15], 0
    ds_read_b64_tr_b16 a[154:155], v230 offset:59392
    v_mul_f32 v216, v244, v216
    v_mfma_f32_16x16x32_bf16 v[196:199], a[128:131], v[8:11], v[196:199]
    v_mfma_f32_16x16x32_bf16 v[200:203], a[128:131], v[16:19], 0
    ds_read_b64_tr_b16 a[156:157], v230 offset:61440
    v_mul_f32 v217, v244, v217
    v_mfma_f32_16x16x32_bf16 v[200:203], a[132:135], v[20:23], v[200:203]
    v_mul_f32 v218, v244, v218
    v_mul_f32 v219, v244, v219
    v_mfma_f32_16x16x32_bf16 v[204:207], a[132:135], v[28:31], 0
    ds_read_b64_tr_b16 a[158:159], v230 offset:63488
    v_cvt_pk_bf16_f32 v216, v216, v217
    v_mfma_f32_16x16x32_bf16 v[204:207], a[128:131], v[24:27], v[204:207]
    v_mfma_f32_16x16x32_bf16 v[204:207], a[136:139], v[56:59], v[204:207]
    ds_read_b64_tr_b16 a[128:129], v231 offset:0
    v_cvt_pk_bf16_f32 v217, v218, v219
    v_mfma_f32_16x16x32_bf16 v[204:207], a[140:143], v[60:63], v[204:207]
    ds_write_b64 v236, v[216:217] offset:16384
    v_mfma_f32_16x16x32_bf16 v[200:203], a[140:143], v[52:55], v[200:203]
    s_xor_b32 s42, s40, 0x100
    ds_read_b64_tr_b16 a[130:131], v231 offset:2048
    v_mfma_f32_16x16x32_bf16 v[200:203], a[136:139], v[48:51], v[200:203]
    v_mul_f32 v208, v242, v208
    v_mul_f32 v209, v242, v209
    v_mfma_f32_16x16x32_bf16 v[196:199], a[136:139], v[40:43], v[196:199]
    ds_read_b64_tr_b16 a[132:133], v231 offset:4096
    v_mul_f32 v210, v242, v210
    v_mfma_f32_16x16x32_bf16 v[196:199], a[140:143], v[44:47], v[196:199]
    v_mul_f32 v211, v242, v211
    v_cvt_pk_bf16_f32 v208, v208, v209
    v_mfma_f32_16x16x32_bf16 v[192:195], a[140:143], v[36:39], v[192:195]
    ds_read_b64_tr_b16 a[134:135], v231 offset:6144
    v_cvt_pk_bf16_f32 v209, v210, v211
    v_mfma_f32_16x16x32_bf16 v[192:195], a[136:139], v[32:35], v[192:195]
    s_waitcnt lgkmcnt(5)
    ds_write_b64 v236, v[208:209] offset:0
    v_mfma_f32_16x16x32_bf16 v[192:195], a[144:147], v[64:67], v[192:195]
    ds_read_b64_tr_b16 a[136:137], v231 offset:8192
    v_mfma_f32_16x16x32_bf16 v[192:195], a[148:151], v[68:71], v[192:195]
    s_add_u32 m0, s23, 0x18000
    buffer_store_dwordx4 a[184:187], v234, s[16:19], s35 offen offset:2048 sc1
    v_mfma_f32_16x16x32_bf16 v[196:199], a[148:151], v[76:79], v[196:199]
    ds_read_b64_tr_b16 a[138:139], v231 offset:10240
    v_mul_f32 v212, v243, v212
    v_mfma_f32_16x16x32_bf16 v[196:199], a[144:147], v[72:75], v[196:199]
    s_xor_b32 s34, s30, 0x4180
    v_mul_f32 v213, v243, v213
    v_mul_f32 v214, v243, v214
    v_mfma_f32_16x16x32_bf16 v[200:203], a[144:147], v[80:83], v[200:203]
    ds_read_b64_tr_b16 a[140:141], v231 offset:12288
    v_mul_f32 v215, v243, v215
    v_mfma_f32_16x16x32_bf16 v[200:203], a[148:151], v[84:87], v[200:203]
    v_mfma_f32_16x16x32_bf16 v[204:207], a[148:151], v[92:95], v[204:207]
    ds_read_b64_tr_b16 a[142:143], v231 offset:14336
    v_xor_b32 v230, 32, v230
    v_mfma_f32_16x16x32_bf16 v[204:207], a[144:147], v[88:91], v[204:207]
    v_xor_b32 v231, 32, v231
    v_cvt_pk_bf16_f32 v212, v212, v213
    v_mfma_f32_16x16x32_bf16 v[204:207], a[152:155], v[120:123], v[204:207]
    ds_read_b64_tr_b16 a[144:145], v231 offset:49152
    v_cvt_pk_bf16_f32 v213, v214, v215
    v_mfma_f32_16x16x32_bf16 v[204:207], a[156:159], v[124:127], v[204:207]
    s_xor_b32 s46, s44, 0x100
    ds_write_b64 v236, v[212:213] offset:2048
    v_mfma_f32_16x16x32_bf16 v[200:203], a[156:159], v[116:119], v[200:203]
    ds_read_b64_tr_b16 a[146:147], v231 offset:51200
    v_mul_f32 v220, v245, v220
    v_mfma_f32_16x16x32_bf16 v[200:203], a[152:155], v[112:115], v[200:203]
    v_mfma_f32_16x16x32_bf16 v[196:199], a[152:155], v[104:107], v[196:199]
    ds_read_b64_tr_b16 a[148:149], v231 offset:53248
    v_mul_f32 v221, v245, v221
    v_mfma_f32_16x16x32_bf16 v[196:199], a[156:159], v[108:111], v[196:199]
    buffer_load_dwordx4 v234, s[4:7], s34 offen offset:2048 nt lds
    v_mfma_f32_16x16x32_bf16 v[192:195], a[156:159], v[100:103], v[192:195]
    ds_read_b64_tr_b16 a[150:151], v231 offset:55296
    v_mul_f32 v222, v245, v222
    v_mfma_f32_16x16x32_bf16 v[192:195], a[152:155], v[96:99], v[192:195]
    s_waitcnt lgkmcnt(5)
    v_mul_f32 v223, v245, v223
    v_cvt_pk_bf16_f32 v220, v220, v221
    v_mfma_f32_16x16x32_bf16 v[192:195], a[128:131], v[128:131], v[192:195]
    ds_read_b64_tr_b16 a[152:153], v231 offset:57344
    v_cvt_pk_bf16_f32 v221, v222, v223
    v_mfma_f32_16x16x32_bf16 v[192:195], a[132:135], v[132:135], v[192:195]
    ds_write_b64 v236, v[220:221] offset:18432
    v_mfma_f32_16x16x32_bf16 v[196:199], a[132:135], v[140:143], v[196:199]
    ds_read_b64_tr_b16 a[154:155], v231 offset:59392
    v_mfma_f32_16x16x32_bf16 v[196:199], a[128:131], v[136:139], v[196:199]
    ds_read_b128 a[212:215], v237 offset:0
    v_mfma_f32_16x16x32_bf16 v[200:203], a[128:131], v[144:147], v[200:203]
    ds_read_b64_tr_b16 a[156:157], v231 offset:61440
    v_mfma_f32_16x16x32_bf16 v[200:203], a[132:135], v[148:151], v[200:203]
    ds_read_b128 a[216:219], v237 offset:1024
    v_mfma_f32_16x16x32_bf16 v[204:207], a[132:135], v[156:159], v[204:207]
    ds_read_b64_tr_b16 a[158:159], v231 offset:63488
    v_mfma_f32_16x16x32_bf16 v[204:207], a[128:131], v[152:155], v[204:207]
    ds_read_b128 a[220:223], v237 offset:2048
    v_mfma_f32_16x16x32_bf16 v[204:207], a[136:139], v[184:187], v[204:207]
    ds_read_b64_tr_b16 a[128:129], v230 offset:49152
    v_mfma_f32_16x16x32_bf16 v[204:207], a[140:143], v[188:191], v[204:207]
    s_xor_b32 s43, s40, 0x180
    buffer_store_dwordx4 a[188:191], v235, s[16:19], s35 offen offset:3072 sc1
    v_mfma_f32_16x16x32_bf16 v[200:203], a[140:143], v[180:183], v[200:203]
    ds_read_b64_tr_b16 a[130:131], v230 offset:51200
    v_mfma_f32_16x16x32_bf16 v[200:203], a[136:139], v[176:179], v[200:203]
    ds_read_b128 a[224:227], v237 offset:3072
    ds_read_b128 a[228:231], v237 offset:16384
    v_mfma_f32_16x16x32_bf16 v[196:199], a[136:139], v[168:171], v[196:199]
    ds_read_b64_tr_b16 a[132:133], v230 offset:53248
    v_mfma_f32_16x16x32_bf16 v[196:199], a[140:143], v[172:175], v[196:199]
    ds_read_b128 a[232:235], v237 offset:17408
    ds_read_b128 a[236:239], v237 offset:18432
    v_mfma_f32_16x16x32_bf16 v[192:195], a[140:143], v[164:167], v[192:195]
    ds_read_b64_tr_b16 a[134:135], v230 offset:55296
    v_mfma_f32_16x16x32_bf16 v[192:195], a[136:139], v[160:163], v[192:195]
    s_waitcnt lgkmcnt(9)
    ds_read_b128 a[240:243], v237 offset:19456
    buffer_load_dwordx4 v235, s[4:7], s34 offen offset:3072 nt lds
    v_mfma_f32_16x16x32_bf16 v[208:211], a[144:147], v[0:3], 0
    ds_read_b64_tr_b16 a[136:137], v230 offset:57344
    v_xor_b32 v236, 0x60, v236
    v_mfma_f32_16x16x32_bf16 v[208:211], a[148:151], v[4:7], v[208:211]
    v_mfma_f32_16x16x32_bf16 v[212:215], a[148:151], v[12:15], 0
    ds_read_b64_tr_b16 a[138:139], v230 offset:59392
    v_mul_f32 v200, v244, v200
    v_mfma_f32_16x16x32_bf16 v[212:215], a[144:147], v[8:11], v[212:215]
    v_mfma_f32_16x16x32_bf16 v[216:219], a[144:147], v[16:19], 0
    ds_read_b64_tr_b16 a[140:141], v230 offset:61440
    v_mul_f32 v201, v244, v201
    v_mfma_f32_16x16x32_bf16 v[216:219], a[148:151], v[20:23], v[216:219]
    v_mfma_f32_16x16x32_bf16 v[220:223], a[148:151], v[28:31], 0
    ds_read_b64_tr_b16 a[142:143], v230 offset:63488
    v_cvt_pk_bf16_f32 v200, v200, v201
    v_mfma_f32_16x16x32_bf16 v[220:223], a[144:147], v[24:27], v[220:223]
    ds_write_b32 v236, v200 offset:16384
    v_mfma_f32_16x16x32_bf16 v[220:223], a[152:155], v[56:59], v[220:223]
    s_xor_b32 s47, s44, 0x180
    ds_read_b64_tr_b16 a[144:145], v231 offset:0
    v_mul_f32 v202, v244, v202
    v_mfma_f32_16x16x32_bf16 v[220:223], a[156:159], v[60:63], v[220:223]
    v_mfma_f32_16x16x32_bf16 v[216:219], a[156:159], v[52:55], v[216:219]
    ds_read_b64_tr_b16 a[146:147], v231 offset:2048
    v_mul_f32 v203, v244, v203
    v_mfma_f32_16x16x32_bf16 v[216:219], a[152:155], v[48:51], v[216:219]
    v_mfma_f32_16x16x32_bf16 v[212:215], a[152:155], v[40:43], v[212:215]
    ds_read_b64_tr_b16 a[148:149], v231 offset:4096
    v_cvt_pk_bf16_f32 v202, v202, v203
    v_mfma_f32_16x16x32_bf16 v[212:215], a[156:159], v[44:47], v[212:215]
    ds_write_b32 v236, v202 offset:16388
    v_mfma_f32_16x16x32_bf16 v[208:211], a[156:159], v[36:39], v[208:211]
    ds_read_b64_tr_b16 a[150:151], v231 offset:6144
    v_mul_f32 v192, v242, v192
    v_mfma_f32_16x16x32_bf16 v[208:211], a[152:155], v[32:35], v[208:211]
    s_waitcnt lgkmcnt(6)
    v_mul_f32 v193, v242, v193
    v_mfma_f32_16x16x32_bf16 v[208:211], a[128:131], v[64:67], v[208:211]
    s_add_u32 m0, s23, 0
    ds_read_b64_tr_b16 a[152:153], v231 offset:8192
    v_cvt_pk_bf16_f32 v192, v192, v193
    v_mfma_f32_16x16x32_bf16 v[208:211], a[132:135], v[68:71], v[208:211]
    ds_write_b32 v236, v192 offset:0
    v_mfma_f32_16x16x32_bf16 v[212:215], a[132:135], v[76:79], v[212:215]
    s_add_u32 s34, s28, 0x4000
    ds_read_b64_tr_b16 a[154:155], v231 offset:10240
    v_mfma_f32_16x16x32_bf16 v[212:215], a[128:131], v[72:75], v[212:215]
    buffer_store_dwordx4 a[212:215], v232, s[16:19], s32 offen sc1
    v_mul_f32 v194, v242, v194
    v_mul_f32 v195, v242, v195
    v_mfma_f32_16x16x32_bf16 v[216:219], a[128:131], v[80:83], v[216:219]
    ds_read_b64_tr_b16 a[156:157], v231 offset:12288
    v_cvt_pk_bf16_f32 v194, v194, v195
    v_mfma_f32_16x16x32_bf16 v[216:219], a[132:135], v[84:87], v[216:219]
    ds_write_b32 v236, v194 offset:4
    v_mfma_f32_16x16x32_bf16 v[220:223], a[132:135], v[92:95], v[220:223]
    ds_read_b64_tr_b16 a[158:159], v231 offset:14336
    v_xor_b32 v230, 0x60, v230
    v_mfma_f32_16x16x32_bf16 v[220:223], a[128:131], v[88:91], v[220:223]
    v_xor_b32 v231, 0x60, v231
    v_mfma_f32_16x16x32_bf16 v[220:223], a[136:139], v[120:123], v[220:223]
    ds_read_b64_tr_b16 a[128:129], v231 offset:49152
    v_mul_f32 v196, v243, v196
    v_mfma_f32_16x16x32_bf16 v[220:223], a[140:143], v[124:127], v[220:223]
    buffer_load_dwordx4 v232, s[8:11], s34 offen nt lds
    v_mfma_f32_16x16x32_bf16 v[216:219], a[140:143], v[116:119], v[216:219]
    ds_read_b64_tr_b16 a[130:131], v231 offset:51200
    v_mul_f32 v197, v243, v197
    v_mfma_f32_16x16x32_bf16 v[216:219], a[136:139], v[112:115], v[216:219]
    v_mfma_f32_16x16x32_bf16 v[212:215], a[136:139], v[104:107], v[212:215]
    ds_read_b64_tr_b16 a[132:133], v231 offset:53248
    v_cvt_pk_bf16_f32 v196, v196, v197
    v_mfma_f32_16x16x32_bf16 v[212:215], a[140:143], v[108:111], v[212:215]
    ds_write_b32 v236, v196 offset:2048
    v_mfma_f32_16x16x32_bf16 v[208:211], a[140:143], v[100:103], v[208:211]
    ds_read_b64_tr_b16 a[134:135], v231 offset:55296
    v_mfma_f32_16x16x32_bf16 v[208:211], a[136:139], v[96:99], v[208:211]
    s_waitcnt lgkmcnt(5)
    v_mul_f32 v198, v243, v198
    v_mul_f32 v199, v243, v199
    v_mfma_f32_16x16x32_bf16 v[208:211], a[144:147], v[128:131], v[208:211]
    ds_read_b64_tr_b16 a[136:137], v231 offset:57344
    v_cvt_pk_bf16_f32 v198, v198, v199
    v_mfma_f32_16x16x32_bf16 v[208:211], a[148:151], v[132:135], v[208:211]
    ds_write_b32 v236, v198 offset:2052
    v_mfma_f32_16x16x32_bf16 v[212:215], a[148:151], v[140:143], v[212:215]
    s_lshl_b32 s30, s54, 17
    ds_read_b64_tr_b16 a[138:139], v231 offset:59392
    v_mul_f32 v204, v245, v204
    v_mfma_f32_16x16x32_bf16 v[212:215], a[144:147], v[136:139], v[212:215]
    v_mfma_f32_16x16x32_bf16 v[216:219], a[144:147], v[144:147], v[216:219]
    ds_read_b64_tr_b16 a[140:141], v231 offset:61440
    v_mul_f32 v205, v245, v205
    v_mfma_f32_16x16x32_bf16 v[216:219], a[148:151], v[148:151], v[216:219]
    buffer_load_dwordx4 v233, s[8:11], s34 offen offset:1024 nt lds
    v_mfma_f32_16x16x32_bf16 v[220:223], a[148:151], v[156:159], v[220:223]
    ds_read_b64_tr_b16 a[142:143], v231 offset:63488
    v_cvt_pk_bf16_f32 v204, v204, v205
    v_mfma_f32_16x16x32_bf16 v[220:223], a[144:147], v[152:155], v[220:223]
    ds_write_b32 v236, v204 offset:18432
    v_mfma_f32_16x16x32_bf16 v[220:223], a[152:155], v[184:187], v[220:223]
    ds_read_b64_tr_b16 a[144:145], v230 offset:49152
    v_mfma_f32_16x16x32_bf16 v[220:223], a[156:159], v[188:191], v[220:223]
    buffer_store_dwordx4 a[216:219], v233, s[16:19], s32 offen offset:1024 sc1
    v_mfma_f32_16x16x32_bf16 v[216:219], a[156:159], v[180:183], v[216:219]
    ds_read_b64_tr_b16 a[146:147], v230 offset:51200
    v_mul_f32 v206, v245, v206
    v_mfma_f32_16x16x32_bf16 v[216:219], a[152:155], v[176:179], v[216:219]
    v_mfma_f32_16x16x32_bf16 v[212:215], a[152:155], v[168:171], v[212:215]
    ds_read_b64_tr_b16 a[148:149], v230 offset:53248
    v_mul_f32 v207, v245, v207
    v_mfma_f32_16x16x32_bf16 v[212:215], a[156:159], v[172:175], v[212:215]
    v_mfma_f32_16x16x32_bf16 v[208:211], a[156:159], v[164:167], v[208:211]
    ds_read_b64_tr_b16 a[150:151], v230 offset:55296
    v_cvt_pk_bf16_f32 v206, v206, v207
    v_mfma_f32_16x16x32_bf16 v[208:211], a[152:155], v[160:163], v[208:211]
    s_waitcnt lgkmcnt(5)
    ds_write_b32 v236, v206 offset:18436
    v_mfma_f32_16x16x32_bf16 v[192:195], a[128:131], v[0:3], 0
    ds_read_b64_tr_b16 a[152:153], v230 offset:57344
    v_xor_b32 v236, 32, v236
    v_mfma_f32_16x16x32_bf16 v[192:195], a[132:135], v[4:7], v[192:195]
    v_mfma_f32_16x16x32_bf16 v[196:199], a[132:135], v[12:15], 0
    ds_read_b64_tr_b16 a[154:155], v230 offset:59392
    v_mul_f32 v216, v244, v216
    v_mfma_f32_16x16x32_bf16 v[196:199], a[128:131], v[8:11], v[196:199]
    buffer_load_dwordx4 v234, s[8:11], s34 offen offset:2048 nt lds
    v_mfma_f32_16x16x32_bf16 v[200:203], a[128:131], v[16:19], 0
    ds_read_b64_tr_b16 a[156:157], v230 offset:61440
    v_mul_f32 v217, v244, v217
    v_mfma_f32_16x16x32_bf16 v[200:203], a[132:135], v[20:23], v[200:203]
    v_mfma_f32_16x16x32_bf16 v[204:207], a[132:135], v[28:31], 0
    ds_read_b64_tr_b16 a[158:159], v230 offset:63488
    v_cvt_pk_bf16_f32 v216, v216, v217
    v_mfma_f32_16x16x32_bf16 v[204:207], a[128:131], v[24:27], v[204:207]
    ds_write_b32 v236, v216 offset:16384
    v_mfma_f32_16x16x32_bf16 v[204:207], a[136:139], v[56:59], v[204:207]
    ds_read_b64_tr_b16 a[128:129], v231 offset:0
    v_mul_f32 v218, v244, v218
    v_mfma_f32_16x16x32_bf16 v[204:207], a[140:143], v[60:63], v[204:207]
    v_mfma_f32_16x16x32_bf16 v[200:203], a[140:143], v[52:55], v[200:203]
    ds_read_b64_tr_b16 a[130:131], v231 offset:2048
    v_mul_f32 v219, v244, v219
    v_mfma_f32_16x16x32_bf16 v[200:203], a[136:139], v[48:51], v[200:203]
    v_mfma_f32_16x16x32_bf16 v[196:199], a[136:139], v[40:43], v[196:199]
    ds_read_b64_tr_b16 a[132:133], v231 offset:4096
    v_cvt_pk_bf16_f32 v218, v218, v219
    v_mfma_f32_16x16x32_bf16 v[196:199], a[140:143], v[44:47], v[196:199]
    buffer_load_dwordx4 v235, s[8:11], s34 offen offset:3072 nt lds
    v_mfma_f32_16x16x32_bf16 v[192:195], a[140:143], v[36:39], v[192:195]
    ds_read_b64_tr_b16 a[134:135], v231 offset:6144
    v_mfma_f32_16x16x32_bf16 v[192:195], a[136:139], v[32:35], v[192:195]
    s_waitcnt lgkmcnt(5)
    ds_write_b32 v236, v218 offset:16388
    v_mfma_f32_16x16x32_bf16 v[192:195], a[144:147], v[64:67], v[192:195]
    ds_read_b64_tr_b16 a[136:137], v231 offset:8192
    v_mul_f32 v208, v242, v208
    v_mfma_f32_16x16x32_bf16 v[192:195], a[148:151], v[68:71], v[192:195]
    buffer_store_dwordx4 a[220:223], v234, s[16:19], s32 offen offset:2048 sc1
    v_mul_f32 v209, v242, v209
    v_cvt_pk_bf16_f32 v208, v208, v209
    v_mfma_f32_16x16x32_bf16 v[196:199], a[148:151], v[76:79], v[196:199]
    ds_read_b64_tr_b16 a[138:139], v231 offset:10240
    v_mfma_f32_16x16x32_bf16 v[196:199], a[144:147], v[72:75], v[196:199]
    ds_write_b32 v236, v208 offset:0
    v_mfma_f32_16x16x32_bf16 v[200:203], a[144:147], v[80:83], v[200:203]
    ds_read_b64_tr_b16 a[140:141], v231 offset:12288
    v_mul_f32 v210, v242, v210
    v_mfma_f32_16x16x32_bf16 v[200:203], a[148:151], v[84:87], v[200:203]
    v_mfma_f32_16x16x32_bf16 v[204:207], a[148:151], v[92:95], v[204:207]
    s_lshl3_add_u32 s30, s23, s30
    ds_read_b64_tr_b16 a[142:143], v231 offset:14336
    v_xor_b32 v230, 32, v230
    v_mfma_f32_16x16x32_bf16 v[204:207], a[144:147], v[88:91], v[204:207]
    v_xor_b32 v231, 32, v231
    v_mul_f32 v211, v242, v211
    v_mfma_f32_16x16x32_bf16 v[204:207], a[152:155], v[120:123], v[204:207]
    ds_read_b64_tr_b16 a[144:145], v231 offset:49152
    v_cvt_pk_bf16_f32 v210, v210, v211
    v_mfma_f32_16x16x32_bf16 v[204:207], a[156:159], v[124:127], v[204:207]
    ds_write_b32 v236, v210 offset:4
    v_mfma_f32_16x16x32_bf16 v[200:203], a[156:159], v[116:119], v[200:203]
    ds_read_b64_tr_b16 a[146:147], v231 offset:51200
    v_mul_f32 v212, v243, v212
    v_mfma_f32_16x16x32_bf16 v[200:203], a[152:155], v[112:115], v[200:203]
    v_mul_f32 v213, v243, v213
    v_mfma_f32_16x16x32_bf16 v[196:199], a[152:155], v[104:107], v[196:199]
    ds_read_b64_tr_b16 a[148:149], v231 offset:53248
    v_cvt_pk_bf16_f32 v212, v212, v213
    v_mfma_f32_16x16x32_bf16 v[196:199], a[156:159], v[108:111], v[196:199]
    ds_write_b32 v236, v212 offset:2048
    v_mfma_f32_16x16x32_bf16 v[192:195], a[156:159], v[100:103], v[192:195]
    ds_read_b64_tr_b16 a[150:151], v231 offset:55296
    v_mfma_f32_16x16x32_bf16 v[192:195], a[152:155], v[96:99], v[192:195]
    s_waitcnt lgkmcnt(6)
    v_mul_f32 v214, v243, v214
    v_mfma_f32_16x16x32_bf16 v[192:195], a[128:131], v[128:131], v[192:195]
    s_add_u32 m0, s23, 0x4000
    ds_read_b64_tr_b16 a[152:153], v231 offset:57344
    v_mul_f32 v215, v243, v215
    v_mfma_f32_16x16x32_bf16 v[192:195], a[132:135], v[132:135], v[192:195]
L_hop7:
    s_cbranch_execz L_hopret1
    v_mfma_f32_16x16x32_bf16 v[196:199], a[132:135], v[140:143], v[196:199]
    s_add_u32 s34, s28, 0x8000
    ds_read_b64_tr_b16 a[154:155], v231 offset:59392
    v_cvt_pk_bf16_f32 v214, v214, v215
    v_mfma_f32_16x16x32_bf16 v[196:199], a[128:131], v[136:139], v[196:199]
    ds_write_b32 v236, v214 offset:2052
    v_mfma_f32_16x16x32_bf16 v[200:203], a[128:131], v[144:147], v[200:203]
    ds_read_b64_tr_b16 a[156:157], v231 offset:61440
    v_mfma_f32_16x16x32_bf16 v[200:203], a[132:135], v[148:151], v[200:203]
    buffer_store_dwordx4 a[224:227], v235, s[16:19], s32 offen offset:3072 sc1
    v_mul_f32 v220, v245, v220
    v_mfma_f32_16x16x32_bf16 v[204:207], a[132:135], v[156:159], v[204:207]
    ds_read_b64_tr_b16 a[158:159], v231 offset:63488
    v_mul_f32 v221, v245, v221
    v_mfma_f32_16x16x32_bf16 v[204:207], a[128:131], v[152:155], v[204:207]
    v_mfma_f32_16x16x32_bf16 v[204:207], a[136:139], v[184:187], v[204:207]
    ds_read_b64_tr_b16 a[128:129], v230 offset:49152
    v_cvt_pk_bf16_f32 v220, v220, v221
    v_mfma_f32_16x16x32_bf16 v[204:207], a[140:143], v[188:191], v[204:207]
    ds_write_b32 v236, v220 offset:18432
    v_mfma_f32_16x16x32_bf16 v[200:203], a[140:143], v[180:183], v[200:203]
    ds_read_b64_tr_b16 a[130:131], v230 offset:51200
    v_mul_f32 v222, v245, v222
    v_mfma_f32_16x16x32_bf16 v[200:203], a[136:139], v[176:179], v[200:203]
    buffer_load_dwordx4 v232, s[8:11], s34 offen nt lds
    v_mfma_f32_16x16x32_bf16 v[196:199], a[136:139], v[168:171], v[196:199]
    ds_read_b64_tr_b16 a[132:133], v230 offset:53248
    v_mul_f32 v223, v245, v223
    v_mfma_f32_16x16x32_bf16 v[196:199], a[140:143], v[172:175], v[196:199]
    s_waitcnt vmcnt(20)
    ds_read_b128 a[88:91], v228 offset:0
    v_mfma_f32_16x16x32_bf16 v[192:195], a[140:143], v[164:167], v[192:195]
    ds_read_b64_tr_b16 a[134:135], v230 offset:55296
    v_cvt_pk_bf16_f32 v222, v222, v223
    v_mfma_f32_16x16x32_bf16 v[192:195], a[136:139], v[160:163], v[192:195]
    s_waitcnt lgkmcnt(6)
    ds_write_b32 v236, v222 offset:18436
    v_mfma_f32_16x16x32_bf16 v[208:211], a[144:147], v[0:3], 0
    ds_read_b64_tr_b16 a[136:137], v230 offset:57344
    v_xor_b32 v236, 0x60, v236
    v_mfma_f32_16x16x32_bf16 v[208:211], a[148:151], v[4:7], v[208:211]
    v_mfma_f32_16x16x32_bf16 v[212:215], a[148:151], v[12:15], 0
    s_add_u32 s35, s32, 0x4000
    ds_read_b64_tr_b16 a[138:139], v230 offset:59392
    v_mul_f32 v200, v244, v200
    v_mfma_f32_16x16x32_bf16 v[212:215], a[144:147], v[8:11], v[212:215]
    ds_read_b128 a[92:95], v229 offset:0
    v_mul_f32 v201, v244, v201
    v_mfma_f32_16x16x32_bf16 v[216:219], a[144:147], v[16:19], 0
    ds_read_b64_tr_b16 a[140:141], v230 offset:61440
    v_cvt_pk_bf16_f32 v200, v200, v201
    v_mfma_f32_16x16x32_bf16 v[216:219], a[148:151], v[20:23], v[216:219]
    ds_write_b32 v236, v200 offset:16384
    v_mfma_f32_16x16x32_bf16 v[220:223], a[148:151], v[28:31], 0
    ds_read_b64_tr_b16 a[142:143], v230 offset:63488
    v_mul_f32 v202, v244, v202
    v_mfma_f32_16x16x32_bf16 v[220:223], a[144:147], v[24:27], v[220:223]
    v_mfma_f32_16x16x32_bf16 v[220:223], a[152:155], v[56:59], v[220:223]
    ds_read_b64_tr_b16 a[144:145], v231 offset:0
    v_mul_f32 v203, v244, v203
    v_mfma_f32_16x16x32_bf16 v[220:223], a[156:159], v[60:63], v[220:223]
    s_or_b32 s30, s30, s96
    buffer_load_dwordx4 v233, s[8:11], s34 offen offset:1024 nt lds
    v_mfma_f32_16x16x32_bf16 v[216:219], a[156:159], v[52:55], v[216:219]
    s_waitcnt vmcnt(10)
    ds_read_b64_tr_b16 a[146:147], v231 offset:2048
    v_cvt_pk_bf16_f32 v202, v202, v203
    v_mfma_f32_16x16x32_bf16 v[216:219], a[152:155], v[48:51], v[216:219]
    ds_write_b32 v236, v202 offset:16388
    v_mfma_f32_16x16x32_bf16 v[212:215], a[152:155], v[40:43], v[212:215]
    ds_read_b64_tr_b16 a[148:149], v231 offset:4096
    v_mfma_f32_16x16x32_bf16 v[212:215], a[156:159], v[44:47], v[212:215]
    buffer_store_dwordx4 a[228:231], v232, s[16:19], s35 offen sc1
    v_mul_f32 v192, v242, v192
    v_mfma_f32_16x16x32_bf16 v[208:211], a[156:159], v[36:39], v[208:211]
    ds_read_b64_tr_b16 a[150:151], v231 offset:6144
    v_mfma_f32_16x16x32_bf16 v[208:211], a[152:155], v[32:35], v[208:211]
    s_waitcnt lgkmcnt(5)
    ds_read_b128 a[120:123], v228 offset:2048
    v_mul_f32 v193, v242, v193
    v_mfma_f32_16x16x32_bf16 v[208:211], a[128:131], v[64:67], v[208:211]
    ds_read_b64_tr_b16 a[152:153], v231 offset:8192
    v_cvt_pk_bf16_f32 v192, v192, v193
    v_mfma_f32_16x16x32_bf16 v[208:211], a[132:135], v[68:71], v[208:211]
    ds_write_b32 v236, v192 offset:0
    v_mfma_f32_16x16x32_bf16 v[212:215], a[132:135], v[76:79], v[212:215]
    ds_read_b64_tr_b16 a[154:155], v231 offset:10240
    v_mul_f32 v194, v242, v194
    v_mfma_f32_16x16x32_bf16 v[212:215], a[128:131], v[72:75], v[212:215]
    ds_read_b128 a[124:127], v229 offset:2048
    v_mfma_f32_16x16x32_bf16 v[216:219], a[128:131], v[80:83], v[216:219]
    ds_read_b64_tr_b16 a[156:157], v231 offset:12288
    v_mul_f32 v195, v242, v195
    v_mfma_f32_16x16x32_bf16 v[216:219], a[132:135], v[84:87], v[216:219]
    v_mfma_f32_16x16x32_bf16 v[220:223], a[132:135], v[92:95], v[220:223]
    ds_read_b64_tr_b16 a[158:159], v231 offset:14336
    v_cvt_pk_bf16_f32 v194, v194, v195
    v_mfma_f32_16x16x32_bf16 v[220:223], a[128:131], v[88:91], v[220:223]
    v_mfma_f32_16x16x32_bf16 v[220:223], a[136:139], v[120:123], v[220:223]
    ds_write_b32 v236, v194 offset:4
    v_mfma_f32_16x16x32_bf16 v[220:223], a[140:143], v[124:127], v[220:223]
    buffer_load_dwordx4 v234, s[8:11], s34 offen offset:2048 nt lds
    v_mfma_f32_16x16x32_bf16 v[216:219], a[140:143], v[116:119], v[216:219]
    v_mul_f32 v196, v243, v196
    v_mul_f32 v197, v243, v197
    v_mfma_f32_16x16x32_bf16 v[216:219], a[136:139], v[112:115], v[216:219]
    v_mfma_f32_16x16x32_bf16 v[212:215], a[136:139], v[104:107], v[212:215]
    v_cvt_pk_bf16_f32 v196, v196, v197
    v_mfma_f32_16x16x32_bf16 v[212:215], a[140:143], v[108:111], v[212:215]
    ds_write_b32 v236, v196 offset:2048
    v_mfma_f32_16x16x32_bf16 v[208:211], a[140:143], v[100:103], v[208:211]
    v_mul_f32 v198, v243, v198
    v_mfma_f32_16x16x32_bf16 v[208:211], a[136:139], v[96:99], v[208:211]
    s_waitcnt lgkmcnt(2)
    s_barrier
    v_mfma_f32_16x16x32_bf16 v[208:211], a[144:147], v[128:131], v[208:211]
    ds_read_b128 a[128:131], v226 offset:16384
    v_mul_f32 v199, v243, v199
    v_mfma_f32_16x16x32_bf16 v[208:211], a[148:151], v[132:135], v[208:211]
    ds_read_b128 a[132:135], v227 offset:16384
    v_cvt_pk_bf16_f32 v198, v198, v199
    v_mfma_f32_16x16x32_bf16 v[212:215], a[148:151], v[140:143], v[212:215]
    ds_write_b32 v236, v198 offset:2052
    v_mfma_f32_16x16x32_bf16 v[212:215], a[144:147], v[136:139], v[212:215]
    buffer_store_dwordx4 a[232:235], v233, s[16:19], s35 offen offset:1024 sc1
    v_mfma_f32_16x16x32_bf16 v[216:219], a[144:147], v[144:147], v[216:219]
    ds_read_b128 a[136:139], v226 offset:20480
    v_mul_f32 v204, v245, v204
    v_mfma_f32_16x16x32_bf16 v[216:219], a[148:151], v[148:151], v[216:219]
    ds_read_b128 a[140:143], v227 offset:20480
    v_mul_f32 v205, v245, v205
    v_mfma_f32_16x16x32_bf16 v[220:223], a[148:151], v[156:159], v[220:223]
    v_mfma_f32_16x16x32_bf16 v[220:223], a[144:147], v[152:155], v[220:223]
    v_mfma_f32_16x16x32_bf16 v[220:223], a[152:155], v[184:187], v[220:223]
    ds_read_b128 a[144:147], v226 offset:24576
    v_cvt_pk_bf16_f32 v204, v204, v205
    v_mfma_f32_16x16x32_bf16 v[220:223], a[156:159], v[188:191], v[220:223]
    buffer_load_dwordx4 v235, s[8:11], s34 offen offset:3072 nt lds
    v_mfma_f32_16x16x32_bf16 v[216:219], a[156:159], v[180:183], v[216:219]
    ds_write_b32 v236, v204 offset:18432
    v_mfma_f32_16x16x32_bf16 v[216:219], a[152:155], v[176:179], v[216:219]
    v_mul_f32 v206, v245, v206
    v_mul_f32 v207, v245, v207
    v_mfma_f32_16x16x32_bf16 v[212:215], a[152:155], v[168:171], v[212:215]
    ds_read_b128 a[148:151], v227 offset:24576
    v_cvt_pk_bf16_f32 v206, v206, v207
    v_mfma_f32_16x16x32_bf16 v[212:215], a[156:159], v[172:175], v[212:215]
    v_mfma_f32_16x16x32_bf16 v[208:211], a[156:159], v[164:167], v[208:211]
    v_mfma_f32_16x16x32_bf16 v[208:211], a[152:155], v[160:163], v[208:211]
    s_waitcnt lgkmcnt(3)
    ds_write_b32 v236, v206 offset:18436
    v_mfma_f32_16x16x32_bf16 v[192:195], a[128:131], a[0:3], 0
    s_add_u32 m0, s23, 0x8000
    ds_read_b128 a[152:155], v226 offset:28672
    v_xor_b32 v236, 32, v236
    v_mfma_f32_16x16x32_bf16 v[192:195], a[132:135], a[4:7], v[192:195]
    v_mul_f32 v216, v244, v216
    v_mul_f32 v217, v244, v217
    v_mfma_f32_16x16x32_bf16 v[196:199], a[132:135], a[36:39], 0
    s_add_u32 s34, s28, 0xc000
    v_mul_f32 v218, v244, v218
    v_mul_f32 v219, v244, v219
    v_mfma_f32_16x16x32_bf16 v[196:199], a[128:131], a[32:35], v[196:199]
    v_cvt_pk_bf16_f32 v216, v216, v217
    v_cvt_pk_bf16_f32 v217, v218, v219
    v_mfma_f32_16x16x32_bf16 v[200:203], a[128:131], a[64:67], 0
    ds_read_b128 a[156:159], v227 offset:28672
    ds_write_b64 v236, v[216:217] offset:16384
    v_mfma_f32_16x16x32_bf16 v[200:203], a[132:135], a[68:71], v[200:203]
    buffer_load_dwordx4 v232, s[8:11], s34 offen nt lds
    v_mfma_f32_16x16x32_bf16 v[204:207], a[132:135], a[100:103], 0
    v_mul_f32 v208, v242, v208
    v_mul_f32 v209, v242, v209
    v_mfma_f32_16x16x32_bf16 v[204:207], a[128:131], a[96:99], v[204:207]
    ds_read_b128 a[176:179], v237 offset:16384
    v_mul_f32 v210, v242, v210
    v_mfma_f32_16x16x32_bf16 v[204:207], a[136:139], a[104:107], v[204:207]
    ds_read_b128 a[128:131], v226 offset:18432
    v_mul_f32 v211, v242, v211
    v_mfma_f32_16x16x32_bf16 v[204:207], a[140:143], a[108:111], v[204:207]
    ds_read_b128 a[180:183], v237 offset:17408
    v_cvt_pk_bf16_f32 v208, v208, v209
    v_cvt_pk_bf16_f32 v209, v210, v211
    v_mfma_f32_16x16x32_bf16 v[200:203], a[140:143], a[76:79], v[200:203]
    ds_write_b64 v236, v[208:209] offset:0
    v_mfma_f32_16x16x32_bf16 v[200:203], a[136:139], a[72:75], v[200:203]
    buffer_store_dwordx4 a[236:239], v234, s[16:19], s35 offen offset:2048 sc1
    v_mul_f32 v212, v243, v212
    v_mfma_f32_16x16x32_bf16 v[196:199], a[136:139], a[40:43], v[196:199]
    ds_read_b128 a[132:135], v227 offset:18432
    v_mul_f32 v213, v243, v213
    v_mfma_f32_16x16x32_bf16 v[196:199], a[140:143], a[44:47], v[196:199]
    ds_read_b128 a[160:163], v237 offset:0
    v_mfma_f32_16x16x32_bf16 v[192:195], a[140:143], a[12:15], v[192:195]
    v_mul_f32 v214, v243, v214
    v_mul_f32 v215, v243, v215
    v_mfma_f32_16x16x32_bf16 v[192:195], a[136:139], a[8:11], v[192:195]
    s_waitcnt lgkmcnt(7)
    ds_read_b128 a[164:167], v237 offset:1024
    v_cvt_pk_bf16_f32 v212, v212, v213
    v_mfma_f32_16x16x32_bf16 v[192:195], a[144:147], a[16:19], v[192:195]
    ds_read_b128 a[136:139], v226 offset:22528
    v_cvt_pk_bf16_f32 v213, v214, v215
    v_mfma_f32_16x16x32_bf16 v[192:195], a[148:151], a[20:23], v[192:195]
    ds_write_b64 v236, v[212:213] offset:2048
    v_mfma_f32_16x16x32_bf16 v[196:199], a[148:151], a[52:55], v[196:199]
    v_mul_f32 v220, v245, v220
    v_mfma_f32_16x16x32_bf16 v[196:199], a[144:147], a[48:51], v[196:199]
    buffer_load_dwordx4 v233, s[8:11], s34 offen offset:1024 nt lds
    v_mfma_f32_16x16x32_bf16 v[200:203], a[144:147], a[80:83], v[200:203]
    ds_read_b128 a[140:143], v227 offset:22528
    v_mul_f32 v221, v245, v221
    v_mfma_f32_16x16x32_bf16 v[200:203], a[148:151], a[84:87], v[200:203]
    ds_read_b128 a[168:171], v237 offset:2048
    v_mfma_f32_16x16x32_bf16 v[204:207], a[148:151], a[116:119], v[204:207]
    v_mul_f32 v222, v245, v222
    v_mul_f32 v223, v245, v223
    v_mfma_f32_16x16x32_bf16 v[204:207], a[144:147], a[112:115], v[204:207]
    ds_read_b128 a[172:175], v237 offset:3072
    v_cvt_pk_bf16_f32 v220, v220, v221
    v_mfma_f32_16x16x32_bf16 v[204:207], a[152:155], a[120:123], v[204:207]
    ds_read_b128 a[144:147], v226 offset:26624
    v_cvt_pk_bf16_f32 v221, v222, v223
    v_mfma_f32_16x16x32_bf16 v[204:207], a[156:159], a[124:127], v[204:207]
    ds_write_b64 v236, v[220:221] offset:18432
    v_mfma_f32_16x16x32_bf16 v[200:203], a[156:159], a[92:95], v[200:203]
    ds_read_b128 a[184:187], v237 offset:18432
    v_mfma_f32_16x16x32_bf16 v[200:203], a[152:155], a[88:91], v[200:203]
    ds_read_b128 a[188:191], v237 offset:19456
    v_mfma_f32_16x16x32_bf16 v[196:199], a[152:155], a[56:59], v[196:199]
    ds_read_b128 a[148:151], v227 offset:26624
    v_mfma_f32_16x16x32_bf16 v[196:199], a[156:159], a[60:63], v[196:199]
    buffer_load_dwordx4 v234, s[8:11], s34 offen offset:2048 nt lds
    v_mfma_f32_16x16x32_bf16 v[192:195], a[156:159], a[28:31], v[192:195]
    v_max3_f32 v241, v204, v205, v206
    v_max_f32 v241, v241, v207
    v_mfma_f32_16x16x32_bf16 v[192:195], a[152:155], a[24:27], v[192:195]
    s_waitcnt lgkmcnt(7)
    v_max3_f32 v240, v200, v201, v202
    v_max_f32 v240, v240, v203
    v_mfma_f32_16x16x32_bf16 v[208:211], a[128:131], a[0:3], 0
    ds_read_b128 a[152:155], v226 offset:30720
    v_max3_f32 v239, v196, v197, v198
    v_mfma_f32_16x16x32_bf16 v[208:211], a[132:135], a[4:7], v[208:211]
    v_max_f32 v239, v239, v199
    v_max3_f32 v238, v192, v193, v194
    v_max_f32 v238, v238, v195
    v_mfma_f32_16x16x32_bf16 v[212:215], a[132:135], a[36:39], 0
    s_nop 0
    v_permlane32_swap_b32 v239, v241
    v_permlane32_swap_b32 v238, v240
    v_mfma_f32_16x16x32_bf16 v[212:215], a[128:131], a[32:35], v[212:215]
    v_max_f32 v239, v239, v241
    v_max_f32 v238, v238, v240
    v_mfma_f32_16x16x32_bf16 v[216:219], a[128:131], a[64:67], 0
    s_nop 0
    ds_read_b128 a[156:159], v227 offset:30720
    v_permlane16_swap_b32 v238, v239
    v_mfma_f32_16x16x32_bf16 v[216:219], a[132:135], a[68:71], v[216:219]
    buffer_store_dwordx4 a[240:243], v235, s[16:19], s35 offen offset:3072 sc1
    v_max_f32 v239, v238, v239
    v_mul_f32 v238, s24, v239
    v_mul_f32 v239, s24, v239
    v_mfma_f32_16x16x32_bf16 v[220:223], a[132:135], a[100:103], 0
    s_nop 0
    v_permlane16_swap_b32 v238, v239
    v_mov_b32 v240, v238
    v_mov_b32 v241, v239
    v_mfma_f32_16x16x32_bf16 v[220:223], a[128:131], a[96:99], v[220:223]
    s_nop 0
    v_permlane32_swap_b32 v238, v240
    v_permlane32_swap_b32 v239, v241
    v_mfma_f32_16x16x32_bf16 v[220:223], a[136:139], a[104:107], v[220:223]
    v_fma_f32 v200, v200, s21, v240
    v_fma_f32 v201, v201, s21, v240
    v_mfma_f32_16x16x32_bf16 v[220:223], a[140:143], a[108:111], v[220:223]
    buffer_load_dwordx4 v235, s[8:11], s34 offen offset:3072 nt lds
    v_exp_f32 v200, v200
    v_mfma_f32_16x16x32_bf16 v[216:219], a[140:143], a[76:79], v[216:219]
    v_exp_f32 v201, v201
    v_mfma_f32_16x16x32_bf16 v[216:219], a[136:139], a[72:75], v[216:219]
    v_fma_f32 v202, v202, s21, v240
    v_fma_f32 v203, v203, s21, v240
    v_mfma_f32_16x16x32_bf16 v[212:215], a[136:139], a[40:43], v[212:215]
    v_exp_f32 v202, v202
    v_mfma_f32_16x16x32_bf16 v[212:215], a[140:143], a[44:47], v[212:215]
    v_cvt_pk_bf16_f32 v16, v200, v201
    v_exp_f32 v203, v203
    v_mfma_f32_16x16x32_bf16 v[208:211], a[140:143], a[12:15], v[208:211]
    v_fma_f32 v192, v192, s21, v238
    v_fma_f32 v193, v193, s21, v238
    v_mfma_f32_16x16x32_bf16 v[208:211], a[136:139], a[8:11], v[208:211]
    s_waitcnt vmcnt(14) lgkmcnt(0)
    s_barrier
    v_exp_f32 v192, v192
    v_mfma_f32_16x16x32_bf16 v[208:211], a[144:147], a[16:19], v[208:211]
    s_add_u32 m0, s23, 0x1c000
    ds_read_b128 a[128:131], v224 offset:0
    v_cvt_pk_bf16_f32 v17, v202, v203
    v_mfma_f32_16x16x32_bf16 v[208:211], a[148:151], a[20:23], v[208:211]
    ds_read_b128 a[132:135], v225 offset:0
    v_exp_f32 v193, v193
    v_fma_f32 v194, v194, s21, v238
    v_fma_f32 v195, v195, s21, v238
    v_mfma_f32_16x16x32_bf16 v[212:215], a[148:151], a[52:55], v[212:215]
    s_add_u32 s34, s28, 0x10000
    v_exp_f32 v194, v194
    v_mfma_f32_16x16x32_bf16 v[212:215], a[144:147], a[48:51], v[212:215]
    v_cvt_pk_bf16_f32 v0, v192, v193
    v_exp_f32 v195, v195
    v_mfma_f32_16x16x32_bf16 v[216:219], a[144:147], a[80:83], v[216:219]
    ds_read_b128 a[136:139], v224 offset:4096
    v_fma_f32 v196, v196, s21, v239
    v_mfma_f32_16x16x32_bf16 v[216:219], a[148:151], a[84:87], v[216:219]
    ds_read_b128 a[140:143], v225 offset:4096
    v_fma_f32 v197, v197, s21, v239
    v_exp_f32 v196, v196
    v_cvt_pk_bf16_f32 v1, v194, v195
    v_exp_f32 v197, v197
    v_mfma_f32_16x16x32_bf16 v[220:223], a[148:151], a[116:119], v[220:223]
    v_fma_f32 v198, v198, s21, v239
    v_fma_f32 v199, v199, s21, v239
    v_mfma_f32_16x16x32_bf16 v[220:223], a[144:147], a[112:115], v[220:223]
    v_exp_f32 v198, v198
    v_mfma_f32_16x16x32_bf16 v[220:223], a[152:155], a[120:123], v[220:223]
    ds_read_b128 a[144:147], v224 offset:8192
    v_cvt_pk_bf16_f32 v8, v196, v197
    v_mfma_f32_16x16x32_bf16 v[220:223], a[156:159], a[124:127], v[220:223]
    buffer_load_dwordx4 v232, s[8:11], s34 offen nt lds
    v_exp_f32 v199, v199
    v_mfma_f32_16x16x32_bf16 v[216:219], a[156:159], a[92:95], v[216:219]
    v_fma_f32 v204, v204, s21, v241
    v_fma_f32 v205, v205, s21, v241
    v_mfma_f32_16x16x32_bf16 v[216:219], a[152:155], a[88:91], v[216:219]
    v_exp_f32 v204, v204
    v_mfma_f32_16x16x32_bf16 v[212:215], a[152:155], a[56:59], v[212:215]
    ds_read_b128 a[148:151], v225 offset:8192
    v_cvt_pk_bf16_f32 v9, v198, v199
    v_mfma_f32_16x16x32_bf16 v[212:215], a[156:159], a[60:63], v[212:215]
    buffer_store_dwordx4 a[160:163], v232, s[16:19], s33 offen sc1
    v_exp_f32 v205, v205
    v_fma_f32 v206, v206, s21, v241
    v_fma_f32 v207, v207, s21, v241
    v_mfma_f32_16x16x32_bf16 v[208:211], a[156:159], a[28:31], v[208:211]
    v_exp_f32 v206, v206
    v_mfma_f32_16x16x32_bf16 v[208:211], a[152:155], a[24:27], v[208:211]
    s_waitcnt lgkmcnt(2)
    v_cvt_pk_bf16_f32 v24, v204, v205
    v_exp_f32 v207, v207
    v_mfma_f32_16x16x32_bf16 v[192:195], a[128:131], a[0:3], 0
    ds_read_b128 a[152:155], v224 offset:12288
    v_fma_f32 v216, v216, s21, v240
    v_mfma_f32_16x16x32_bf16 v[192:195], a[132:135], a[4:7], v[192:195]
    v_exp_f32 v216, v216
    v_mfma_f32_16x16x32_bf16 v[196:199], a[132:135], a[36:39], 0
    v_cvt_pk_bf16_f32 v25, v206, v207
    v_fma_f32 v217, v217, s21, v240
    v_mfma_f32_16x16x32_bf16 v[196:199], a[128:131], a[32:35], v[196:199]
    v_exp_f32 v217, v217
    v_mfma_f32_16x16x32_bf16 v[200:203], a[128:131], a[64:67], 0
    ds_read_b128 a[156:159], v225 offset:12288
    v_fma_f32 v218, v218, s21, v240
    v_mfma_f32_16x16x32_bf16 v[200:203], a[132:135], a[68:71], v[200:203]
    v_exp_f32 v218, v218
    v_mfma_f32_16x16x32_bf16 v[204:207], a[132:135], a[100:103], 0
    v_cvt_pk_bf16_f32 v18, v216, v217
    v_fma_f32 v219, v219, s21, v240
    v_mfma_f32_16x16x32_bf16 v[204:207], a[128:131], a[96:99], v[204:207]
    v_exp_f32 v219, v219
    v_mfma_f32_16x16x32_bf16 v[204:207], a[136:139], a[104:107], v[204:207]
    ds_read_b128 a[128:131], v224 offset:2048
    v_fma_f32 v208, v208, s21, v238
    v_mfma_f32_16x16x32_bf16 v[204:207], a[140:143], a[108:111], v[204:207]
    buffer_load_dwordx4 v233, s[8:11], s34 offen offset:1024 nt lds
    v_exp_f32 v208, v208
    v_mfma_f32_16x16x32_bf16 v[200:203], a[140:143], a[76:79], v[200:203]
    v_cvt_pk_bf16_f32 v19, v218, v219
    v_fma_f32 v209, v209, s21, v238
    v_mfma_f32_16x16x32_bf16 v[200:203], a[136:139], a[72:75], v[200:203]
    v_exp_f32 v209, v209
    v_mfma_f32_16x16x32_bf16 v[196:199], a[136:139], a[40:43], v[196:199]
    ds_read_b128 a[132:135], v225 offset:2048
    v_fma_f32 v210, v210, s21, v238
    v_mfma_f32_16x16x32_bf16 v[196:199], a[140:143], a[44:47], v[196:199]
    v_exp_f32 v210, v210
    v_mfma_f32_16x16x32_bf16 v[192:195], a[140:143], a[12:15], v[192:195]
    v_cvt_pk_bf16_f32 v2, v208, v209
    v_fma_f32 v211, v211, s21, v238
    v_mfma_f32_16x16x32_bf16 v[192:195], a[136:139], a[8:11], v[192:195]
    s_waitcnt lgkmcnt(2)
    v_exp_f32 v211, v211
    v_mfma_f32_16x16x32_bf16 v[192:195], a[144:147], a[16:19], v[192:195]
    ds_read_b128 a[136:139], v224 offset:6144
    v_fma_f32 v212, v212, s21, v239
    v_mfma_f32_16x16x32_bf16 v[192:195], a[148:151], a[20:23], v[192:195]
    v_exp_f32 v212, v212
    v_mfma_f32_16x16x32_bf16 v[196:199], a[148:151], a[52:55], v[196:199]
    v_cvt_pk_bf16_f32 v3, v210, v211
    v_fma_f32 v213, v213, s21, v239
    v_mfma_f32_16x16x32_bf16 v[196:199], a[144:147], a[48:51], v[196:199]
    buffer_store_dwordx4 a[164:167], v233, s[16:19], s33 offen offset:1024 sc1
    v_exp_f32 v213, v213
    v_mfma_f32_16x16x32_bf16 v[200:203], a[144:147], a[80:83], v[200:203]
    ds_read_b128 a[140:143], v225 offset:6144
    v_fma_f32 v214, v214, s21, v239
    v_mfma_f32_16x16x32_bf16 v[200:203], a[148:151], a[84:87], v[200:203]
    v_exp_f32 v214, v214
    v_mfma_f32_16x16x32_bf16 v[204:207], a[148:151], a[116:119], v[204:207]
    v_cvt_pk_bf16_f32 v10, v212, v213
    v_fma_f32 v215, v215, s21, v239
    v_mfma_f32_16x16x32_bf16 v[204:207], a[144:147], a[112:115], v[204:207]
    v_exp_f32 v215, v215
    v_mfma_f32_16x16x32_bf16 v[204:207], a[152:155], a[120:123], v[204:207]
    ds_read_b128 a[144:147], v224 offset:10240
    v_fma_f32 v220, v220, s21, v241
    v_mfma_f32_16x16x32_bf16 v[204:207], a[156:159], a[124:127], v[204:207]
    buffer_load_dwordx4 v234, s[8:11], s34 offen offset:2048 nt lds
    v_exp_f32 v220, v220
    v_mfma_f32_16x16x32_bf16 v[200:203], a[156:159], a[92:95], v[200:203]
    v_cvt_pk_bf16_f32 v11, v214, v215
    v_fma_f32 v221, v221, s21, v241
    v_mfma_f32_16x16x32_bf16 v[200:203], a[152:155], a[88:91], v[200:203]
    v_exp_f32 v221, v221
    v_mfma_f32_16x16x32_bf16 v[196:199], a[152:155], a[56:59], v[196:199]
    ds_read_b128 a[148:151], v225 offset:10240
    v_fma_f32 v222, v222, s21, v241
    v_mfma_f32_16x16x32_bf16 v[196:199], a[156:159], a[60:63], v[196:199]
    v_exp_f32 v222, v222
    v_mfma_f32_16x16x32_bf16 v[192:195], a[156:159], a[28:31], v[192:195]
    v_cvt_pk_bf16_f32 v26, v220, v221
    v_fma_f32 v223, v223, s21, v241
    v_mfma_f32_16x16x32_bf16 v[192:195], a[152:155], a[24:27], v[192:195]
    s_waitcnt lgkmcnt(2)
    v_exp_f32 v223, v223
    v_mfma_f32_16x16x32_bf16 v[208:211], a[128:131], a[0:3], 0
    ds_read_b128 a[152:155], v224 offset:14336
    v_fma_f32 v200, v200, s21, v240
    v_mfma_f32_16x16x32_bf16 v[208:211], a[132:135], a[4:7], v[208:211]
    v_exp_f32 v200, v200
    v_mfma_f32_16x16x32_bf16 v[212:215], a[132:135], a[36:39], 0
    v_cvt_pk_bf16_f32 v27, v222, v223
    v_fma_f32 v201, v201, s21, v240
    v_mfma_f32_16x16x32_bf16 v[212:215], a[128:131], a[32:35], v[212:215]
    v_exp_f32 v201, v201
    v_mfma_f32_16x16x32_bf16 v[216:219], a[128:131], a[64:67], 0
    ds_read_b128 a[156:159], v225 offset:14336
    v_fma_f32 v202, v202, s21, v240
    v_mfma_f32_16x16x32_bf16 v[216:219], a[132:135], a[68:71], v[216:219]
    v_exp_f32 v202, v202
    v_mfma_f32_16x16x32_bf16 v[220:223], a[132:135], a[100:103], 0
    v_cvt_pk_bf16_f32 v20, v200, v201
    v_fma_f32 v203, v203, s21, v240
    v_mfma_f32_16x16x32_bf16 v[220:223], a[128:131], a[96:99], v[220:223]
    v_exp_f32 v203, v203
    v_mfma_f32_16x16x32_bf16 v[220:223], a[136:139], a[104:107], v[220:223]
    buffer_load_dwordx4 v235, s[8:11], s34 offen offset:3072 nt lds
    v_fma_f32 v192, v192, s21, v238
    v_mfma_f32_16x16x32_bf16 v[220:223], a[140:143], a[108:111], v[220:223]
    v_exp_f32 v192, v192
    v_mfma_f32_16x16x32_bf16 v[216:219], a[140:143], a[76:79], v[216:219]
    v_cvt_pk_bf16_f32 v21, v202, v203
    v_fma_f32 v193, v193, s21, v238
    v_mfma_f32_16x16x32_bf16 v[216:219], a[136:139], a[72:75], v[216:219]
    v_exp_f32 v193, v193
    v_mfma_f32_16x16x32_bf16 v[212:215], a[136:139], a[40:43], v[212:215]
    v_fma_f32 v194, v194, s21, v238
    v_mfma_f32_16x16x32_bf16 v[212:215], a[140:143], a[44:47], v[212:215]
    v_exp_f32 v194, v194
    v_mfma_f32_16x16x32_bf16 v[208:211], a[140:143], a[12:15], v[208:211]
    v_cvt_pk_bf16_f32 v4, v192, v193
    v_fma_f32 v195, v195, s21, v238
    v_mfma_f32_16x16x32_bf16 v[208:211], a[136:139], a[8:11], v[208:211]
    s_waitcnt vmcnt(12) lgkmcnt(0)
    s_barrier
    buffer_store_dwordx4 a[168:171], v234, s[16:19], s33 offen offset:2048 sc1
    v_exp_f32 v195, v195
    v_mfma_f32_16x16x32_bf16 v[208:211], a[144:147], a[16:19], v[208:211]
    s_add_u32 m0, s23, 0xc000
    ds_read_b128 a[128:131], v224 offset:16384
    v_fma_f32 v196, v196, s21, v239
    v_mfma_f32_16x16x32_bf16 v[208:211], a[148:151], a[20:23], v[208:211]
    ds_read_b128 a[132:135], v225 offset:16384
    v_exp_f32 v196, v196
    v_mfma_f32_16x16x32_bf16 v[212:215], a[148:151], a[52:55], v[212:215]
    s_add_u32 s34, s28, 0x14000
    v_cvt_pk_bf16_f32 v5, v194, v195
    v_fma_f32 v197, v197, s21, v239
    v_mfma_f32_16x16x32_bf16 v[212:215], a[144:147], a[48:51], v[212:215]
    v_exp_f32 v197, v197
    v_mfma_f32_16x16x32_bf16 v[216:219], a[144:147], a[80:83], v[216:219]
    ds_read_b128 a[136:139], v224 offset:20480
    v_fma_f32 v198, v198, s21, v239
    v_mfma_f32_16x16x32_bf16 v[216:219], a[148:151], a[84:87], v[216:219]
    ds_read_b128 a[140:143], v225 offset:20480
    v_exp_f32 v198, v198
    v_mfma_f32_16x16x32_bf16 v[220:223], a[148:151], a[116:119], v[220:223]
    v_cvt_pk_bf16_f32 v12, v196, v197
    v_fma_f32 v199, v199, s21, v239
    v_mfma_f32_16x16x32_bf16 v[220:223], a[144:147], a[112:115], v[220:223]
    v_exp_f32 v199, v199
    v_mfma_f32_16x16x32_bf16 v[220:223], a[152:155], a[120:123], v[220:223]
    ds_read_b128 a[144:147], v224 offset:24576
    v_fma_f32 v204, v204, s21, v241
    v_mfma_f32_16x16x32_bf16 v[220:223], a[156:159], a[124:127], v[220:223]
    v_exp_f32 v204, v204
    v_mfma_f32_16x16x32_bf16 v[216:219], a[156:159], a[92:95], v[216:219]
    v_cvt_pk_bf16_f32 v13, v198, v199
    v_fma_f32 v205, v205, s21, v241
    v_mfma_f32_16x16x32_bf16 v[216:219], a[152:155], a[88:91], v[216:219]
    buffer_load_dwordx4 v232, s[8:11], s34 offen nt lds
    v_exp_f32 v205, v205
    v_mfma_f32_16x16x32_bf16 v[212:215], a[152:155], a[56:59], v[212:215]
    ds_read_b128 a[148:151], v225 offset:24576
    v_fma_f32 v206, v206, s21, v241
    v_mfma_f32_16x16x32_bf16 v[212:215], a[156:159], a[60:63], v[212:215]
    v_exp_f32 v206, v206
    v_mfma_f32_16x16x32_bf16 v[208:211], a[156:159], a[28:31], v[208:211]
    v_cvt_pk_bf16_f32 v28, v204, v205
    v_fma_f32 v207, v207, s21, v241
    v_mfma_f32_16x16x32_bf16 v[208:211], a[152:155], a[24:27], v[208:211]
    s_waitcnt lgkmcnt(2)
    v_exp_f32 v207, v207
    v_mfma_f32_16x16x32_bf16 v[192:195], a[128:131], a[0:3], 0
    ds_read_b128 a[152:155], v224 offset:28672
    v_fma_f32 v216, v216, s21, v240
    v_mfma_f32_16x16x32_bf16 v[192:195], a[132:135], a[4:7], v[192:195]
    v_exp_f32 v216, v216
    v_mfma_f32_16x16x32_bf16 v[196:199], a[132:135], a[36:39], 0
    v_cvt_pk_bf16_f32 v29, v206, v207
    v_fma_f32 v217, v217, s21, v240
    v_mfma_f32_16x16x32_bf16 v[196:199], a[128:131], a[32:35], v[196:199]
    buffer_store_dwordx4 a[172:175], v235, s[16:19], s33 offen offset:3072 sc1
    v_exp_f32 v217, v217
    v_mfma_f32_16x16x32_bf16 v[200:203], a[128:131], a[64:67], 0
    ds_read_b128 a[156:159], v225 offset:28672
    v_fma_f32 v218, v218, s21, v240
    v_mfma_f32_16x16x32_bf16 v[200:203], a[132:135], a[68:71], v[200:203]
    v_exp_f32 v218, v218
    v_mfma_f32_16x16x32_bf16 v[204:207], a[132:135], a[100:103], 0
    v_cvt_pk_bf16_f32 v22, v216, v217
    v_fma_f32 v219, v219, s21, v240
    v_mfma_f32_16x16x32_bf16 v[204:207], a[128:131], a[96:99], v[204:207]
    v_exp_f32 v219, v219
    v_mfma_f32_16x16x32_bf16 v[204:207], a[136:139], a[104:107], v[204:207]
    ds_read_b128 a[128:131], v224 offset:18432
    v_fma_f32 v208, v208, s21, v238
    v_mfma_f32_16x16x32_bf16 v[204:207], a[140:143], a[108:111], v[204:207]
    v_exp_f32 v208, v208
    v_mfma_f32_16x16x32_bf16 v[200:203], a[140:143], a[76:79], v[200:203]
    v_cvt_pk_bf16_f32 v23, v218, v219
    v_fma_f32 v209, v209, s21, v238
    v_mfma_f32_16x16x32_bf16 v[200:203], a[136:139], a[72:75], v[200:203]
    v_exp_f32 v209, v209
    v_mfma_f32_16x16x32_bf16 v[196:199], a[136:139], a[40:43], v[196:199]
    ds_read_b128 a[132:135], v225 offset:18432
    v_fma_f32 v210, v210, s21, v238
    v_mfma_f32_16x16x32_bf16 v[196:199], a[140:143], a[44:47], v[196:199]
    v_exp_f32 v210, v210
    v_mfma_f32_16x16x32_bf16 v[192:195], a[140:143], a[12:15], v[192:195]
    v_cvt_pk_bf16_f32 v6, v208, v209
    v_fma_f32 v211, v211, s21, v238
    v_mfma_f32_16x16x32_bf16 v[192:195], a[136:139], a[8:11], v[192:195]
    s_waitcnt lgkmcnt(2)
    v_exp_f32 v211, v211
    v_smfmac_f32_16x16x64_bf16 a[200:203], a[208:211], v[16:23], v254
    s_add_u32 s35, s33, 0x4000
    buffer_load_dwordx4 v233, s[8:11], s34 offen offset:1024 nt lds
    v_mfma_f32_16x16x32_bf16 v[192:195], a[144:147], a[16:19], v[192:195]
    ds_read_b128 a[136:139], v224 offset:22528
    v_fma_f32 v212, v212, s21, v239
    v_mfma_f32_16x16x32_bf16 v[192:195], a[148:151], a[20:23], v[192:195]
    v_exp_f32 v212, v212
    v_mfma_f32_16x16x32_bf16 v[196:199], a[148:151], a[52:55], v[196:199]
    v_cvt_pk_bf16_f32 v7, v210, v211
    v_fma_f32 v213, v213, s21, v239
    v_mfma_f32_16x16x32_bf16 v[196:199], a[144:147], a[48:51], v[196:199]
L_hop8:
    s_cbranch_execz L_hopret2
    v_exp_f32 v213, v213
    v_mfma_f32_16x16x32_bf16 v[200:203], a[144:147], a[80:83], v[200:203]
    ds_read_b128 a[140:143], v225 offset:22528
    v_fma_f32 v214, v214, s21, v239
    v_mfma_f32_16x16x32_bf16 v[200:203], a[148:151], a[84:87], v[200:203]
    v_exp_f32 v214, v214
    v_mfma_f32_16x16x32_bf16 v[204:207], a[148:151], a[116:119], v[204:207]
    v_cvt_pk_bf16_f32 v14, v212, v213
    v_fma_f32 v215, v215, s21, v239
    v_mfma_f32_16x16x32_bf16 v[204:207], a[144:147], a[112:115], v[204:207]
    v_exp_f32 v215, v215
    v_mfma_f32_16x16x32_bf16 v[204:207], a[152:155], a[120:123], v[204:207]
    ds_read_b128 a[144:147], v224 offset:26624
    v_fma_f32 v220, v220, s21, v241
    v_mfma_f32_16x16x32_bf16 v[204:207], a[156:159], a[124:127], v[204:207]
    buffer_load_dwordx4 v234, s[8:11], s34 offen offset:2048 nt lds
    v_exp_f32 v220, v220
    v_mfma_f32_16x16x32_bf16 v[200:203], a[156:159], a[92:95], v[200:203]
    v_cvt_pk_bf16_f32 v15, v214, v215
    v_fma_f32 v221, v221, s21, v241
    v_mfma_f32_16x16x32_bf16 v[200:203], a[152:155], a[88:91], v[200:203]
    v_exp_f32 v221, v221
    v_mfma_f32_16x16x32_bf16 v[196:199], a[152:155], a[56:59], v[196:199]
    ds_read_b128 a[148:151], v225 offset:26624
    v_fma_f32 v222, v222, s21, v241
    v_mfma_f32_16x16x32_bf16 v[196:199], a[156:159], a[60:63], v[196:199]
    buffer_store_dwordx4 a[176:179], v232, s[16:19], s35 offen sc1
    v_exp_f32 v222, v222
    v_mfma_f32_16x16x32_bf16 v[192:195], a[156:159], a[28:31], v[192:195]
    v_cvt_pk_bf16_f32 v30, v220, v221
    v_fma_f32 v223, v223, s21, v241
    v_mfma_f32_16x16x32_bf16 v[192:195], a[152:155], a[24:27], v[192:195]
    s_waitcnt lgkmcnt(2)
    v_exp_f32 v223, v223
    v_mfma_f32_16x16x32_bf16 v[208:211], a[128:131], a[0:3], 0
    ds_read_b128 a[152:155], v224 offset:30720
    v_fma_f32 v200, v200, s21, v240
    v_mfma_f32_16x16x32_bf16 v[208:211], a[132:135], a[4:7], v[208:211]
    v_exp_f32 v200, v200
    v_mfma_f32_16x16x32_bf16 v[212:215], a[132:135], a[36:39], 0
    v_cvt_pk_bf16_f32 v31, v222, v223
    v_fma_f32 v201, v201, s21, v240
    v_mfma_f32_16x16x32_bf16 v[212:215], a[128:131], a[32:35], v[212:215]
    v_exp_f32 v201, v201
    v_mfma_f32_16x16x32_bf16 v[216:219], a[128:131], a[64:67], 0
    ds_read_b128 a[156:159], v225 offset:30720
    v_fma_f32 v202, v202, s21, v240
    v_mfma_f32_16x16x32_bf16 v[216:219], a[132:135], a[68:71], v[216:219]
    v_exp_f32 v202, v202
    v_mfma_f32_16x16x32_bf16 v[220:223], a[132:135], a[100:103], 0
    v_cvt_pk_bf16_f32 v48, v200, v201
    v_fma_f32 v203, v203, s21, v240
    v_mfma_f32_16x16x32_bf16 v[220:223], a[128:131], a[96:99], v[220:223]
    v_exp_f32 v203, v203
    v_mfma_f32_16x16x32_bf16 v[220:223], a[136:139], a[104:107], v[220:223]
    buffer_load_dwordx4 v235, s[8:11], s34 offen offset:3072 nt lds
    v_fma_f32 v192, v192, s21, v238
    v_mfma_f32_16x16x32_bf16 v[220:223], a[140:143], a[108:111], v[220:223]
    v_exp_f32 v192, v192
    v_mfma_f32_16x16x32_bf16 v[216:219], a[140:143], a[76:79], v[216:219]
    v_cvt_pk_bf16_f32 v49, v202, v203
    v_fma_f32 v193, v193, s21, v238
    v_mfma_f32_16x16x32_bf16 v[216:219], a[136:139], a[72:75], v[216:219]
    v_exp_f32 v193, v193
    v_mfma_f32_16x16x32_bf16 v[212:215], a[136:139], a[40:43], v[212:215]
    v_fma_f32 v194, v194, s21, v238
    v_mfma_f32_16x16x32_bf16 v[212:215], a[140:143], a[44:47], v[212:215]
    v_exp_f32 v194, v194
    v_mfma_f32_16x16x32_bf16 v[208:211], a[140:143], a[12:15], v[208:211]
    v_cvt_pk_bf16_f32 v32, v192, v193
    v_fma_f32 v195, v195, s21, v238
    v_mfma_f32_16x16x32_bf16 v[208:211], a[136:139], a[8:11], v[208:211]
    s_waitcnt vmcnt(13) lgkmcnt(0)
    v_exp_f32 v195, v195
    v_smfmac_f32_16x16x64_bf16 a[192:195], a[208:211], v[0:7], v254
    s_barrier
    v_mfma_f32_16x16x32_bf16 v[208:211], a[144:147], a[16:19], v[208:211]
    s_add_u32 m0, s23, 0x10000
    ds_read_b128 a[128:131], v224 offset:32768
    v_fma_f32 v196, v196, s21, v239
    v_mfma_f32_16x16x32_bf16 v[208:211], a[148:151], a[20:23], v[208:211]
    ds_read_b128 a[132:135], v225 offset:32768
    v_exp_f32 v196, v196
    v_mfma_f32_16x16x32_bf16 v[212:215], a[148:151], a[52:55], v[212:215]
    s_add_u32 s34, s28, 0x18000
    v_cvt_pk_bf16_f32 v33, v194, v195
    v_fma_f32 v197, v197, s21, v239
    v_mfma_f32_16x16x32_bf16 v[212:215], a[144:147], a[48:51], v[212:215]
    buffer_store_dwordx4 a[180:183], v233, s[16:19], s35 offen offset:1024 sc1
    v_exp_f32 v197, v197
    v_mfma_f32_16x16x32_bf16 v[216:219], a[144:147], a[80:83], v[216:219]
    ds_read_b128 a[136:139], v224 offset:36864
    v_fma_f32 v198, v198, s21, v239
    v_mfma_f32_16x16x32_bf16 v[216:219], a[148:151], a[84:87], v[216:219]
    ds_read_b128 a[140:143], v225 offset:36864
    v_exp_f32 v198, v198
    v_mfma_f32_16x16x32_bf16 v[220:223], a[148:151], a[116:119], v[220:223]
    v_cvt_pk_bf16_f32 v40, v196, v197
    v_fma_f32 v199, v199, s21, v239
    v_mfma_f32_16x16x32_bf16 v[220:223], a[144:147], a[112:115], v[220:223]
    v_exp_f32 v199, v199
    v_mfma_f32_16x16x32_bf16 v[220:223], a[152:155], a[120:123], v[220:223]
    ds_read_b128 a[144:147], v224 offset:40960
    v_fma_f32 v204, v204, s21, v241
    v_mfma_f32_16x16x32_bf16 v[220:223], a[156:159], a[124:127], v[220:223]
    v_exp_f32 v204, v204
    v_mfma_f32_16x16x32_bf16 v[216:219], a[156:159], a[92:95], v[216:219]
    v_cvt_pk_bf16_f32 v41, v198, v199
    v_fma_f32 v205, v205, s21, v241
    v_mfma_f32_16x16x32_bf16 v[216:219], a[152:155], a[88:91], v[216:219]
    buffer_load_dwordx4 v232, s[8:11], s34 offen nt lds
    v_exp_f32 v205, v205
    v_mfma_f32_16x16x32_bf16 v[212:215], a[152:155], a[56:59], v[212:215]
    ds_read_b128 a[148:151], v225 offset:40960
    v_fma_f32 v206, v206, s21, v241
    v_mfma_f32_16x16x32_bf16 v[212:215], a[156:159], a[60:63], v[212:215]
    v_exp_f32 v206, v206
    v_mfma_f32_16x16x32_bf16 v[208:211], a[156:159], a[28:31], v[208:211]
    v_cvt_pk_bf16_f32 v56, v204, v205
    v_fma_f32 v207, v207, s21, v241
    v_mfma_f32_16x16x32_bf16 v[208:211], a[152:155], a[24:27], v[208:211]
    s_waitcnt lgkmcnt(2)
    v_exp_f32 v207, v207
    v_mfma_f32_16x16x32_bf16 v[192:195], a[128:131], a[0:3], 0
    ds_read_b128 a[152:155], v224 offset:45056
    v_fma_f32 v216, v216, s21, v240
    v_mfma_f32_16x16x32_bf16 v[192:195], a[132:135], a[4:7], v[192:195]
    v_exp_f32 v216, v216
    v_mfma_f32_16x16x32_bf16 v[196:199], a[132:135], a[36:39], 0
    v_cvt_pk_bf16_f32 v57, v206, v207
    v_fma_f32 v217, v217, s21, v240
    v_mfma_f32_16x16x32_bf16 v[196:199], a[128:131], a[32:35], v[196:199]
    v_exp_f32 v217, v217
    v_mfma_f32_16x16x32_bf16 v[200:203], a[128:131], a[64:67], 0
    ds_read_b128 a[156:159], v225 offset:45056
    v_fma_f32 v218, v218, s21, v240
    v_mfma_f32_16x16x32_bf16 v[200:203], a[132:135], a[68:71], v[200:203]
    v_exp_f32 v218, v218
    v_mfma_f32_16x16x32_bf16 v[204:207], a[132:135], a[100:103], 0
    v_cvt_pk_bf16_f32 v50, v216, v217
    v_fma_f32 v219, v219, s21, v240
    v_mfma_f32_16x16x32_bf16 v[204:207], a[128:131], a[96:99], v[204:207]
    v_exp_f32 v219, v219
    v_mfma_f32_16x16x32_bf16 v[204:207], a[136:139], a[104:107], v[204:207]
    ds_read_b128 a[128:131], v224 offset:34816
    v_fma_f32 v208, v208, s21, v238
    v_mfma_f32_16x16x32_bf16 v[204:207], a[140:143], a[108:111], v[204:207]
    v_exp_f32 v208, v208
    v_mfma_f32_16x16x32_bf16 v[200:203], a[140:143], a[76:79], v[200:203]
    v_cvt_pk_bf16_f32 v51, v218, v219
    v_fma_f32 v209, v209, s21, v238
    v_mfma_f32_16x16x32_bf16 v[200:203], a[136:139], a[72:75], v[200:203]
    buffer_store_dwordx4 a[184:187], v234, s[16:19], s35 offen offset:2048 sc1
    v_exp_f32 v209, v209
    v_mfma_f32_16x16x32_bf16 v[196:199], a[136:139], a[40:43], v[196:199]
    ds_read_b128 a[132:135], v225 offset:34816
    v_fma_f32 v210, v210, s21, v238
    v_mfma_f32_16x16x32_bf16 v[196:199], a[140:143], a[44:47], v[196:199]
    v_exp_f32 v210, v210
    v_mfma_f32_16x16x32_bf16 v[192:195], a[140:143], a[12:15], v[192:195]
    v_cvt_pk_bf16_f32 v34, v208, v209
    v_fma_f32 v211, v211, s21, v238
    v_mfma_f32_16x16x32_bf16 v[192:195], a[136:139], a[8:11], v[192:195]
    s_waitcnt lgkmcnt(2)
    v_exp_f32 v211, v211
    v_smfmac_f32_16x16x64_bf16 a[196:199], a[208:211], v[8:15], v254
    buffer_load_dwordx4 v233, s[8:11], s34 offen offset:1024 nt lds
    v_mfma_f32_16x16x32_bf16 v[192:195], a[144:147], a[16:19], v[192:195]
    ds_read_b128 a[136:139], v224 offset:38912
    v_fma_f32 v212, v212, s21, v239
    v_mfma_f32_16x16x32_bf16 v[192:195], a[148:151], a[20:23], v[192:195]
    v_exp_f32 v212, v212
    v_mfma_f32_16x16x32_bf16 v[196:199], a[148:151], a[52:55], v[196:199]
    v_cvt_pk_bf16_f32 v35, v210, v211
    v_fma_f32 v213, v213, s21, v239
    v_mfma_f32_16x16x32_bf16 v[196:199], a[144:147], a[48:51], v[196:199]
    v_exp_f32 v213, v213
    v_mfma_f32_16x16x32_bf16 v[200:203], a[144:147], a[80:83], v[200:203]
    ds_read_b128 a[140:143], v225 offset:38912
    v_fma_f32 v214, v214, s21, v239
    v_mfma_f32_16x16x32_bf16 v[200:203], a[148:151], a[84:87], v[200:203]
    v_exp_f32 v214, v214
    v_mfma_f32_16x16x32_bf16 v[204:207], a[148:151], a[116:119], v[204:207]
    v_cvt_pk_bf16_f32 v42, v212, v213
    v_fma_f32 v215, v215, s21, v239
    v_mfma_f32_16x16x32_bf16 v[204:207], a[144:147], a[112:115], v[204:207]
    v_exp_f32 v215, v215
    v_mfma_f32_16x16x32_bf16 v[204:207], a[152:155], a[120:123], v[204:207]
    ds_read_b128 a[144:147], v224 offset:43008
    v_fma_f32 v220, v220, s21, v241
    v_mfma_f32_16x16x32_bf16 v[204:207], a[156:159], a[124:127], v[204:207]
    buffer_load_dwordx4 v234, s[8:11], s34 offen offset:2048 nt lds
    v_exp_f32 v220, v220
    v_mfma_f32_16x16x32_bf16 v[200:203], a[156:159], a[92:95], v[200:203]
    v_cvt_pk_bf16_f32 v43, v214, v215
    v_fma_f32 v221, v221, s21, v241
    v_mfma_f32_16x16x32_bf16 v[200:203], a[152:155], a[88:91], v[200:203]
    v_exp_f32 v221, v221
    v_mfma_f32_16x16x32_bf16 v[196:199], a[152:155], a[56:59], v[196:199]
    ds_read_b128 a[148:151], v225 offset:43008
    v_fma_f32 v222, v222, s21, v241
    v_mfma_f32_16x16x32_bf16 v[196:199], a[156:159], a[60:63], v[196:199]
    v_exp_f32 v222, v222
    v_mfma_f32_16x16x32_bf16 v[192:195], a[156:159], a[28:31], v[192:195]
    v_cvt_pk_bf16_f32 v58, v220, v221
    v_fma_f32 v223, v223, s21, v241
    v_mfma_f32_16x16x32_bf16 v[192:195], a[152:155], a[24:27], v[192:195]
    s_waitcnt lgkmcnt(2)
    v_exp_f32 v223, v223
    v_mfma_f32_16x16x32_bf16 v[208:211], a[128:131], a[0:3], 0
    ds_read_b128 a[152:155], v224 offset:47104
    v_fma_f32 v200, v200, s21, v240
    v_mfma_f32_16x16x32_bf16 v[208:211], a[132:135], a[4:7], v[208:211]
    buffer_store_dwordx4 a[188:191], v235, s[16:19], s35 offen offset:3072 sc1
    v_exp_f32 v200, v200
    v_mfma_f32_16x16x32_bf16 v[212:215], a[132:135], a[36:39], 0
    v_cvt_pk_bf16_f32 v59, v222, v223
    v_fma_f32 v201, v201, s21, v240
    v_mfma_f32_16x16x32_bf16 v[212:215], a[128:131], a[32:35], v[212:215]
    v_exp_f32 v201, v201
    v_mfma_f32_16x16x32_bf16 v[216:219], a[128:131], a[64:67], 0
    ds_read_b128 a[156:159], v225 offset:47104
    v_fma_f32 v202, v202, s21, v240
    v_mfma_f32_16x16x32_bf16 v[216:219], a[132:135], a[68:71], v[216:219]
    v_exp_f32 v202, v202
    v_mfma_f32_16x16x32_bf16 v[220:223], a[132:135], a[100:103], 0
    v_cvt_pk_bf16_f32 v52, v200, v201
    v_fma_f32 v203, v203, s21, v240
    v_mfma_f32_16x16x32_bf16 v[220:223], a[128:131], a[96:99], v[220:223]
    v_exp_f32 v203, v203
    v_mfma_f32_16x16x32_bf16 v[220:223], a[136:139], a[104:107], v[220:223]
    buffer_load_dwordx4 v235, s[8:11], s34 offen offset:3072 nt lds
    v_fma_f32 v192, v192, s21, v238
    v_mfma_f32_16x16x32_bf16 v[220:223], a[140:143], a[108:111], v[220:223]
    v_exp_f32 v192, v192
    v_mfma_f32_16x16x32_bf16 v[216:219], a[140:143], a[76:79], v[216:219]
    v_cvt_pk_bf16_f32 v53, v202, v203
    v_fma_f32 v193, v193, s21, v238
    v_mfma_f32_16x16x32_bf16 v[216:219], a[136:139], a[72:75], v[216:219]
    v_exp_f32 v193, v193
    v_mfma_f32_16x16x32_bf16 v[212:215], a[136:139], a[40:43], v[212:215]
    v_fma_f32 v194, v194, s21, v238
    v_mfma_f32_16x16x32_bf16 v[212:215], a[140:143], a[44:47], v[212:215]
    v_exp_f32 v194, v194
    v_mfma_f32_16x16x32_bf16 v[208:211], a[140:143], a[12:15], v[208:211]
    s_cmp_lt_u32 s25, 2
    v_cvt_pk_bf16_f32 v36, v192, v193
    v_fma_f32 v195, v195, s21, v238
    v_mfma_f32_16x16x32_bf16 v[208:211], a[136:139], a[8:11], v[208:211]
    s_waitcnt vmcnt(14) lgkmcnt(0)
    v_exp_f32 v195, v195
    v_smfmac_f32_16x16x64_bf16 a[204:207], a[208:211], v[24:31], v254
    s_barrier
    s_cbranch_scc1 L_mid
    v_mfma_f32_16x16x32_bf16 v[208:211], a[144:147], a[16:19], v[208:211]
    s_add_u32 m0, s23, 0
    ds_read_b128 a[128:131], v226 offset:49152
    v_fma_f32 v196, v196, s21, v239
    v_mfma_f32_16x16x32_bf16 v[208:211], a[148:151], a[20:23], v[208:211]
    s_add_u32 s34, s28, 0x1c000
    ds_read_b128 a[132:135], v227 offset:49152
    v_exp_f32 v196, v196
    v_mfma_f32_16x16x32_bf16 v[212:215], a[148:151], a[52:55], v[212:215]
    s_mul_i32 s36, s31, 3
    v_cvt_pk_bf16_f32 v37, v194, v195
    v_fma_f32 v197, v197, s21, v239
    v_mfma_f32_16x16x32_bf16 v[212:215], a[144:147], a[48:51], v[212:215]
    s_sub_u32 s36, s26, s36
    v_exp_f32 v197, v197
    v_mfma_f32_16x16x32_bf16 v[216:219], a[144:147], a[80:83], v[216:219]
    ds_read_b128 a[136:139], v226 offset:53248
    v_fma_f32 v198, v198, s21, v239
    v_mfma_f32_16x16x32_bf16 v[216:219], a[148:151], a[84:87], v[216:219]
    s_lshl_b32 s36, s36, 16
    ds_read_b128 a[140:143], v227 offset:53248
    buffer_load_dwordx4 v232, s[8:11], s34 offen nt lds
    v_exp_f32 v198, v198
    v_mfma_f32_16x16x32_bf16 v[220:223], a[148:151], a[116:119], v[220:223]
    v_cvt_pk_bf16_f32 v44, v196, v197
    v_fma_f32 v199, v199, s21, v239
    v_mfma_f32_16x16x32_bf16 v[220:223], a[144:147], a[112:115], v[220:223]
    v_exp_f32 v199, v199
    v_mfma_f32_16x16x32_bf16 v[220:223], a[152:155], a[120:123], v[220:223]
    s_and_b32 s38, s40, 0xffffff7f
    ds_read_b128 a[144:147], v226 offset:57344
    v_fma_f32 v204, v204, s21, v241
    v_mfma_f32_16x16x32_bf16 v[220:223], a[156:159], a[124:127], v[220:223]
    v_exp_f32 v204, v204
    v_mfma_f32_16x16x32_bf16 v[216:219], a[156:159], a[92:95], v[216:219]
    s_add_u32 s3, s38, s36
    v_cvt_pk_bf16_f32 v45, v198, v199
    v_fma_f32 v205, v205, s21, v241
    v_mfma_f32_16x16x32_bf16 v[216:219], a[152:155], a[88:91], v[216:219]
    v_exp_f32 v205, v205
    v_mfma_f32_16x16x32_bf16 v[212:215], a[152:155], a[56:59], v[212:215]
    ds_read_b128 a[148:151], v227 offset:57344
    v_fma_f32 v206, v206, s21, v241
    v_mfma_f32_16x16x32_bf16 v[212:215], a[156:159], a[60:63], v[212:215]
    v_exp_f32 v206, v206
    v_mfma_f32_16x16x32_bf16 v[208:211], a[156:159], a[28:31], v[208:211]
    s_add_u32 s3, s42, s36
    v_cvt_pk_bf16_f32 v60, v204, v205
    v_fma_f32 v207, v207, s21, v241
    v_mfma_f32_16x16x32_bf16 v[208:211], a[152:155], a[24:27], v[208:211]
    s_waitcnt lgkmcnt(2)
    buffer_load_dwordx4 v233, s[8:11], s34 offen offset:1024 nt lds
    v_exp_f32 v207, v207
    v_mfma_f32_16x16x32_bf16 v[192:195], a[128:131], a[0:3], 0
    ds_read_b128 a[152:155], v226 offset:61440
    v_fma_f32 v216, v216, s21, v240
    v_mfma_f32_16x16x32_bf16 v[192:195], a[132:135], a[4:7], v[192:195]
    v_exp_f32 v216, v216
    v_mfma_f32_16x16x32_bf16 v[196:199], a[132:135], a[36:39], 0
    s_add_u32 s38, s43, s36
    v_cvt_pk_bf16_f32 v61, v206, v207
    v_fma_f32 v217, v217, s21, v240
    v_mfma_f32_16x16x32_bf16 v[196:199], a[128:131], a[32:35], v[196:199]
    v_exp_f32 v217, v217
    v_mfma_f32_16x16x32_bf16 v[200:203], a[128:131], a[64:67], 0
    ds_read_b128 a[156:159], v227 offset:61440
    v_fma_f32 v218, v218, s21, v240
    v_mfma_f32_16x16x32_bf16 v[200:203], a[132:135], a[68:71], v[200:203]
    s_bfe_u32 s36, s2, 0x10003
    v_exp_f32 v218, v218
    v_mfma_f32_16x16x32_bf16 v[204:207], a[132:135], a[100:103], 0
    v_cvt_pk_bf16_f32 v54, v216, v217
    v_fma_f32 v219, v219, s21, v240
    v_mfma_f32_16x16x32_bf16 v[204:207], a[128:131], a[96:99], v[204:207]
    v_exp_f32 v219, v219
    v_mfma_f32_16x16x32_bf16 v[204:207], a[136:139], a[104:107], v[204:207]
    ds_read_b128 a[128:131], v226 offset:51200
    v_fma_f32 v208, v208, s21, v238
    v_mfma_f32_16x16x32_bf16 v[204:207], a[140:143], a[108:111], v[204:207]
    s_and_b32 s39, s2, 7
    buffer_load_dwordx4 v234, s[8:11], s34 offen offset:2048 nt lds
    v_exp_f32 v208, v208
    v_mfma_f32_16x16x32_bf16 v[200:203], a[140:143], a[76:79], v[200:203]
    v_cvt_pk_bf16_f32 v55, v218, v219
    v_fma_f32 v209, v209, s21, v238
    v_mfma_f32_16x16x32_bf16 v[200:203], a[136:139], a[72:75], v[200:203]
    v_exp_f32 v209, v209
    v_mfma_f32_16x16x32_bf16 v[196:199], a[136:139], a[40:43], v[196:199]
    s_lshl_b32 s39, s39, 5
    ds_read_b128 a[132:135], v227 offset:51200
    v_fma_f32 v210, v210, s21, v238
    v_mfma_f32_16x16x32_bf16 v[196:199], a[140:143], a[44:47], v[196:199]
    v_exp_f32 v210, v210
    v_mfma_f32_16x16x32_bf16 v[192:195], a[140:143], a[12:15], v[192:195]
    v_cvt_pk_bf16_f32 v38, v208, v209
    v_fma_f32 v211, v211, s21, v238
    v_mfma_f32_16x16x32_bf16 v[192:195], a[136:139], a[8:11], v[192:195]
    s_waitcnt lgkmcnt(2)
    v_exp_f32 v211, v211
    v_smfmac_f32_16x16x64_bf16 a[200:203], a[208:211], v[48:55], v254
    s_add_u32 s39, s39, s36
    buffer_load_dwordx4 v235, s[8:11], s34 offen offset:3072 nt lds
    v_mfma_f32_16x16x32_bf16 v[192:195], a[144:147], a[16:19], v[192:195]
    ds_read_b128 a[136:139], v226 offset:55296
    v_fma_f32 v212, v212, s21, v239
    v_mfma_f32_16x16x32_bf16 v[192:195], a[148:151], a[20:23], v[192:195]
    v_exp_f32 v212, v212
    v_mfma_f32_16x16x32_bf16 v[196:199], a[148:151], a[52:55], v[196:199]
    v_cvt_pk_bf16_f32 v39, v210, v211
    v_fma_f32 v213, v213, s21, v239
    v_mfma_f32_16x16x32_bf16 v[196:199], a[144:147], a[48:51], v[196:199]
    s_add_u32 s39, s39, 30
    v_exp_f32 v213, v213
    v_mfma_f32_16x16x32_bf16 v[200:203], a[144:147], a[80:83], v[200:203]
    s_add_u32 m0, s23, 0x4000
    ds_read_b128 a[140:143], v227 offset:55296
    v_fma_f32 v214, v214, s21, v239
    v_mfma_f32_16x16x32_bf16 v[200:203], a[148:151], a[84:87], v[200:203]
    s_add_u32 s34, s28, 0x20000
    v_exp_f32 v214, v214
    v_mfma_f32_16x16x32_bf16 v[204:207], a[148:151], a[116:119], v[204:207]
    s_mul_i32 s39, s39, 196608
    v_cvt_pk_bf16_f32 v46, v212, v213
    v_fma_f32 v215, v215, s21, v239
    v_mfma_f32_16x16x32_bf16 v[204:207], a[144:147], a[112:115], v[204:207]
    v_exp_f32 v215, v215
    v_mfma_f32_16x16x32_bf16 v[204:207], a[152:155], a[120:123], v[204:207]
    ds_read_b128 a[144:147], v226 offset:59392
    v_fma_f32 v220, v220, s21, v241
    v_mfma_f32_16x16x32_bf16 v[204:207], a[156:159], a[124:127], v[204:207]
    v_exp_f32 v220, v220
    v_mfma_f32_16x16x32_bf16 v[200:203], a[156:159], a[92:95], v[200:203]
    s_lshl2_add_u32 s39, s23, s39
    v_cvt_pk_bf16_f32 v47, v214, v215
    v_fma_f32 v221, v221, s21, v241
    v_mfma_f32_16x16x32_bf16 v[200:203], a[152:155], a[88:91], v[200:203]
    buffer_load_dwordx4 v232, s[8:11], s34 offen nt lds
    v_exp_f32 v221, v221
    v_mfma_f32_16x16x32_bf16 v[196:199], a[152:155], a[56:59], v[196:199]
    ds_read_b128 a[148:151], v227 offset:59392
    v_fma_f32 v222, v222, s21, v241
    v_mfma_f32_16x16x32_bf16 v[196:199], a[156:159], a[60:63], v[196:199]
    s_bfe_u32 s37, s2, 0x10005
    v_exp_f32 v222, v222
    v_mfma_f32_16x16x32_bf16 v[192:195], a[156:159], a[28:31], v[192:195]
    v_cvt_pk_bf16_f32 v62, v220, v221
    v_fma_f32 v223, v223, s21, v241
    v_mfma_f32_16x16x32_bf16 v[192:195], a[152:155], a[24:27], v[192:195]
    s_waitcnt lgkmcnt(2)
    v_exp_f32 v223, v223
    v_mfma_f32_16x16x32_bf16 v[208:211], a[128:131], a[0:3], 0
    ds_read_b128 a[152:155], v226 offset:63488
    v_fma_f32 v200, v200, s21, v240
    v_mfma_f32_16x16x32_bf16 v[208:211], a[132:135], a[4:7], v[208:211]
    s_xor_b32 s36, s36, s37
    v_exp_f32 v200, v200
    v_mfma_f32_16x16x32_bf16 v[212:215], a[132:135], a[36:39], 0
    v_cvt_pk_bf16_f32 v63, v222, v223
    v_fma_f32 v201, v201, s21, v240
    v_mfma_f32_16x16x32_bf16 v[212:215], a[128:131], a[32:35], v[212:215]
    v_exp_f32 v201, v201
    v_mfma_f32_16x16x32_bf16 v[216:219], a[128:131], a[64:67], 0
    s_lshl_b32 s36, s36, 7
    ds_read_b128 a[156:159], v227 offset:63488
    v_fma_f32 v202, v202, s21, v240
    v_mfma_f32_16x16x32_bf16 v[216:219], a[132:135], a[68:71], v[216:219]
    v_exp_f32 v202, v202
    v_mfma_f32_16x16x32_bf16 v[220:223], a[132:135], a[100:103], 0
    v_cvt_pk_bf16_f32 v80, v200, v201
    v_fma_f32 v203, v203, s21, v240
    v_mfma_f32_16x16x32_bf16 v[220:223], a[128:131], a[96:99], v[220:223]
    v_exp_f32 v203, v203
    v_mfma_f32_16x16x32_bf16 v[220:223], a[136:139], a[104:107], v[220:223]
    s_add_u32 s39, s39, s36
    buffer_load_dwordx4 v233, s[8:11], s34 offen offset:1024 nt lds
    v_fma_f32 v192, v192, s21, v238
    v_mfma_f32_16x16x32_bf16 v[220:223], a[140:143], a[108:111], v[220:223]
    v_exp_f32 v192, v192
    v_mfma_f32_16x16x32_bf16 v[216:219], a[140:143], a[76:79], v[216:219]
    v_cvt_pk_bf16_f32 v81, v202, v203
    v_fma_f32 v193, v193, s21, v238
    v_mfma_f32_16x16x32_bf16 v[216:219], a[136:139], a[72:75], v[216:219]
    v_exp_f32 v193, v193
    v_mfma_f32_16x16x32_bf16 v[212:215], a[136:139], a[40:43], v[212:215]
    s_bfe_u32 s36, s2, 0x10004
    buffer_load_dwordx4 v234, s[8:11], s34 offen offset:2048 nt lds
    v_fma_f32 v194, v194, s21, v238
    v_mfma_f32_16x16x32_bf16 v[212:215], a[140:143], a[44:47], v[212:215]
    v_exp_f32 v194, v194
    v_mfma_f32_16x16x32_bf16 v[208:211], a[140:143], a[12:15], v[208:211]
    s_lshl_b32 s36, s36, 16
    v_cvt_pk_bf16_f32 v64, v192, v193
    v_fma_f32 v195, v195, s21, v238
    v_mfma_f32_16x16x32_bf16 v[208:211], a[136:139], a[8:11], v[208:211]
    s_waitcnt vmcnt(14) lgkmcnt(0)
    v_exp_f32 v195, v195
    v_smfmac_f32_16x16x64_bf16 a[192:195], a[208:211], v[32:39], v254
    s_barrier
    buffer_load_dwordx4 v235, s[8:11], s34 offen offset:3072 nt lds
    v_mfma_f32_16x16x32_bf16 v[208:211], a[144:147], a[16:19], v[208:211]
    ds_read_b128 a[128:131], v224 offset:49152
    v_fma_f32 v196, v196, s21, v239
    v_mfma_f32_16x16x32_bf16 v[208:211], a[148:151], a[20:23], v[208:211]
    ds_read_b128 a[132:135], v225 offset:49152
    v_exp_f32 v196, v196
    v_mfma_f32_16x16x32_bf16 v[212:215], a[148:151], a[52:55], v[212:215]
    s_add_u32 s36, s36, s39
    v_cvt_pk_bf16_f32 v65, v194, v195
    v_fma_f32 v197, v197, s21, v239
    v_mfma_f32_16x16x32_bf16 v[212:215], a[144:147], a[48:51], v[212:215]
    v_exp_f32 v197, v197
    v_mfma_f32_16x16x32_bf16 v[216:219], a[144:147], a[80:83], v[216:219]
    ds_read_b128 a[136:139], v224 offset:53248
    v_fma_f32 v198, v198, s21, v239
    v_mfma_f32_16x16x32_bf16 v[216:219], a[148:151], a[84:87], v[216:219]
    ds_read_b128 a[140:143], v225 offset:53248
    v_exp_f32 v198, v198
    v_mfma_f32_16x16x32_bf16 v[220:223], a[148:151], a[116:119], v[220:223]
    v_cvt_pk_bf16_f32 v72, v196, v197
    v_fma_f32 v199, v199, s21, v239
    v_mfma_f32_16x16x32_bf16 v[220:223], a[144:147], a[112:115], v[220:223]
    v_exp_f32 v199, v199
    v_mfma_f32_16x16x32_bf16 v[220:223], a[152:155], a[120:123], v[220:223]
    s_add_u32 m0, s23, 0x8000
    ds_read_b128 a[144:147], v224 offset:57344
    v_fma_f32 v204, v204, s21, v241
    v_mfma_f32_16x16x32_bf16 v[220:223], a[156:159], a[124:127], v[220:223]
    s_add_u32 s34, s28, 0x24000
    v_exp_f32 v204, v204
    v_mfma_f32_16x16x32_bf16 v[216:219], a[156:159], a[92:95], v[216:219]
    v_cvt_pk_bf16_f32 v73, v198, v199
    v_fma_f32 v205, v205, s21, v241
    v_mfma_f32_16x16x32_bf16 v[216:219], a[152:155], a[88:91], v[216:219]
    v_exp_f32 v205, v205
    v_mfma_f32_16x16x32_bf16 v[212:215], a[152:155], a[56:59], v[212:215]
    ds_read_b128 a[148:151], v225 offset:57344
    v_fma_f32 v206, v206, s21, v241
    v_mfma_f32_16x16x32_bf16 v[212:215], a[156:159], a[60:63], v[212:215]
    v_exp_f32 v206, v206
    v_mfma_f32_16x16x32_bf16 v[208:211], a[156:159], a[28:31], v[208:211]
    v_cvt_pk_bf16_f32 v88, v204, v205
    v_fma_f32 v207, v207, s21, v241
    v_mfma_f32_16x16x32_bf16 v[208:211], a[152:155], a[24:27], v[208:211]
    s_waitcnt lgkmcnt(2)
    buffer_load_dwordx4 v232, s[8:11], s34 offen nt lds
    v_exp_f32 v207, v207
    v_mfma_f32_16x16x32_bf16 v[192:195], a[128:131], a[0:3], 0
    ds_read_b128 a[152:155], v224 offset:61440
    v_fma_f32 v216, v216, s21, v240
    v_mfma_f32_16x16x32_bf16 v[192:195], a[132:135], a[4:7], v[192:195]
    v_exp_f32 v216, v216
    v_mfma_f32_16x16x32_bf16 v[196:199], a[132:135], a[36:39], 0
    v_cvt_pk_bf16_f32 v89, v206, v207
    v_fma_f32 v217, v217, s21, v240
    v_mfma_f32_16x16x32_bf16 v[196:199], a[128:131], a[32:35], v[196:199]
    v_exp_f32 v217, v217
    v_mfma_f32_16x16x32_bf16 v[200:203], a[128:131], a[64:67], 0
    ds_read_b128 a[156:159], v225 offset:61440
    v_fma_f32 v218, v218, s21, v240
    v_mfma_f32_16x16x32_bf16 v[200:203], a[132:135], a[68:71], v[200:203]
    buffer_load_dwordx4 v233, s[8:11], s34 offen offset:1024 nt lds
    v_exp_f32 v218, v218
    v_mfma_f32_16x16x32_bf16 v[204:207], a[132:135], a[100:103], 0
    v_cvt_pk_bf16_f32 v82, v216, v217
    v_fma_f32 v219, v219, s21, v240
    v_mfma_f32_16x16x32_bf16 v[204:207], a[128:131], a[96:99], v[204:207]
    v_exp_f32 v219, v219
    v_mfma_f32_16x16x32_bf16 v[204:207], a[136:139], a[104:107], v[204:207]
    ds_read_b128 a[128:131], v224 offset:51200
    v_fma_f32 v208, v208, s21, v238
    v_mfma_f32_16x16x32_bf16 v[204:207], a[140:143], a[108:111], v[204:207]
    v_exp_f32 v208, v208
    v_mfma_f32_16x16x32_bf16 v[200:203], a[140:143], a[76:79], v[200:203]
    v_cvt_pk_bf16_f32 v83, v218, v219
    v_fma_f32 v209, v209, s21, v238
    v_mfma_f32_16x16x32_bf16 v[200:203], a[136:139], a[72:75], v[200:203]
    v_exp_f32 v209, v209
    v_mfma_f32_16x16x32_bf16 v[196:199], a[136:139], a[40:43], v[196:199]
    ds_read_b128 a[132:135], v225 offset:51200
    v_fma_f32 v210, v210, s21, v238
    v_mfma_f32_16x16x32_bf16 v[196:199], a[140:143], a[44:47], v[196:199]
    v_exp_f32 v210, v210
    v_mfma_f32_16x16x32_bf16 v[192:195], a[140:143], a[12:15], v[192:195]
    v_cvt_pk_bf16_f32 v66, v208, v209
    v_fma_f32 v211, v211, s21, v238
    v_mfma_f32_16x16x32_bf16 v[192:195], a[136:139], a[8:11], v[192:195]
    s_waitcnt lgkmcnt(2)
    v_exp_f32 v211, v211
    v_smfmac_f32_16x16x64_bf16 a[196:199], a[208:211], v[40:47], v254
    buffer_load_dwordx4 v234, s[8:11], s34 offen offset:2048 nt lds
    v_mfma_f32_16x16x32_bf16 v[192:195], a[144:147], a[16:19], v[192:195]
    ds_read_b128 a[136:139], v224 offset:55296
    v_fma_f32 v212, v212, s21, v239
    v_mfma_f32_16x16x32_bf16 v[192:195], a[148:151], a[20:23], v[192:195]
    v_exp_f32 v212, v212
    v_mfma_f32_16x16x32_bf16 v[196:199], a[148:151], a[52:55], v[196:199]
    v_cvt_pk_bf16_f32 v67, v210, v211
    v_fma_f32 v213, v213, s21, v239
    v_mfma_f32_16x16x32_bf16 v[196:199], a[144:147], a[48:51], v[196:199]
    v_exp_f32 v213, v213
    v_mfma_f32_16x16x32_bf16 v[200:203], a[144:147], a[80:83], v[200:203]
    ds_read_b128 a[140:143], v225 offset:55296
    v_fma_f32 v214, v214, s21, v239
    v_mfma_f32_16x16x32_bf16 v[200:203], a[148:151], a[84:87], v[200:203]
    v_exp_f32 v214, v214
    v_mfma_f32_16x16x32_bf16 v[204:207], a[148:151], a[116:119], v[204:207]
    v_cvt_pk_bf16_f32 v74, v212, v213
    v_fma_f32 v215, v215, s21, v239
    v_mfma_f32_16x16x32_bf16 v[204:207], a[144:147], a[112:115], v[204:207]
    v_exp_f32 v215, v215
    v_mfma_f32_16x16x32_bf16 v[204:207], a[152:155], a[120:123], v[204:207]
    ds_read_b128 a[144:147], v224 offset:59392
    v_fma_f32 v220, v220, s21, v241
    v_mfma_f32_16x16x32_bf16 v[204:207], a[156:159], a[124:127], v[204:207]
    buffer_load_dwordx4 v235, s[8:11], s34 offen offset:3072 nt lds
    v_exp_f32 v220, v220
    v_mfma_f32_16x16x32_bf16 v[200:203], a[156:159], a[92:95], v[200:203]
    v_cvt_pk_bf16_f32 v75, v214, v215
    v_fma_f32 v221, v221, s21, v241
    v_mfma_f32_16x16x32_bf16 v[200:203], a[152:155], a[88:91], v[200:203]
    v_exp_f32 v221, v221
    v_mfma_f32_16x16x32_bf16 v[196:199], a[152:155], a[56:59], v[196:199]
    s_add_u32 m0, s23, 0x14000
    ds_read_b128 a[148:151], v225 offset:59392
    v_fma_f32 v222, v222, s21, v241
    v_mfma_f32_16x16x32_bf16 v[196:199], a[156:159], a[60:63], v[196:199]
L_hop9:
    s_cbranch_execz L_hopret2
    s_add_u32 s34, s40, 0
    v_exp_f32 v222, v222
    v_mfma_f32_16x16x32_bf16 v[192:195], a[156:159], a[28:31], v[192:195]
    v_cvt_pk_bf16_f32 v90, v220, v221
    v_fma_f32 v223, v223, s21, v241
    v_mfma_f32_16x16x32_bf16 v[192:195], a[152:155], a[24:27], v[192:195]
    s_waitcnt lgkmcnt(2)
    v_exp_f32 v223, v223
    v_mfma_f32_16x16x32_bf16 v[208:211], a[128:131], a[0:3], 0
    ds_read_b128 a[152:155], v224 offset:63488
    v_fma_f32 v200, v200, s21, v240
    v_mfma_f32_16x16x32_bf16 v[208:211], a[132:135], a[4:7], v[208:211]
    v_exp_f32 v200, v200
    v_mfma_f32_16x16x32_bf16 v[212:215], a[132:135], a[36:39], 0
    v_cvt_pk_bf16_f32 v91, v222, v223
    v_fma_f32 v201, v201, s21, v240
    v_mfma_f32_16x16x32_bf16 v[212:215], a[128:131], a[32:35], v[212:215]
    v_exp_f32 v201, v201
    v_mfma_f32_16x16x32_bf16 v[216:219], a[128:131], a[64:67], 0
    ds_read_b128 a[156:159], v225 offset:63488
    v_fma_f32 v202, v202, s21, v240
    v_mfma_f32_16x16x32_bf16 v[216:219], a[132:135], a[68:71], v[216:219]
    v_exp_f32 v202, v202
    v_mfma_f32_16x16x32_bf16 v[220:223], a[132:135], a[100:103], 0
    v_cvt_pk_bf16_f32 v84, v200, v201
    v_fma_f32 v203, v203, s21, v240
    v_mfma_f32_16x16x32_bf16 v[220:223], a[128:131], a[96:99], v[220:223]
    v_exp_f32 v203, v203
    v_mfma_f32_16x16x32_bf16 v[220:223], a[136:139], a[104:107], v[220:223]
    buffer_load_dwordx4 v232, s[12:15], s34 offen nt lds
    v_fma_f32 v192, v192, s21, v238
    v_mfma_f32_16x16x32_bf16 v[220:223], a[140:143], a[108:111], v[220:223]
    v_exp_f32 v192, v192
    v_mfma_f32_16x16x32_bf16 v[216:219], a[140:143], a[76:79], v[216:219]
    v_cvt_pk_bf16_f32 v85, v202, v203
    v_fma_f32 v193, v193, s21, v238
    v_mfma_f32_16x16x32_bf16 v[216:219], a[136:139], a[72:75], v[216:219]
    v_exp_f32 v193, v193
    v_mfma_f32_16x16x32_bf16 v[212:215], a[136:139], a[40:43], v[212:215]
    buffer_load_dwordx4 v233, s[12:15], s34 offen offset:1024 nt lds
    v_fma_f32 v194, v194, s21, v238
    v_mfma_f32_16x16x32_bf16 v[212:215], a[140:143], a[44:47], v[212:215]
    v_exp_f32 v194, v194
    v_mfma_f32_16x16x32_bf16 v[208:211], a[140:143], a[12:15], v[208:211]
    v_cvt_pk_bf16_f32 v68, v192, v193
    v_fma_f32 v195, v195, s21, v238
    v_mfma_f32_16x16x32_bf16 v[208:211], a[136:139], a[8:11], v[208:211]
    s_waitcnt vmcnt(14) lgkmcnt(0)
    v_exp_f32 v195, v195
    v_smfmac_f32_16x16x64_bf16 a[204:207], a[208:211], v[56:63], v254
    s_barrier
    buffer_load_dwordx4 v234, s[12:15], s34 offen offset:2048 nt lds
    v_mfma_f32_16x16x32_bf16 v[208:211], a[144:147], a[16:19], v[208:211]
    ds_read_b128 a[128:131], v226 offset:0
    v_fma_f32 v196, v196, s21, v239
    v_mfma_f32_16x16x32_bf16 v[208:211], a[148:151], a[20:23], v[208:211]
    ds_read_b128 a[132:135], v227 offset:0
    v_exp_f32 v196, v196
    v_mfma_f32_16x16x32_bf16 v[212:215], a[148:151], a[52:55], v[212:215]
    v_cvt_pk_bf16_f32 v69, v194, v195
    v_fma_f32 v197, v197, s21, v239
    v_mfma_f32_16x16x32_bf16 v[212:215], a[144:147], a[48:51], v[212:215]
    v_exp_f32 v197, v197
    v_mfma_f32_16x16x32_bf16 v[216:219], a[144:147], a[80:83], v[216:219]
    ds_read_b128 a[136:139], v226 offset:4096
    v_fma_f32 v198, v198, s21, v239
    v_mfma_f32_16x16x32_bf16 v[216:219], a[148:151], a[84:87], v[216:219]
    ds_read_b128 a[140:143], v227 offset:4096
    v_exp_f32 v198, v198
    v_mfma_f32_16x16x32_bf16 v[220:223], a[148:151], a[116:119], v[220:223]
    v_cvt_pk_bf16_f32 v76, v196, v197
    v_fma_f32 v199, v199, s21, v239
    v_mfma_f32_16x16x32_bf16 v[220:223], a[144:147], a[112:115], v[220:223]
    v_exp_f32 v199, v199
    v_mfma_f32_16x16x32_bf16 v[220:223], a[152:155], a[120:123], v[220:223]
    ds_read_b128 a[144:147], v226 offset:8192
    v_fma_f32 v204, v204, s21, v241
    v_mfma_f32_16x16x32_bf16 v[220:223], a[156:159], a[124:127], v[220:223]
    v_exp_f32 v204, v204
    v_mfma_f32_16x16x32_bf16 v[216:219], a[156:159], a[92:95], v[216:219]
    v_cvt_pk_bf16_f32 v77, v198, v199
    v_fma_f32 v205, v205, s21, v241
    v_mfma_f32_16x16x32_bf16 v[216:219], a[152:155], a[88:91], v[216:219]
    buffer_load_dwordx4 v235, s[12:15], s34 offen offset:3072 nt lds
    v_exp_f32 v205, v205
    v_mfma_f32_16x16x32_bf16 v[212:215], a[152:155], a[56:59], v[212:215]
    ds_read_b128 a[148:151], v227 offset:8192
    v_fma_f32 v206, v206, s21, v241
    v_mfma_f32_16x16x32_bf16 v[212:215], a[156:159], a[60:63], v[212:215]
    v_exp_f32 v206, v206
    v_mfma_f32_16x16x32_bf16 v[208:211], a[156:159], a[28:31], v[208:211]
    v_cvt_pk_bf16_f32 v92, v204, v205
    v_fma_f32 v207, v207, s21, v241
    v_mfma_f32_16x16x32_bf16 v[208:211], a[152:155], a[24:27], v[208:211]
    s_waitcnt lgkmcnt(2)
    v_exp_f32 v207, v207
    v_mfma_f32_16x16x32_bf16 v[192:195], a[128:131], a[0:3], 0
    s_add_u32 m0, s23, 0xc000
    ds_read_b128 a[152:155], v226 offset:12288
    v_fma_f32 v216, v216, s21, v240
    v_mfma_f32_16x16x32_bf16 v[192:195], a[132:135], a[4:7], v[192:195]
    s_add_u32 s34, s28, 0x28000
    v_exp_f32 v216, v216
    v_mfma_f32_16x16x32_bf16 v[196:199], a[132:135], a[36:39], 0
    v_cvt_pk_bf16_f32 v93, v206, v207
    v_fma_f32 v217, v217, s21, v240
    v_mfma_f32_16x16x32_bf16 v[196:199], a[128:131], a[32:35], v[196:199]
    v_exp_f32 v217, v217
    v_mfma_f32_16x16x32_bf16 v[200:203], a[128:131], a[64:67], 0
    ds_read_b128 a[156:159], v227 offset:12288
    v_fma_f32 v218, v218, s21, v240
    v_mfma_f32_16x16x32_bf16 v[200:203], a[132:135], a[68:71], v[200:203]
    buffer_load_dwordx4 v232, s[8:11], s34 offen nt lds
    v_exp_f32 v218, v218
    v_mfma_f32_16x16x32_bf16 v[204:207], a[132:135], a[100:103], 0
    v_cvt_pk_bf16_f32 v86, v216, v217
    v_fma_f32 v219, v219, s21, v240
    v_mfma_f32_16x16x32_bf16 v[204:207], a[128:131], a[96:99], v[204:207]
    v_exp_f32 v219, v219
    v_mfma_f32_16x16x32_bf16 v[204:207], a[136:139], a[104:107], v[204:207]
    ds_read_b128 a[128:131], v226 offset:2048
    v_fma_f32 v208, v208, s21, v238
    v_mfma_f32_16x16x32_bf16 v[204:207], a[140:143], a[108:111], v[204:207]
    v_exp_f32 v208, v208
    v_mfma_f32_16x16x32_bf16 v[200:203], a[140:143], a[76:79], v[200:203]
    v_cvt_pk_bf16_f32 v87, v218, v219
    v_fma_f32 v209, v209, s21, v238
    v_mfma_f32_16x16x32_bf16 v[200:203], a[136:139], a[72:75], v[200:203]
    v_exp_f32 v209, v209
    v_mfma_f32_16x16x32_bf16 v[196:199], a[136:139], a[40:43], v[196:199]
    ds_read_b128 a[132:135], v227 offset:2048
    v_fma_f32 v210, v210, s21, v238
    v_mfma_f32_16x16x32_bf16 v[196:199], a[140:143], a[44:47], v[196:199]
    v_exp_f32 v210, v210
    v_mfma_f32_16x16x32_bf16 v[192:195], a[140:143], a[12:15], v[192:195]
    v_cvt_pk_bf16_f32 v70, v208, v209
    v_fma_f32 v211, v211, s21, v238
    v_mfma_f32_16x16x32_bf16 v[192:195], a[136:139], a[8:11], v[192:195]
    s_waitcnt lgkmcnt(2)
    v_exp_f32 v211, v211
    v_smfmac_f32_16x16x64_bf16 a[200:203], a[208:211], v[80:87], v254
    buffer_load_dwordx4 v233, s[8:11], s34 offen offset:1024 nt lds
    v_mfma_f32_16x16x32_bf16 v[192:195], a[144:147], a[16:19], v[192:195]
    ds_read_b128 a[136:139], v226 offset:6144
    v_fma_f32 v212, v212, s21, v239
    v_mfma_f32_16x16x32_bf16 v[192:195], a[148:151], a[20:23], v[192:195]
    v_exp_f32 v212, v212
    v_mfma_f32_16x16x32_bf16 v[196:199], a[148:151], a[52:55], v[196:199]
    v_cvt_pk_bf16_f32 v71, v210, v211
    v_fma_f32 v213, v213, s21, v239
    v_mfma_f32_16x16x32_bf16 v[196:199], a[144:147], a[48:51], v[196:199]
    v_exp_f32 v213, v213
    v_mfma_f32_16x16x32_bf16 v[200:203], a[144:147], a[80:83], v[200:203]
    ds_read_b128 a[140:143], v227 offset:6144
    v_fma_f32 v214, v214, s21, v239
    v_mfma_f32_16x16x32_bf16 v[200:203], a[148:151], a[84:87], v[200:203]
    buffer_load_dwordx4 v234, s[8:11], s34 offen offset:2048 nt lds
    v_exp_f32 v214, v214
    v_mfma_f32_16x16x32_bf16 v[204:207], a[148:151], a[116:119], v[204:207]
    v_cvt_pk_bf16_f32 v78, v212, v213
    v_fma_f32 v215, v215, s21, v239
    v_mfma_f32_16x16x32_bf16 v[204:207], a[144:147], a[112:115], v[204:207]
    v_exp_f32 v215, v215
    v_mfma_f32_16x16x32_bf16 v[204:207], a[152:155], a[120:123], v[204:207]
    ds_read_b128 a[144:147], v226 offset:10240
    v_fma_f32 v220, v220, s21, v241
    v_mfma_f32_16x16x32_bf16 v[204:207], a[156:159], a[124:127], v[204:207]
    v_exp_f32 v220, v220
    v_mfma_f32_16x16x32_bf16 v[200:203], a[156:159], a[92:95], v[200:203]
    v_cvt_pk_bf16_f32 v79, v214, v215
    v_fma_f32 v221, v221, s21, v241
    v_mfma_f32_16x16x32_bf16 v[200:203], a[152:155], a[88:91], v[200:203]
    v_exp_f32 v221, v221
    v_mfma_f32_16x16x32_bf16 v[196:199], a[152:155], a[56:59], v[196:199]
    ds_read_b128 a[148:151], v227 offset:10240
    v_fma_f32 v222, v222, s21, v241
    v_mfma_f32_16x16x32_bf16 v[196:199], a[156:159], a[60:63], v[196:199]
    v_exp_f32 v222, v222
    v_mfma_f32_16x16x32_bf16 v[192:195], a[156:159], a[28:31], v[192:195]
    v_cvt_pk_bf16_f32 v94, v220, v221
    v_fma_f32 v223, v223, s21, v241
    v_mfma_f32_16x16x32_bf16 v[192:195], a[152:155], a[24:27], v[192:195]
    s_waitcnt lgkmcnt(2)
    buffer_load_dwordx4 v235, s[8:11], s34 offen offset:3072 nt lds
    v_exp_f32 v223, v223
    v_mfma_f32_16x16x32_bf16 v[208:211], a[128:131], a[0:3], 0
    ds_read_b128 a[152:155], v226 offset:14336
    v_fma_f32 v200, v200, s21, v240
    v_mfma_f32_16x16x32_bf16 v[208:211], a[132:135], a[4:7], v[208:211]
    v_exp_f32 v200, v200
    v_mfma_f32_16x16x32_bf16 v[212:215], a[132:135], a[36:39], 0
    v_cvt_pk_bf16_f32 v95, v222, v223
    v_fma_f32 v201, v201, s21, v240
    v_mfma_f32_16x16x32_bf16 v[212:215], a[128:131], a[32:35], v[212:215]
    v_exp_f32 v201, v201
    v_mfma_f32_16x16x32_bf16 v[216:219], a[128:131], a[64:67], 0
    s_add_u32 m0, s23, 0x18000
    ds_read_b128 a[156:159], v227 offset:14336
    v_fma_f32 v202, v202, s21, v240
    v_mfma_f32_16x16x32_bf16 v[216:219], a[132:135], a[68:71], v[216:219]
    s_add_u32 s34, s40, 0x10000
    v_exp_f32 v202, v202
    v_mfma_f32_16x16x32_bf16 v[220:223], a[132:135], a[100:103], 0
    v_cvt_pk_bf16_f32 v112, v200, v201
    v_fma_f32 v203, v203, s21, v240
    v_mfma_f32_16x16x32_bf16 v[220:223], a[128:131], a[96:99], v[220:223]
    v_exp_f32 v203, v203
    v_mfma_f32_16x16x32_bf16 v[220:223], a[136:139], a[104:107], v[220:223]
    buffer_load_dwordx4 v232, s[12:15], s34 offen nt lds
    v_fma_f32 v192, v192, s21, v238
    v_mfma_f32_16x16x32_bf16 v[220:223], a[140:143], a[108:111], v[220:223]
    v_exp_f32 v192, v192
    v_mfma_f32_16x16x32_bf16 v[216:219], a[140:143], a[76:79], v[216:219]
    v_cvt_pk_bf16_f32 v113, v202, v203
    v_fma_f32 v193, v193, s21, v238
    v_mfma_f32_16x16x32_bf16 v[216:219], a[136:139], a[72:75], v[216:219]
    v_exp_f32 v193, v193
    v_mfma_f32_16x16x32_bf16 v[212:215], a[136:139], a[40:43], v[212:215]
    buffer_load_dwordx4 v233, s[12:15], s34 offen offset:1024 nt lds
    v_fma_f32 v194, v194, s21, v238
    v_mfma_f32_16x16x32_bf16 v[212:215], a[140:143], a[44:47], v[212:215]
    v_exp_f32 v194, v194
    v_mfma_f32_16x16x32_bf16 v[208:211], a[140:143], a[12:15], v[208:211]
    v_cvt_pk_bf16_f32 v96, v192, v193
    v_fma_f32 v195, v195, s21, v238
    v_mfma_f32_16x16x32_bf16 v[208:211], a[136:139], a[8:11], v[208:211]
    s_waitcnt vmcnt(18) lgkmcnt(0)
    v_exp_f32 v195, v195
    v_smfmac_f32_16x16x64_bf16 a[192:195], a[208:211], v[64:71], v254
    s_barrier
    v_mfma_f32_16x16x32_bf16 v[208:211], a[144:147], a[16:19], v[208:211]
    ds_read_b128 a[128:131], v224 offset:0
    v_fma_f32 v196, v196, s21, v239
    v_mfma_f32_16x16x32_bf16 v[208:211], a[148:151], a[20:23], v[208:211]
    ds_read_b128 a[132:135], v225 offset:0
    v_exp_f32 v196, v196
    v_mfma_f32_16x16x32_bf16 v[212:215], a[148:151], a[52:55], v[212:215]
    v_cvt_pk_bf16_f32 v97, v194, v195
    v_fma_f32 v197, v197, s21, v239
    v_mfma_f32_16x16x32_bf16 v[212:215], a[144:147], a[48:51], v[212:215]
    v_exp_f32 v197, v197
    v_mfma_f32_16x16x32_bf16 v[216:219], a[144:147], a[80:83], v[216:219]
    ds_read_b128 a[136:139], v224 offset:4096
    v_fma_f32 v198, v198, s21, v239
    v_mfma_f32_16x16x32_bf16 v[216:219], a[148:151], a[84:87], v[216:219]
    ds_read_b128 a[140:143], v225 offset:4096
    v_exp_f32 v198, v198
    v_mfma_f32_16x16x32_bf16 v[220:223], a[148:151], a[116:119], v[220:223]
    v_cvt_pk_bf16_f32 v104, v196, v197
    v_fma_f32 v199, v199, s21, v239
    v_mfma_f32_16x16x32_bf16 v[220:223], a[144:147], a[112:115], v[220:223]
    v_exp_f32 v199, v199
    v_mfma_f32_16x16x32_bf16 v[220:223], a[152:155], a[120:123], v[220:223]
    ds_read_b128 a[144:147], v224 offset:8192
    v_fma_f32 v204, v204, s21, v241
    v_mfma_f32_16x16x32_bf16 v[220:223], a[156:159], a[124:127], v[220:223]
    v_exp_f32 v204, v204
    v_mfma_f32_16x16x32_bf16 v[216:219], a[156:159], a[92:95], v[216:219]
    v_cvt_pk_bf16_f32 v105, v198, v199
    v_fma_f32 v205, v205, s21, v241
    v_mfma_f32_16x16x32_bf16 v[216:219], a[152:155], a[88:91], v[216:219]
    buffer_load_dwordx4 v234, s[12:15], s34 offen offset:2048 nt lds
    v_exp_f32 v205, v205
    v_mfma_f32_16x16x32_bf16 v[212:215], a[152:155], a[56:59], v[212:215]
    ds_read_b128 a[148:151], v225 offset:8192
    v_fma_f32 v206, v206, s21, v241
    v_mfma_f32_16x16x32_bf16 v[212:215], a[156:159], a[60:63], v[212:215]
    v_exp_f32 v206, v206
    v_mfma_f32_16x16x32_bf16 v[208:211], a[156:159], a[28:31], v[208:211]
    v_cvt_pk_bf16_f32 v120, v204, v205
    v_fma_f32 v207, v207, s21, v241
    v_mfma_f32_16x16x32_bf16 v[208:211], a[152:155], a[24:27], v[208:211]
    s_waitcnt lgkmcnt(2)
    v_exp_f32 v207, v207
    v_mfma_f32_16x16x32_bf16 v[192:195], a[128:131], a[0:3], 0
    ds_read_b128 a[152:155], v224 offset:12288
    v_fma_f32 v216, v216, s21, v240
    v_mfma_f32_16x16x32_bf16 v[192:195], a[132:135], a[4:7], v[192:195]
    v_exp_f32 v216, v216
    v_mfma_f32_16x16x32_bf16 v[196:199], a[132:135], a[36:39], 0
    v_cvt_pk_bf16_f32 v121, v206, v207
    v_fma_f32 v217, v217, s21, v240
    v_mfma_f32_16x16x32_bf16 v[196:199], a[128:131], a[32:35], v[196:199]
    buffer_load_dwordx4 v235, s[12:15], s34 offen offset:3072 nt lds
    v_exp_f32 v217, v217
    v_mfma_f32_16x16x32_bf16 v[200:203], a[128:131], a[64:67], 0
    ds_read_b128 a[156:159], v225 offset:12288
    v_fma_f32 v218, v218, s21, v240
    v_mfma_f32_16x16x32_bf16 v[200:203], a[132:135], a[68:71], v[200:203]
    v_exp_f32 v218, v218
    v_mfma_f32_16x16x32_bf16 v[204:207], a[132:135], a[100:103], 0
    v_cvt_pk_bf16_f32 v114, v216, v217
    v_fma_f32 v219, v219, s21, v240
    v_mfma_f32_16x16x32_bf16 v[204:207], a[128:131], a[96:99], v[204:207]
    v_exp_f32 v219, v219
    v_mfma_f32_16x16x32_bf16 v[204:207], a[136:139], a[104:107], v[204:207]
    s_add_u32 m0, s23, 0x10000
    ds_read_b128 a[128:131], v224 offset:2048
    v_fma_f32 v208, v208, s21, v238
    v_mfma_f32_16x16x32_bf16 v[204:207], a[140:143], a[108:111], v[204:207]
    s_add_u32 s34, s28, 0x2c000
    v_exp_f32 v208, v208
    v_mfma_f32_16x16x32_bf16 v[200:203], a[140:143], a[76:79], v[200:203]
    v_cvt_pk_bf16_f32 v115, v218, v219
    v_fma_f32 v209, v209, s21, v238
    v_mfma_f32_16x16x32_bf16 v[200:203], a[136:139], a[72:75], v[200:203]
    v_exp_f32 v209, v209
    v_mfma_f32_16x16x32_bf16 v[196:199], a[136:139], a[40:43], v[196:199]
    ds_read_b128 a[132:135], v225 offset:2048
    v_fma_f32 v210, v210, s21, v238
    v_mfma_f32_16x16x32_bf16 v[196:199], a[140:143], a[44:47], v[196:199]
    v_exp_f32 v210, v210
    v_mfma_f32_16x16x32_bf16 v[192:195], a[140:143], a[12:15], v[192:195]
    v_cvt_pk_bf16_f32 v98, v208, v209
    v_fma_f32 v211, v211, s21, v238
    v_mfma_f32_16x16x32_bf16 v[192:195], a[136:139], a[8:11], v[192:195]
    s_waitcnt lgkmcnt(2)
    v_exp_f32 v211, v211
    v_smfmac_f32_16x16x64_bf16 a[196:199], a[208:211], v[72:79], v254
    buffer_load_dwordx4 v232, s[8:11], s34 offen nt lds
    v_mfma_f32_16x16x32_bf16 v[192:195], a[144:147], a[16:19], v[192:195]
    ds_read_b128 a[136:139], v224 offset:6144
    v_fma_f32 v212, v212, s21, v239
    v_mfma_f32_16x16x32_bf16 v[192:195], a[148:151], a[20:23], v[192:195]
    v_exp_f32 v212, v212
    v_mfma_f32_16x16x32_bf16 v[196:199], a[148:151], a[52:55], v[196:199]
    v_cvt_pk_bf16_f32 v99, v210, v211
    v_fma_f32 v213, v213, s21, v239
    v_mfma_f32_16x16x32_bf16 v[196:199], a[144:147], a[48:51], v[196:199]
    v_exp_f32 v213, v213
    v_mfma_f32_16x16x32_bf16 v[200:203], a[144:147], a[80:83], v[200:203]
    ds_read_b128 a[140:143], v225 offset:6144
    v_fma_f32 v214, v214, s21, v239
    v_mfma_f32_16x16x32_bf16 v[200:203], a[148:151], a[84:87], v[200:203]
    buffer_load_dwordx4 v233, s[8:11], s34 offen offset:1024 nt lds
    v_exp_f32 v214, v214
    v_mfma_f32_16x16x32_bf16 v[204:207], a[148:151], a[116:119], v[204:207]
    v_cvt_pk_bf16_f32 v106, v212, v213
    v_fma_f32 v215, v215, s21, v239
    v_mfma_f32_16x16x32_bf16 v[204:207], a[144:147], a[112:115], v[204:207]
    v_exp_f32 v215, v215
    v_mfma_f32_16x16x32_bf16 v[204:207], a[152:155], a[120:123], v[204:207]
    ds_read_b128 a[144:147], v224 offset:10240
    v_fma_f32 v220, v220, s21, v241
    v_mfma_f32_16x16x32_bf16 v[204:207], a[156:159], a[124:127], v[204:207]
    v_exp_f32 v220, v220
    v_mfma_f32_16x16x32_bf16 v[200:203], a[156:159], a[92:95], v[200:203]
    v_cvt_pk_bf16_f32 v107, v214, v215
    v_fma_f32 v221, v221, s21, v241
    v_mfma_f32_16x16x32_bf16 v[200:203], a[152:155], a[88:91], v[200:203]
    v_exp_f32 v221, v221
    v_mfma_f32_16x16x32_bf16 v[196:199], a[152:155], a[56:59], v[196:199]
    ds_read_b128 a[148:151], v225 offset:10240
    v_fma_f32 v222, v222, s21, v241
    v_mfma_f32_16x16x32_bf16 v[196:199], a[156:159], a[60:63], v[196:199]
    v_exp_f32 v222, v222
    v_mfma_f32_16x16x32_bf16 v[192:195], a[156:159], a[28:31], v[192:195]
    v_cvt_pk_bf16_f32 v122, v220, v221
    v_fma_f32 v223, v223, s21, v241
    v_mfma_f32_16x16x32_bf16 v[192:195], a[152:155], a[24:27], v[192:195]
    s_waitcnt lgkmcnt(2)
    buffer_load_dwordx4 v234, s[8:11], s34 offen offset:2048 nt lds
    v_exp_f32 v223, v223
    v_mfma_f32_16x16x32_bf16 v[208:211], a[128:131], a[0:3], 0
    ds_read_b128 a[152:155], v224 offset:14336
    v_fma_f32 v200, v200, s21, v240
    v_mfma_f32_16x16x32_bf16 v[208:211], a[132:135], a[4:7], v[208:211]
    v_exp_f32 v200, v200
    v_mfma_f32_16x16x32_bf16 v[212:215], a[132:135], a[36:39], 0
    v_cvt_pk_bf16_f32 v123, v222, v223
    v_fma_f32 v201, v201, s21, v240
    v_mfma_f32_16x16x32_bf16 v[212:215], a[128:131], a[32:35], v[212:215]
    v_exp_f32 v201, v201
    v_mfma_f32_16x16x32_bf16 v[216:219], a[128:131], a[64:67], 0
    ds_read_b128 a[156:159], v225 offset:14336
    v_fma_f32 v202, v202, s21, v240
    v_mfma_f32_16x16x32_bf16 v[216:219], a[132:135], a[68:71], v[216:219]
    v_exp_f32 v202, v202
    v_mfma_f32_16x16x32_bf16 v[220:223], a[132:135], a[100:103], 0
    v_cvt_pk_bf16_f32 v116, v200, v201
    v_fma_f32 v203, v203, s21, v240
    v_mfma_f32_16x16x32_bf16 v[220:223], a[128:131], a[96:99], v[220:223]
    v_exp_f32 v203, v203
    v_mfma_f32_16x16x32_bf16 v[220:223], a[136:139], a[104:107], v[220:223]
    buffer_load_dwordx4 v235, s[8:11], s34 offen offset:3072 nt lds
    v_fma_f32 v192, v192, s21, v238
    v_mfma_f32_16x16x32_bf16 v[220:223], a[140:143], a[108:111], v[220:223]
    v_exp_f32 v192, v192
    v_mfma_f32_16x16x32_bf16 v[216:219], a[140:143], a[76:79], v[216:219]
    v_cvt_pk_bf16_f32 v117, v202, v203
    v_fma_f32 v193, v193, s21, v238
    v_mfma_f32_16x16x32_bf16 v[216:219], a[136:139], a[72:75], v[216:219]
    v_exp_f32 v193, v193
    v_mfma_f32_16x16x32_bf16 v[212:215], a[136:139], a[40:43], v[212:215]
    s_add_u32 m0, s23, 0x1c000
    v_fma_f32 v194, v194, s21, v238
    v_mfma_f32_16x16x32_bf16 v[212:215], a[140:143], a[44:47], v[212:215]
    s_add_u32 s34, s40, 0x20000
    v_exp_f32 v194, v194
    v_mfma_f32_16x16x32_bf16 v[208:211], a[140:143], a[12:15], v[208:211]
    v_cvt_pk_bf16_f32 v100, v192, v193
    v_fma_f32 v195, v195, s21, v238
    v_mfma_f32_16x16x32_bf16 v[208:211], a[136:139], a[8:11], v[208:211]
    s_waitcnt vmcnt(20) lgkmcnt(0)
    v_exp_f32 v195, v195
    v_smfmac_f32_16x16x64_bf16 a[204:207], a[208:211], v[88:95], v254
    s_barrier
    buffer_load_dwordx4 v232, s[12:15], s34 offen nt lds
    v_mfma_f32_16x16x32_bf16 v[208:211], a[144:147], a[16:19], v[208:211]
    ds_read_b128 a[128:131], v224 offset:16384
    v_fma_f32 v196, v196, s21, v239
    v_mfma_f32_16x16x32_bf16 v[208:211], a[148:151], a[20:23], v[208:211]
    ds_read_b128 a[132:135], v225 offset:16384
    v_exp_f32 v196, v196
    v_mfma_f32_16x16x32_bf16 v[212:215], a[148:151], a[52:55], v[212:215]
    v_cvt_pk_bf16_f32 v101, v194, v195
    v_fma_f32 v197, v197, s21, v239
    v_mfma_f32_16x16x32_bf16 v[212:215], a[144:147], a[48:51], v[212:215]
    v_exp_f32 v197, v197
    v_mfma_f32_16x16x32_bf16 v[216:219], a[144:147], a[80:83], v[216:219]
    ds_read_b128 a[136:139], v224 offset:20480
    v_fma_f32 v198, v198, s21, v239
    v_mfma_f32_16x16x32_bf16 v[216:219], a[148:151], a[84:87], v[216:219]
    ds_read_b128 a[140:143], v225 offset:20480
    v_exp_f32 v198, v198
    v_mfma_f32_16x16x32_bf16 v[220:223], a[148:151], a[116:119], v[220:223]
    v_cvt_pk_bf16_f32 v108, v196, v197
    v_fma_f32 v199, v199, s21, v239
    v_mfma_f32_16x16x32_bf16 v[220:223], a[144:147], a[112:115], v[220:223]
    v_exp_f32 v199, v199
    v_mfma_f32_16x16x32_bf16 v[220:223], a[152:155], a[120:123], v[220:223]
    ds_read_b128 a[144:147], v224 offset:24576
    v_fma_f32 v204, v204, s21, v241
    v_mfma_f32_16x16x32_bf16 v[220:223], a[156:159], a[124:127], v[220:223]
    v_exp_f32 v204, v204
    v_mfma_f32_16x16x32_bf16 v[216:219], a[156:159], a[92:95], v[216:219]
    v_cvt_pk_bf16_f32 v109, v198, v199
    v_fma_f32 v205, v205, s21, v241
    v_mfma_f32_16x16x32_bf16 v[216:219], a[152:155], a[88:91], v[216:219]
    buffer_load_dwordx4 v233, s[12:15], s34 offen offset:1024 nt lds
    v_exp_f32 v205, v205
    v_mfma_f32_16x16x32_bf16 v[212:215], a[152:155], a[56:59], v[212:215]
    ds_read_b128 a[148:151], v225 offset:24576
    v_fma_f32 v206, v206, s21, v241
    v_mfma_f32_16x16x32_bf16 v[212:215], a[156:159], a[60:63], v[212:215]
    v_exp_f32 v206, v206
    v_mfma_f32_16x16x32_bf16 v[208:211], a[156:159], a[28:31], v[208:211]
    v_cvt_pk_bf16_f32 v124, v204, v205
    v_fma_f32 v207, v207, s21, v241
    v_mfma_f32_16x16x32_bf16 v[208:211], a[152:155], a[24:27], v[208:211]
    s_waitcnt lgkmcnt(2)
    v_exp_f32 v207, v207
    v_mfma_f32_16x16x32_bf16 v[192:195], a[128:131], a[0:3], 0
    ds_read_b128 a[152:155], v224 offset:28672
    v_fma_f32 v216, v216, s21, v240
    v_mfma_f32_16x16x32_bf16 v[192:195], a[132:135], a[4:7], v[192:195]
    v_exp_f32 v216, v216
    v_mfma_f32_16x16x32_bf16 v[196:199], a[132:135], a[36:39], 0
    v_cvt_pk_bf16_f32 v125, v206, v207
    v_fma_f32 v217, v217, s21, v240
    v_mfma_f32_16x16x32_bf16 v[196:199], a[128:131], a[32:35], v[196:199]
    buffer_load_dwordx4 v234, s[12:15], s34 offen offset:2048 nt lds
    v_exp_f32 v217, v217
    v_mfma_f32_16x16x32_bf16 v[200:203], a[128:131], a[64:67], 0
    ds_read_b128 a[156:159], v225 offset:28672
    v_fma_f32 v218, v218, s21, v240
    v_mfma_f32_16x16x32_bf16 v[200:203], a[132:135], a[68:71], v[200:203]
    v_exp_f32 v218, v218
    v_mfma_f32_16x16x32_bf16 v[204:207], a[132:135], a[100:103], 0
    v_cvt_pk_bf16_f32 v118, v216, v217
    v_fma_f32 v219, v219, s21, v240
    v_mfma_f32_16x16x32_bf16 v[204:207], a[128:131], a[96:99], v[204:207]
    v_exp_f32 v219, v219
    v_mfma_f32_16x16x32_bf16 v[204:207], a[136:139], a[104:107], v[204:207]
    ds_read_b128 a[128:131], v224 offset:18432
    v_fma_f32 v208, v208, s21, v238
    v_mfma_f32_16x16x32_bf16 v[204:207], a[140:143], a[108:111], v[204:207]
    v_exp_f32 v208, v208
    v_mfma_f32_16x16x32_bf16 v[200:203], a[140:143], a[76:79], v[200:203]
    v_cvt_pk_bf16_f32 v119, v218, v219
    v_fma_f32 v209, v209, s21, v238
    v_mfma_f32_16x16x32_bf16 v[200:203], a[136:139], a[72:75], v[200:203]
    v_exp_f32 v209, v209
    v_mfma_f32_16x16x32_bf16 v[196:199], a[136:139], a[40:43], v[196:199]
    ds_read_b128 a[132:135], v225 offset:18432
    v_fma_f32 v210, v210, s21, v238
    v_mfma_f32_16x16x32_bf16 v[196:199], a[140:143], a[44:47], v[196:199]
    v_exp_f32 v210, v210
    v_mfma_f32_16x16x32_bf16 v[192:195], a[140:143], a[12:15], v[192:195]
    v_cvt_pk_bf16_f32 v102, v208, v209
    v_fma_f32 v211, v211, s21, v238
    v_mfma_f32_16x16x32_bf16 v[192:195], a[136:139], a[8:11], v[192:195]
    s_waitcnt lgkmcnt(2)
    v_exp_f32 v211, v211
    v_smfmac_f32_16x16x64_bf16 a[200:203], a[208:211], v[112:119], v254
    buffer_load_dwordx4 v235, s[12:15], s34 offen offset:3072 nt lds
    v_mfma_f32_16x16x32_bf16 v[192:195], a[144:147], a[16:19], v[192:195]
    s_add_u32 m0, s23, 0
    ds_read_b128 a[136:139], v224 offset:22528
    v_fma_f32 v212, v212, s21, v239
    v_mfma_f32_16x16x32_bf16 v[192:195], a[148:151], a[20:23], v[192:195]
    s_add_u32 s34, s41, 0
    v_exp_f32 v212, v212
    v_mfma_f32_16x16x32_bf16 v[196:199], a[148:151], a[52:55], v[196:199]
    v_cvt_pk_bf16_f32 v103, v210, v211
    v_fma_f32 v213, v213, s21, v239
    v_mfma_f32_16x16x32_bf16 v[196:199], a[144:147], a[48:51], v[196:199]
    v_exp_f32 v213, v213
    v_mfma_f32_16x16x32_bf16 v[200:203], a[144:147], a[80:83], v[200:203]
    ds_read_b128 a[140:143], v225 offset:22528
    v_fma_f32 v214, v214, s21, v239
    v_mfma_f32_16x16x32_bf16 v[200:203], a[148:151], a[84:87], v[200:203]
    v_exp_f32 v214, v214
    v_mfma_f32_16x16x32_bf16 v[204:207], a[148:151], a[116:119], v[204:207]
    v_cvt_pk_bf16_f32 v110, v212, v213
    v_fma_f32 v215, v215, s21, v239
    v_mfma_f32_16x16x32_bf16 v[204:207], a[144:147], a[112:115], v[204:207]
    v_exp_f32 v215, v215
    v_mfma_f32_16x16x32_bf16 v[204:207], a[152:155], a[120:123], v[204:207]
    ds_read_b128 a[144:147], v224 offset:26624
    v_fma_f32 v220, v220, s21, v241
    v_mfma_f32_16x16x32_bf16 v[204:207], a[156:159], a[124:127], v[204:207]
    buffer_load_dwordx4 v232, s[12:15], s34 offen nt lds
    v_exp_f32 v220, v220
    v_mfma_f32_16x16x32_bf16 v[200:203], a[156:159], a[92:95], v[200:203]
    v_cvt_pk_bf16_f32 v111, v214, v215
    v_fma_f32 v221, v221, s21, v241
    v_mfma_f32_16x16x32_bf16 v[200:203], a[152:155], a[88:91], v[200:203]
    v_exp_f32 v221, v221
    v_mfma_f32_16x16x32_bf16 v[196:199], a[152:155], a[56:59], v[196:199]
    ds_read_b128 a[148:151], v225 offset:26624
    v_fma_f32 v222, v222, s21, v241
    v_mfma_f32_16x16x32_bf16 v[196:199], a[156:159], a[60:63], v[196:199]
    v_exp_f32 v222, v222
    v_mfma_f32_16x16x32_bf16 v[192:195], a[156:159], a[28:31], v[192:195]
    v_cvt_pk_bf16_f32 v126, v220, v221
    v_fma_f32 v223, v223, s21, v241
    v_mfma_f32_16x16x32_bf16 v[192:195], a[152:155], a[24:27], v[192:195]
    s_waitcnt lgkmcnt(2)
    v_exp_f32 v223, v223
    v_mfma_f32_16x16x32_bf16 v[208:211], a[128:131], a[0:3], 0
    ds_read_b128 a[152:155], v224 offset:30720
    v_fma_f32 v200, v200, s21, v240
    v_mfma_f32_16x16x32_bf16 v[208:211], a[132:135], a[4:7], v[208:211]
    v_exp_f32 v200, v200
    v_mfma_f32_16x16x32_bf16 v[212:215], a[132:135], a[36:39], 0
    v_cvt_pk_bf16_f32 v127, v222, v223
    v_fma_f32 v201, v201, s21, v240
    v_mfma_f32_16x16x32_bf16 v[212:215], a[128:131], a[32:35], v[212:215]
    v_exp_f32 v201, v201
    v_mfma_f32_16x16x32_bf16 v[216:219], a[128:131], a[64:67], 0
    ds_read_b128 a[156:159], v225 offset:30720
    v_fma_f32 v202, v202, s21, v240
    v_mfma_f32_16x16x32_bf16 v[216:219], a[132:135], a[68:71], v[216:219]
    v_exp_f32 v202, v202
    v_mfma_f32_16x16x32_bf16 v[220:223], a[132:135], a[100:103], 0
    v_cvt_pk_bf16_f32 v144, v200, v201
    v_fma_f32 v203, v203, s21, v240
    v_mfma_f32_16x16x32_bf16 v[220:223], a[128:131], a[96:99], v[220:223]
    v_exp_f32 v203, v203
    v_mfma_f32_16x16x32_bf16 v[220:223], a[136:139], a[104:107], v[220:223]
    buffer_load_dwordx4 v233, s[12:15], s34 offen offset:1024 nt lds
    v_fma_f32 v192, v192, s21, v238
    v_mfma_f32_16x16x32_bf16 v[220:223], a[140:143], a[108:111], v[220:223]
    v_exp_f32 v192, v192
    v_mfma_f32_16x16x32_bf16 v[216:219], a[140:143], a[76:79], v[216:219]
    v_cvt_pk_bf16_f32 v145, v202, v203
    v_fma_f32 v193, v193, s21, v238
    v_mfma_f32_16x16x32_bf16 v[216:219], a[136:139], a[72:75], v[216:219]
    v_exp_f32 v193, v193
    v_mfma_f32_16x16x32_bf16 v[212:215], a[136:139], a[40:43], v[212:215]
    buffer_load_dwordx4 v234, s[12:15], s34 offen offset:2048 nt lds
    v_fma_f32 v194, v194, s21, v238
    v_mfma_f32_16x16x32_bf16 v[212:215], a[140:143], a[44:47], v[212:215]
L_hop10:
    s_cbranch_execz L_hopret2
    v_exp_f32 v194, v194
    v_mfma_f32_16x16x32_bf16 v[208:211], a[140:143], a[12:15], v[208:211]
    v_cvt_pk_bf16_f32 v128, v192, v193
    v_fma_f32 v195, v195, s21, v238
    v_mfma_f32_16x16x32_bf16 v[208:211], a[136:139], a[8:11], v[208:211]
    s_waitcnt vmcnt(23) lgkmcnt(0)
    v_exp_f32 v195, v195
    v_smfmac_f32_16x16x64_bf16 a[192:195], a[208:211], v[96:103], v254
    s_barrier
    buffer_load_dwordx4 v235, s[12:15], s34 offen offset:3072 nt lds
    v_mfma_f32_16x16x32_bf16 v[208:211], a[144:147], a[16:19], v[208:211]
    ds_read_b128 a[128:131], v224 offset:32768
    v_fma_f32 v196, v196, s21, v239
    v_mfma_f32_16x16x32_bf16 v[208:211], a[148:151], a[20:23], v[208:211]
    ds_read_b128 a[132:135], v225 offset:32768
    v_exp_f32 v196, v196
    v_mfma_f32_16x16x32_bf16 v[212:215], a[148:151], a[52:55], v[212:215]
    v_cvt_pk_bf16_f32 v129, v194, v195
    v_fma_f32 v197, v197, s21, v239
    v_mfma_f32_16x16x32_bf16 v[212:215], a[144:147], a[48:51], v[212:215]
    v_exp_f32 v197, v197
    v_mfma_f32_16x16x32_bf16 v[216:219], a[144:147], a[80:83], v[216:219]
    ds_read_b128 a[136:139], v224 offset:36864
    v_fma_f32 v198, v198, s21, v239
    v_mfma_f32_16x16x32_bf16 v[216:219], a[148:151], a[84:87], v[216:219]
    ds_read_b128 a[140:143], v225 offset:36864
    v_exp_f32 v198, v198
    v_mfma_f32_16x16x32_bf16 v[220:223], a[148:151], a[116:119], v[220:223]
    v_cvt_pk_bf16_f32 v136, v196, v197
    v_fma_f32 v199, v199, s21, v239
    v_mfma_f32_16x16x32_bf16 v[220:223], a[144:147], a[112:115], v[220:223]
    v_exp_f32 v199, v199
    v_mfma_f32_16x16x32_bf16 v[220:223], a[152:155], a[120:123], v[220:223]
    ds_read_b128 a[144:147], v224 offset:40960
    v_fma_f32 v204, v204, s21, v241
    v_mfma_f32_16x16x32_bf16 v[220:223], a[156:159], a[124:127], v[220:223]
    v_exp_f32 v204, v204
    v_mfma_f32_16x16x32_bf16 v[216:219], a[156:159], a[92:95], v[216:219]
    v_cvt_pk_bf16_f32 v137, v198, v199
    v_fma_f32 v205, v205, s21, v241
    v_mfma_f32_16x16x32_bf16 v[216:219], a[152:155], a[88:91], v[216:219]
    v_exp_f32 v205, v205
    v_mfma_f32_16x16x32_bf16 v[212:215], a[152:155], a[56:59], v[212:215]
    ds_read_b128 a[148:151], v225 offset:40960
    v_fma_f32 v206, v206, s21, v241
    v_mfma_f32_16x16x32_bf16 v[212:215], a[156:159], a[60:63], v[212:215]
    v_exp_f32 v206, v206
    v_mfma_f32_16x16x32_bf16 v[208:211], a[156:159], a[28:31], v[208:211]
    v_cvt_pk_bf16_f32 v152, v204, v205
    v_fma_f32 v207, v207, s21, v241
    v_mfma_f32_16x16x32_bf16 v[208:211], a[152:155], a[24:27], v[208:211]
    s_waitcnt lgkmcnt(2)
    v_exp_f32 v207, v207
    v_mfma_f32_16x16x32_bf16 v[192:195], a[128:131], a[0:3], 0
    ds_read_b128 a[152:155], v224 offset:45056
    v_fma_f32 v216, v216, s21, v240
    v_mfma_f32_16x16x32_bf16 v[192:195], a[132:135], a[4:7], v[192:195]
    v_exp_f32 v216, v216
    v_mfma_f32_16x16x32_bf16 v[196:199], a[132:135], a[36:39], 0
    v_cvt_pk_bf16_f32 v153, v206, v207
    v_fma_f32 v217, v217, s21, v240
    v_mfma_f32_16x16x32_bf16 v[196:199], a[128:131], a[32:35], v[196:199]
    buffer_load_dword v253, v251, s[12:15], s3 offen
    v_exp_f32 v217, v217
    v_mfma_f32_16x16x32_bf16 v[200:203], a[128:131], a[64:67], 0
    ds_read_b128 a[156:159], v225 offset:45056
    v_fma_f32 v218, v218, s21, v240
    v_mfma_f32_16x16x32_bf16 v[200:203], a[132:135], a[68:71], v[200:203]
    v_exp_f32 v218, v218
    v_mfma_f32_16x16x32_bf16 v[204:207], a[132:135], a[100:103], 0
    v_cvt_pk_bf16_f32 v146, v216, v217
    v_fma_f32 v219, v219, s21, v240
    v_mfma_f32_16x16x32_bf16 v[204:207], a[128:131], a[96:99], v[204:207]
    v_exp_f32 v219, v219
    v_mfma_f32_16x16x32_bf16 v[204:207], a[136:139], a[104:107], v[204:207]
    s_add_u32 m0, s23, 0x4000
    ds_read_b128 a[128:131], v224 offset:34816
    v_fma_f32 v208, v208, s21, v238
    v_mfma_f32_16x16x32_bf16 v[204:207], a[140:143], a[108:111], v[204:207]
    v_exp_f32 v208, v208
    v_mfma_f32_16x16x32_bf16 v[200:203], a[140:143], a[76:79], v[200:203]
    s_add_u32 s34, s41, 0x10000
    v_cvt_pk_bf16_f32 v147, v218, v219
    v_fma_f32 v209, v209, s21, v238
    v_mfma_f32_16x16x32_bf16 v[200:203], a[136:139], a[72:75], v[200:203]
    v_exp_f32 v209, v209
    v_mfma_f32_16x16x32_bf16 v[196:199], a[136:139], a[40:43], v[196:199]
    ds_read_b128 a[132:135], v225 offset:34816
    v_fma_f32 v210, v210, s21, v238
    v_mfma_f32_16x16x32_bf16 v[196:199], a[140:143], a[44:47], v[196:199]
    v_exp_f32 v210, v210
    v_mfma_f32_16x16x32_bf16 v[192:195], a[140:143], a[12:15], v[192:195]
    v_cvt_pk_bf16_f32 v130, v208, v209
    v_fma_f32 v211, v211, s21, v238
    v_mfma_f32_16x16x32_bf16 v[192:195], a[136:139], a[8:11], v[192:195]
    s_waitcnt lgkmcnt(2)
    v_exp_f32 v211, v211
    v_smfmac_f32_16x16x64_bf16 a[196:199], a[208:211], v[104:111], v254
    buffer_load_dwordx4 v232, s[12:15], s34 offen nt lds
    v_mfma_f32_16x16x32_bf16 v[192:195], a[144:147], a[16:19], v[192:195]
    ds_read_b128 a[136:139], v224 offset:38912
    v_fma_f32 v212, v212, s21, v239
    v_mfma_f32_16x16x32_bf16 v[192:195], a[148:151], a[20:23], v[192:195]
    v_exp_f32 v212, v212
    v_mfma_f32_16x16x32_bf16 v[196:199], a[148:151], a[52:55], v[196:199]
    v_cvt_pk_bf16_f32 v131, v210, v211
    v_fma_f32 v213, v213, s21, v239
    v_mfma_f32_16x16x32_bf16 v[196:199], a[144:147], a[48:51], v[196:199]
    v_exp_f32 v213, v213
    v_mfma_f32_16x16x32_bf16 v[200:203], a[144:147], a[80:83], v[200:203]
    ds_read_b128 a[140:143], v225 offset:38912
    v_fma_f32 v214, v214, s21, v239
    v_mfma_f32_16x16x32_bf16 v[200:203], a[148:151], a[84:87], v[200:203]
    v_exp_f32 v214, v214
    v_mfma_f32_16x16x32_bf16 v[204:207], a[148:151], a[116:119], v[204:207]
    v_cvt_pk_bf16_f32 v138, v212, v213
    v_fma_f32 v215, v215, s21, v239
    v_mfma_f32_16x16x32_bf16 v[204:207], a[144:147], a[112:115], v[204:207]
    v_exp_f32 v215, v215
    v_mfma_f32_16x16x32_bf16 v[204:207], a[152:155], a[120:123], v[204:207]
    ds_read_b128 a[144:147], v224 offset:43008
    v_fma_f32 v220, v220, s21, v241
    v_mfma_f32_16x16x32_bf16 v[204:207], a[156:159], a[124:127], v[204:207]
    buffer_load_dwordx4 v233, s[12:15], s34 offen offset:1024 nt lds
    v_exp_f32 v220, v220
    v_mfma_f32_16x16x32_bf16 v[200:203], a[156:159], a[92:95], v[200:203]
    v_cvt_pk_bf16_f32 v139, v214, v215
    v_fma_f32 v221, v221, s21, v241
    v_mfma_f32_16x16x32_bf16 v[200:203], a[152:155], a[88:91], v[200:203]
    v_exp_f32 v221, v221
    v_mfma_f32_16x16x32_bf16 v[196:199], a[152:155], a[56:59], v[196:199]
    ds_read_b128 a[148:151], v225 offset:43008
    v_fma_f32 v222, v222, s21, v241
    v_mfma_f32_16x16x32_bf16 v[196:199], a[156:159], a[60:63], v[196:199]
    v_exp_f32 v222, v222
    v_mfma_f32_16x16x32_bf16 v[192:195], a[156:159], a[28:31], v[192:195]
    v_cvt_pk_bf16_f32 v154, v220, v221
    v_fma_f32 v223, v223, s21, v241
    v_mfma_f32_16x16x32_bf16 v[192:195], a[152:155], a[24:27], v[192:195]
    s_waitcnt lgkmcnt(2)
    v_exp_f32 v223, v223
    v_mfma_f32_16x16x32_bf16 v[208:211], a[128:131], a[0:3], 0
    ds_read_b128 a[152:155], v224 offset:47104
    v_fma_f32 v200, v200, s21, v240
    v_mfma_f32_16x16x32_bf16 v[208:211], a[132:135], a[4:7], v[208:211]
    v_exp_f32 v200, v200
    v_mfma_f32_16x16x32_bf16 v[212:215], a[132:135], a[36:39], 0
    v_cvt_pk_bf16_f32 v155, v222, v223
    v_fma_f32 v201, v201, s21, v240
    v_mfma_f32_16x16x32_bf16 v[212:215], a[128:131], a[32:35], v[212:215]
    v_exp_f32 v201, v201
    v_mfma_f32_16x16x32_bf16 v[216:219], a[128:131], a[64:67], 0
    ds_read_b128 a[156:159], v225 offset:47104
    v_fma_f32 v202, v202, s21, v240
    v_mfma_f32_16x16x32_bf16 v[216:219], a[132:135], a[68:71], v[216:219]
    v_exp_f32 v202, v202
    v_mfma_f32_16x16x32_bf16 v[220:223], a[132:135], a[100:103], 0
    v_cvt_pk_bf16_f32 v148, v200, v201
    v_fma_f32 v203, v203, s21, v240
    v_mfma_f32_16x16x32_bf16 v[220:223], a[128:131], a[96:99], v[220:223]
    v_exp_f32 v203, v203
    v_mfma_f32_16x16x32_bf16 v[220:223], a[136:139], a[104:107], v[220:223]
    buffer_load_dwordx4 v234, s[12:15], s34 offen offset:2048 nt lds
    v_fma_f32 v192, v192, s21, v238
    v_mfma_f32_16x16x32_bf16 v[220:223], a[140:143], a[108:111], v[220:223]
    v_exp_f32 v192, v192
    v_mfma_f32_16x16x32_bf16 v[216:219], a[140:143], a[76:79], v[216:219]
    v_cvt_pk_bf16_f32 v149, v202, v203
    v_fma_f32 v193, v193, s21, v238
    v_mfma_f32_16x16x32_bf16 v[216:219], a[136:139], a[72:75], v[216:219]
    v_exp_f32 v193, v193
    v_mfma_f32_16x16x32_bf16 v[212:215], a[136:139], a[40:43], v[212:215]
    buffer_load_dwordx4 v235, s[12:15], s34 offen offset:3072 nt lds
    v_fma_f32 v194, v194, s21, v238
    v_mfma_f32_16x16x32_bf16 v[212:215], a[140:143], a[44:47], v[212:215]
    v_exp_f32 v194, v194
    v_mfma_f32_16x16x32_bf16 v[208:211], a[140:143], a[12:15], v[208:211]
    v_cvt_pk_bf16_f32 v132, v192, v193
    v_fma_f32 v195, v195, s21, v238
    v_mfma_f32_16x16x32_bf16 v[208:211], a[136:139], a[8:11], v[208:211]
    s_waitcnt vmcnt(21) lgkmcnt(0)
    v_exp_f32 v195, v195
    v_smfmac_f32_16x16x64_bf16 a[204:207], a[208:211], v[120:127], v254
    s_barrier
    v_mfma_f32_16x16x32_bf16 v[208:211], a[144:147], a[16:19], v[208:211]
    ds_read_b128 a[128:131], v224 offset:49152
    v_fma_f32 v196, v196, s21, v239
    v_mfma_f32_16x16x32_bf16 v[208:211], a[148:151], a[20:23], v[208:211]
    ds_read_b128 a[132:135], v225 offset:49152
    v_exp_f32 v196, v196
    v_mfma_f32_16x16x32_bf16 v[212:215], a[148:151], a[52:55], v[212:215]
    v_cvt_pk_bf16_f32 v133, v194, v195
    v_fma_f32 v197, v197, s21, v239
    v_mfma_f32_16x16x32_bf16 v[212:215], a[144:147], a[48:51], v[212:215]
    v_exp_f32 v197, v197
    v_mfma_f32_16x16x32_bf16 v[216:219], a[144:147], a[80:83], v[216:219]
    ds_read_b128 a[136:139], v224 offset:53248
    v_fma_f32 v198, v198, s21, v239
    v_mfma_f32_16x16x32_bf16 v[216:219], a[148:151], a[84:87], v[216:219]
    ds_read_b128 a[140:143], v225 offset:53248
    v_exp_f32 v198, v198
    v_mfma_f32_16x16x32_bf16 v[220:223], a[148:151], a[116:119], v[220:223]
    v_cvt_pk_bf16_f32 v140, v196, v197
    v_fma_f32 v199, v199, s21, v239
    v_mfma_f32_16x16x32_bf16 v[220:223], a[144:147], a[112:115], v[220:223]
    v_exp_f32 v199, v199
    v_mfma_f32_16x16x32_bf16 v[220:223], a[152:155], a[120:123], v[220:223]
    ds_read_b128 a[144:147], v224 offset:57344
    v_fma_f32 v204, v204, s21, v241
    v_mfma_f32_16x16x32_bf16 v[220:223], a[156:159], a[124:127], v[220:223]
    v_exp_f32 v204, v204
    v_mfma_f32_16x16x32_bf16 v[216:219], a[156:159], a[92:95], v[216:219]
    v_cvt_pk_bf16_f32 v141, v198, v199
    v_fma_f32 v205, v205, s21, v241
    v_mfma_f32_16x16x32_bf16 v[216:219], a[152:155], a[88:91], v[216:219]
    buffer_load_dword v253, v251, s[12:15], s38 offen
    v_exp_f32 v205, v205
    v_mfma_f32_16x16x32_bf16 v[212:215], a[152:155], a[56:59], v[212:215]
    ds_read_b128 a[148:151], v225 offset:57344
    v_fma_f32 v206, v206, s21, v241
    v_mfma_f32_16x16x32_bf16 v[212:215], a[156:159], a[60:63], v[212:215]
    v_exp_f32 v206, v206
    v_mfma_f32_16x16x32_bf16 v[208:211], a[156:159], a[28:31], v[208:211]
    v_cvt_pk_bf16_f32 v156, v204, v205
    v_fma_f32 v207, v207, s21, v241
    v_mfma_f32_16x16x32_bf16 v[208:211], a[152:155], a[24:27], v[208:211]
    s_waitcnt lgkmcnt(2)
    v_exp_f32 v207, v207
    v_mfma_f32_16x16x32_bf16 v[192:195], a[128:131], a[0:3], 0
    s_add_u32 m0, s23, 0x8000
    ds_read_b128 a[152:155], v224 offset:61440
    v_fma_f32 v216, v216, s21, v240
    v_mfma_f32_16x16x32_bf16 v[192:195], a[132:135], a[4:7], v[192:195]
    v_exp_f32 v216, v216
    v_mfma_f32_16x16x32_bf16 v[196:199], a[132:135], a[36:39], 0
    s_add_u32 s34, s41, 0x20000
    v_cvt_pk_bf16_f32 v157, v206, v207
    v_fma_f32 v217, v217, s21, v240
    v_mfma_f32_16x16x32_bf16 v[196:199], a[128:131], a[32:35], v[196:199]
    v_exp_f32 v217, v217
    v_mfma_f32_16x16x32_bf16 v[200:203], a[128:131], a[64:67], 0
    ds_read_b128 a[156:159], v225 offset:61440
    v_fma_f32 v218, v218, s21, v240
    v_mfma_f32_16x16x32_bf16 v[200:203], a[132:135], a[68:71], v[200:203]
    v_exp_f32 v218, v218
    v_mfma_f32_16x16x32_bf16 v[204:207], a[132:135], a[100:103], 0
    v_cvt_pk_bf16_f32 v150, v216, v217
    v_fma_f32 v219, v219, s21, v240
    v_mfma_f32_16x16x32_bf16 v[204:207], a[128:131], a[96:99], v[204:207]
    v_exp_f32 v219, v219
    v_mfma_f32_16x16x32_bf16 v[204:207], a[136:139], a[104:107], v[204:207]
    ds_read_b128 a[128:131], v224 offset:51200
    v_fma_f32 v208, v208, s21, v238
    v_mfma_f32_16x16x32_bf16 v[204:207], a[140:143], a[108:111], v[204:207]
    buffer_load_dwordx4 v232, s[12:15], s34 offen nt lds
    v_exp_f32 v208, v208
    v_mfma_f32_16x16x32_bf16 v[200:203], a[140:143], a[76:79], v[200:203]
    v_cvt_pk_bf16_f32 v151, v218, v219
    v_fma_f32 v209, v209, s21, v238
    v_mfma_f32_16x16x32_bf16 v[200:203], a[136:139], a[72:75], v[200:203]
    v_exp_f32 v209, v209
    v_mfma_f32_16x16x32_bf16 v[196:199], a[136:139], a[40:43], v[196:199]
    ds_read_b128 a[132:135], v225 offset:51200
    v_fma_f32 v210, v210, s21, v238
    v_mfma_f32_16x16x32_bf16 v[196:199], a[140:143], a[44:47], v[196:199]
    v_exp_f32 v210, v210
    v_mfma_f32_16x16x32_bf16 v[192:195], a[140:143], a[12:15], v[192:195]
    v_cvt_pk_bf16_f32 v134, v208, v209
    v_fma_f32 v211, v211, s21, v238
    v_mfma_f32_16x16x32_bf16 v[192:195], a[136:139], a[8:11], v[192:195]
    s_waitcnt lgkmcnt(2)
    v_exp_f32 v211, v211
    v_smfmac_f32_16x16x64_bf16 a[200:203], a[208:211], v[144:151], v254
    buffer_load_dwordx4 v233, s[12:15], s34 offen offset:1024 nt lds
    v_mfma_f32_16x16x32_bf16 v[192:195], a[144:147], a[16:19], v[192:195]
    ds_read_b128 a[136:139], v224 offset:55296
    v_fma_f32 v212, v212, s21, v239
    v_mfma_f32_16x16x32_bf16 v[192:195], a[148:151], a[20:23], v[192:195]
    v_exp_f32 v212, v212
    v_mfma_f32_16x16x32_bf16 v[196:199], a[148:151], a[52:55], v[196:199]
    v_cvt_pk_bf16_f32 v135, v210, v211
    v_fma_f32 v213, v213, s21, v239
    v_mfma_f32_16x16x32_bf16 v[196:199], a[144:147], a[48:51], v[196:199]
    v_exp_f32 v213, v213
    v_mfma_f32_16x16x32_bf16 v[200:203], a[144:147], a[80:83], v[200:203]
    ds_read_b128 a[140:143], v225 offset:55296
    v_fma_f32 v214, v214, s21, v239
    v_mfma_f32_16x16x32_bf16 v[200:203], a[148:151], a[84:87], v[200:203]
    v_exp_f32 v214, v214
    v_mfma_f32_16x16x32_bf16 v[204:207], a[148:151], a[116:119], v[204:207]
    v_cvt_pk_bf16_f32 v142, v212, v213
    v_fma_f32 v215, v215, s21, v239
    v_mfma_f32_16x16x32_bf16 v[204:207], a[144:147], a[112:115], v[204:207]
    v_exp_f32 v215, v215
    v_mfma_f32_16x16x32_bf16 v[204:207], a[152:155], a[120:123], v[204:207]
    ds_read_b128 a[144:147], v224 offset:59392
    v_fma_f32 v220, v220, s21, v241
    v_mfma_f32_16x16x32_bf16 v[204:207], a[156:159], a[124:127], v[204:207]
    v_exp_f32 v220, v220
    v_mfma_f32_16x16x32_bf16 v[200:203], a[156:159], a[92:95], v[200:203]
    v_cvt_pk_bf16_f32 v143, v214, v215
    v_fma_f32 v221, v221, s21, v241
    v_mfma_f32_16x16x32_bf16 v[200:203], a[152:155], a[88:91], v[200:203]
    v_exp_f32 v221, v221
    v_mfma_f32_16x16x32_bf16 v[196:199], a[152:155], a[56:59], v[196:199]
    ds_read_b128 a[148:151], v225 offset:59392
    v_fma_f32 v222, v222, s21, v241
    v_mfma_f32_16x16x32_bf16 v[196:199], a[156:159], a[60:63], v[196:199]
    v_exp_f32 v222, v222
    v_mfma_f32_16x16x32_bf16 v[192:195], a[156:159], a[28:31], v[192:195]
    v_cvt_pk_bf16_f32 v158, v220, v221
    v_fma_f32 v223, v223, s21, v241
    v_mfma_f32_16x16x32_bf16 v[192:195], a[152:155], a[24:27], v[192:195]
    s_waitcnt lgkmcnt(2)
    buffer_load_dwordx4 v234, s[12:15], s34 offen offset:2048 nt lds
    v_exp_f32 v223, v223
    v_mfma_f32_16x16x32_bf16 v[208:211], a[128:131], a[0:3], 0
    ds_read_b128 a[152:155], v224 offset:63488
    v_fma_f32 v200, v200, s21, v240
    v_mfma_f32_16x16x32_bf16 v[208:211], a[132:135], a[4:7], v[208:211]
    v_exp_f32 v200, v200
    v_mfma_f32_16x16x32_bf16 v[212:215], a[132:135], a[36:39], 0
    v_cvt_pk_bf16_f32 v159, v222, v223
    v_fma_f32 v201, v201, s21, v240
    v_mfma_f32_16x16x32_bf16 v[212:215], a[128:131], a[32:35], v[212:215]
    v_exp_f32 v201, v201
    v_mfma_f32_16x16x32_bf16 v[216:219], a[128:131], a[64:67], 0
    ds_read_b128 a[156:159], v225 offset:63488
    v_fma_f32 v202, v202, s21, v240
    v_mfma_f32_16x16x32_bf16 v[216:219], a[132:135], a[68:71], v[216:219]
    v_exp_f32 v202, v202
    v_mfma_f32_16x16x32_bf16 v[220:223], a[132:135], a[100:103], 0
    v_cvt_pk_bf16_f32 v176, v200, v201
    v_fma_f32 v203, v203, s21, v240
    v_mfma_f32_16x16x32_bf16 v[220:223], a[128:131], a[96:99], v[220:223]
    v_exp_f32 v203, v203
    v_mfma_f32_16x16x32_bf16 v[220:223], a[136:139], a[104:107], v[220:223]
    v_fma_f32 v192, v192, s21, v238
    v_mfma_f32_16x16x32_bf16 v[220:223], a[140:143], a[108:111], v[220:223]
    v_exp_f32 v192, v192
    v_mfma_f32_16x16x32_bf16 v[216:219], a[140:143], a[76:79], v[216:219]
    v_cvt_pk_bf16_f32 v177, v202, v203
    v_fma_f32 v193, v193, s21, v238
    v_mfma_f32_16x16x32_bf16 v[216:219], a[136:139], a[72:75], v[216:219]
    v_exp_f32 v193, v193
    v_mfma_f32_16x16x32_bf16 v[212:215], a[136:139], a[40:43], v[212:215]
    buffer_load_dwordx4 v235, s[12:15], s34 offen offset:3072 nt lds
    v_fma_f32 v194, v194, s21, v238
    v_mfma_f32_16x16x32_bf16 v[212:215], a[140:143], a[44:47], v[212:215]
    v_exp_f32 v194, v194
    v_mfma_f32_16x16x32_bf16 v[208:211], a[140:143], a[12:15], v[208:211]
    v_cvt_pk_bf16_f32 v160, v192, v193
    v_fma_f32 v195, v195, s21, v238
    v_mfma_f32_16x16x32_bf16 v[208:211], a[136:139], a[8:11], v[208:211]
    s_waitcnt vmcnt(18) lgkmcnt(0)
    v_exp_f32 v195, v195
    v_smfmac_f32_16x16x64_bf16 a[192:195], a[208:211], v[128:135], v254
    s_barrier
    v_mfma_f32_16x16x32_bf16 v[208:211], a[144:147], a[16:19], v[208:211]
    ds_read_b128 a[128:131], v226 offset:0
    v_fma_f32 v196, v196, s21, v239
    v_mfma_f32_16x16x32_bf16 v[208:211], a[148:151], a[20:23], v[208:211]
    ds_read_b128 a[132:135], v227 offset:0
    v_exp_f32 v196, v196
    v_mfma_f32_16x16x32_bf16 v[212:215], a[148:151], a[52:55], v[212:215]
    v_cvt_pk_bf16_f32 v161, v194, v195
    v_fma_f32 v197, v197, s21, v239
    v_mfma_f32_16x16x32_bf16 v[212:215], a[144:147], a[48:51], v[212:215]
    v_exp_f32 v197, v197
    v_mfma_f32_16x16x32_bf16 v[216:219], a[144:147], a[80:83], v[216:219]
    ds_read_b128 a[136:139], v226 offset:4096
    v_fma_f32 v198, v198, s21, v239
    v_mfma_f32_16x16x32_bf16 v[216:219], a[148:151], a[84:87], v[216:219]
    ds_read_b128 a[140:143], v227 offset:4096
    v_exp_f32 v198, v198
    v_mfma_f32_16x16x32_bf16 v[220:223], a[148:151], a[116:119], v[220:223]
    v_cvt_pk_bf16_f32 v168, v196, v197
    v_fma_f32 v199, v199, s21, v239
    v_mfma_f32_16x16x32_bf16 v[220:223], a[144:147], a[112:115], v[220:223]
    v_exp_f32 v199, v199
    v_mfma_f32_16x16x32_bf16 v[220:223], a[152:155], a[120:123], v[220:223]
    ds_read_b128 a[144:147], v226 offset:8192
    v_fma_f32 v204, v204, s21, v241
    v_mfma_f32_16x16x32_bf16 v[220:223], a[156:159], a[124:127], v[220:223]
    v_exp_f32 v204, v204
    v_mfma_f32_16x16x32_bf16 v[216:219], a[156:159], a[92:95], v[216:219]
    v_cvt_pk_bf16_f32 v169, v198, v199
    v_fma_f32 v205, v205, s21, v241
    v_mfma_f32_16x16x32_bf16 v[216:219], a[152:155], a[88:91], v[216:219]
    buffer_load_dword v253, v252, s[12:15], s36 offen
    v_exp_f32 v205, v205
    v_mfma_f32_16x16x32_bf16 v[212:215], a[152:155], a[56:59], v[212:215]
    ds_read_b128 a[148:151], v227 offset:8192
    v_fma_f32 v206, v206, s21, v241
    v_mfma_f32_16x16x32_bf16 v[212:215], a[156:159], a[60:63], v[212:215]
    v_exp_f32 v206, v206
    v_mfma_f32_16x16x32_bf16 v[208:211], a[156:159], a[28:31], v[208:211]
    v_cvt_pk_bf16_f32 v184, v204, v205
    v_fma_f32 v207, v207, s21, v241
    v_mfma_f32_16x16x32_bf16 v[208:211], a[152:155], a[24:27], v[208:211]
    s_waitcnt lgkmcnt(2)
    v_exp_f32 v207, v207
    v_mfma_f32_16x16x32_bf16 v[192:195], a[128:131], a[0:3], 0
    ds_read_b128 a[152:155], v226 offset:12288
    v_fma_f32 v216, v216, s21, v240
    v_mfma_f32_16x16x32_bf16 v[192:195], a[132:135], a[4:7], v[192:195]
    v_exp_f32 v216, v216
    v_mfma_f32_16x16x32_bf16 v[196:199], a[132:135], a[36:39], 0
    v_cvt_pk_bf16_f32 v185, v206, v207
    v_fma_f32 v217, v217, s21, v240
    v_mfma_f32_16x16x32_bf16 v[196:199], a[128:131], a[32:35], v[196:199]
    v_exp_f32 v217, v217
    v_mfma_f32_16x16x32_bf16 v[200:203], a[128:131], a[64:67], 0
    ds_read_b128 a[156:159], v227 offset:12288
    v_fma_f32 v218, v218, s21, v240
    v_mfma_f32_16x16x32_bf16 v[200:203], a[132:135], a[68:71], v[200:203]
    v_exp_f32 v218, v218
    v_mfma_f32_16x16x32_bf16 v[204:207], a[132:135], a[100:103], 0
    v_cvt_pk_bf16_f32 v178, v216, v217
    v_fma_f32 v219, v219, s21, v240
    v_mfma_f32_16x16x32_bf16 v[204:207], a[128:131], a[96:99], v[204:207]
    v_exp_f32 v219, v219
    v_mfma_f32_16x16x32_bf16 v[204:207], a[136:139], a[104:107], v[204:207]
    s_add_u32 m0, s23, 0xc000
    ds_read_b128 a[128:131], v226 offset:2048
    v_fma_f32 v208, v208, s21, v238
    v_mfma_f32_16x16x32_bf16 v[204:207], a[140:143], a[108:111], v[204:207]
    s_add_u32 s34, s42, 0
    v_exp_f32 v208, v208
    v_mfma_f32_16x16x32_bf16 v[200:203], a[140:143], a[76:79], v[200:203]
    v_cvt_pk_bf16_f32 v179, v218, v219
    v_fma_f32 v209, v209, s21, v238
    v_mfma_f32_16x16x32_bf16 v[200:203], a[136:139], a[72:75], v[200:203]
    v_exp_f32 v209, v209
    v_mfma_f32_16x16x32_bf16 v[196:199], a[136:139], a[40:43], v[196:199]
    ds_read_b128 a[132:135], v227 offset:2048
    v_fma_f32 v210, v210, s21, v238
    v_mfma_f32_16x16x32_bf16 v[196:199], a[140:143], a[44:47], v[196:199]
    v_exp_f32 v210, v210
    v_mfma_f32_16x16x32_bf16 v[192:195], a[140:143], a[12:15], v[192:195]
    v_cvt_pk_bf16_f32 v162, v208, v209
    v_fma_f32 v211, v211, s21, v238
    v_mfma_f32_16x16x32_bf16 v[192:195], a[136:139], a[8:11], v[192:195]
    s_waitcnt lgkmcnt(2)
    v_exp_f32 v211, v211
    v_smfmac_f32_16x16x64_bf16 a[196:199], a[208:211], v[136:143], v254
    buffer_load_dwordx4 v232, s[12:15], s34 offen nt lds
    v_mfma_f32_16x16x32_bf16 v[192:195], a[144:147], a[16:19], v[192:195]
    ds_read_b128 a[136:139], v226 offset:6144
    v_fma_f32 v212, v212, s21, v239
    v_mfma_f32_16x16x32_bf16 v[192:195], a[148:151], a[20:23], v[192:195]
    v_exp_f32 v212, v212
    v_mfma_f32_16x16x32_bf16 v[196:199], a[148:151], a[52:55], v[196:199]
    v_cvt_pk_bf16_f32 v163, v210, v211
    v_fma_f32 v213, v213, s21, v239
    v_mfma_f32_16x16x32_bf16 v[196:199], a[144:147], a[48:51], v[196:199]
    v_exp_f32 v213, v213
    v_mfma_f32_16x16x32_bf16 v[200:203], a[144:147], a[80:83], v[200:203]
    ds_read_b128 a[140:143], v227 offset:6144
    v_fma_f32 v214, v214, s21, v239
    v_mfma_f32_16x16x32_bf16 v[200:203], a[148:151], a[84:87], v[200:203]
    v_exp_f32 v214, v214
    v_mfma_f32_16x16x32_bf16 v[204:207], a[148:151], a[116:119], v[204:207]
    v_cvt_pk_bf16_f32 v170, v212, v213
    v_fma_f32 v215, v215, s21, v239
    v_mfma_f32_16x16x32_bf16 v[204:207], a[144:147], a[112:115], v[204:207]
    v_exp_f32 v215, v215
    v_mfma_f32_16x16x32_bf16 v[204:207], a[152:155], a[120:123], v[204:207]
    ds_read_b128 a[144:147], v226 offset:10240
    v_fma_f32 v220, v220, s21, v241
    v_mfma_f32_16x16x32_bf16 v[204:207], a[156:159], a[124:127], v[204:207]
    buffer_load_dwordx4 v233, s[12:15], s34 offen offset:1024 nt lds
    v_exp_f32 v220, v220
    v_mfma_f32_16x16x32_bf16 v[200:203], a[156:159], a[92:95], v[200:203]
    v_cvt_pk_bf16_f32 v171, v214, v215
    v_fma_f32 v221, v221, s21, v241
    v_mfma_f32_16x16x32_bf16 v[200:203], a[152:155], a[88:91], v[200:203]
    v_exp_f32 v221, v221
    v_mfma_f32_16x16x32_bf16 v[196:199], a[152:155], a[56:59], v[196:199]
    ds_read_b128 a[148:151], v227 offset:10240
    v_fma_f32 v222, v222, s21, v241
    v_mfma_f32_16x16x32_bf16 v[196:199], a[156:159], a[60:63], v[196:199]
    v_exp_f32 v222, v222
    v_mfma_f32_16x16x32_bf16 v[192:195], a[156:159], a[28:31], v[192:195]
    v_cvt_pk_bf16_f32 v186, v220, v221
    v_fma_f32 v223, v223, s21, v241
    v_mfma_f32_16x16x32_bf16 v[192:195], a[152:155], a[24:27], v[192:195]
    s_waitcnt lgkmcnt(2)
    v_exp_f32 v223, v223
    v_mfma_f32_16x16x32_bf16 v[208:211], a[128:131], a[0:3], 0
    ds_read_b128 a[152:155], v226 offset:14336
    v_fma_f32 v200, v200, s21, v240
    v_mfma_f32_16x16x32_bf16 v[208:211], a[132:135], a[4:7], v[208:211]
    buffer_load_dwordx4 v234, s[12:15], s34 offen offset:2048 nt lds
    v_exp_f32 v200, v200
    v_mfma_f32_16x16x32_bf16 v[212:215], a[132:135], a[36:39], 0
    v_cvt_pk_bf16_f32 v187, v222, v223
    v_fma_f32 v201, v201, s21, v240
    v_mfma_f32_16x16x32_bf16 v[212:215], a[128:131], a[32:35], v[212:215]
    v_exp_f32 v201, v201
    v_mfma_f32_16x16x32_bf16 v[216:219], a[128:131], a[64:67], 0
    ds_read_b128 a[156:159], v227 offset:14336
    v_fma_f32 v202, v202, s21, v240
    v_mfma_f32_16x16x32_bf16 v[216:219], a[132:135], a[68:71], v[216:219]
    v_exp_f32 v202, v202
    v_mfma_f32_16x16x32_bf16 v[220:223], a[132:135], a[100:103], 0
    v_cvt_pk_bf16_f32 v180, v200, v201
    v_fma_f32 v203, v203, s21, v240
    v_mfma_f32_16x16x32_bf16 v[220:223], a[128:131], a[96:99], v[220:223]
    v_exp_f32 v203, v203
    v_mfma_f32_16x16x32_bf16 v[220:223], a[136:139], a[104:107], v[220:223]
    v_fma_f32 v192, v192, s21, v238
    v_xor_b32 v230, 0x60, v230
    v_mfma_f32_16x16x32_bf16 v[220:223], a[140:143], a[108:111], v[220:223]
    v_exp_f32 v192, v192
    v_mfma_f32_16x16x32_bf16 v[216:219], a[140:143], a[76:79], v[216:219]
    v_cvt_pk_bf16_f32 v181, v202, v203
    v_fma_f32 v193, v193, s21, v238
    v_mfma_f32_16x16x32_bf16 v[216:219], a[136:139], a[72:75], v[216:219]
    v_exp_f32 v193, v193
    v_mfma_f32_16x16x32_bf16 v[212:215], a[136:139], a[40:43], v[212:215]
    v_fma_f32 v194, v194, s21, v238
    v_xor_b32 v231, 0x60, v231
    v_mfma_f32_16x16x32_bf16 v[212:215], a[140:143], a[44:47], v[212:215]
    v_exp_f32 v194, v194
    v_mfma_f32_16x16x32_bf16 v[208:211], a[140:143], a[12:15], v[208:211]
    v_cvt_pk_bf16_f32 v164, v192, v193
    v_fma_f32 v195, v195, s21, v238
    v_mfma_f32_16x16x32_bf16 v[208:211], a[136:139], a[8:11], v[208:211]
    s_waitcnt vmcnt(18) lgkmcnt(0)
    v_exp_f32 v195, v195
    v_smfmac_f32_16x16x64_bf16 a[204:207], a[208:211], v[152:159], v254
    s_barrier
    buffer_load_dwordx4 v235, s[12:15], s34 offen offset:3072 nt lds
    v_mfma_f32_16x16x32_bf16 v[208:211], a[144:147], a[16:19], v[208:211]
    ds_read_b64_tr_b16 a[128:129], v231 offset:16384
    v_fma_f32 v196, v196, s21, v239
    v_mfma_f32_16x16x32_bf16 v[208:211], a[148:151], a[20:23], v[208:211]
    ds_read_b64_tr_b16 a[130:131], v231 offset:18432
    v_exp_f32 v196, v196
    v_mfma_f32_16x16x32_bf16 v[212:215], a[148:151], a[52:55], v[212:215]
    ds_read_b64_tr_b16 a[132:133], v231 offset:20480
    v_cvt_pk_bf16_f32 v165, v194, v195
    v_fma_f32 v197, v197, s21, v239
    v_mfma_f32_16x16x32_bf16 v[212:215], a[144:147], a[48:51], v[212:215]
    ds_read_b64_tr_b16 a[134:135], v231 offset:22528
    v_exp_f32 v197, v197
    v_mfma_f32_16x16x32_bf16 v[216:219], a[144:147], a[80:83], v[216:219]
    ds_read_b64_tr_b16 a[136:137], v231 offset:24576
    v_fma_f32 v198, v198, s21, v239
    v_mfma_f32_16x16x32_bf16 v[216:219], a[148:151], a[84:87], v[216:219]
    ds_read_b64_tr_b16 a[138:139], v231 offset:26624
    v_exp_f32 v198, v198
    v_mfma_f32_16x16x32_bf16 v[220:223], a[148:151], a[116:119], v[220:223]
    ds_read_b64_tr_b16 a[140:141], v231 offset:28672
    v_cvt_pk_bf16_f32 v172, v196, v197
    v_fma_f32 v199, v199, s21, v239
    v_mfma_f32_16x16x32_bf16 v[220:223], a[144:147], a[112:115], v[220:223]
    ds_read_b64_tr_b16 a[142:143], v231 offset:30720
    v_exp_f32 v199, v199
    v_mfma_f32_16x16x32_bf16 v[220:223], a[152:155], a[120:123], v[220:223]
    ds_read_b64_tr_b16 a[144:145], v231 offset:32768
    v_fma_f32 v204, v204, s21, v241
    v_mfma_f32_16x16x32_bf16 v[220:223], a[156:159], a[124:127], v[220:223]
    ds_read_b64_tr_b16 a[146:147], v231 offset:34816
    v_exp_f32 v204, v204
    v_mfma_f32_16x16x32_bf16 v[216:219], a[156:159], a[92:95], v[216:219]
    v_cvt_pk_bf16_f32 v173, v198, v199
    v_fma_f32 v205, v205, s21, v241
    v_mfma_f32_16x16x32_bf16 v[216:219], a[152:155], a[88:91], v[216:219]
L_hop11:
    s_cbranch_execz L_hopret2
    v_exp_f32 v205, v205
    v_mfma_f32_16x16x32_bf16 v[212:215], a[152:155], a[56:59], v[212:215]
    ds_read_b64_tr_b16 a[148:149], v231 offset:36864
    v_fma_f32 v206, v206, s21, v241
    v_mfma_f32_16x16x32_bf16 v[212:215], a[156:159], a[60:63], v[212:215]
    ds_read_b64_tr_b16 a[150:151], v231 offset:38912
    v_exp_f32 v206, v206
    v_mfma_f32_16x16x32_bf16 v[208:211], a[156:159], a[28:31], v[208:211]
    v_cvt_pk_bf16_f32 v188, v204, v205
    v_fma_f32 v207, v207, s21, v241
    v_mfma_f32_16x16x32_bf16 v[208:211], a[152:155], a[24:27], v[208:211]
    s_waitcnt lgkmcnt(4)
    v_exp_f32 v207, v207
    v_mfma_f32_16x16x32_bf16 v[192:195], a[128:131], v[0:3], 0
    ds_read_b64_tr_b16 a[152:153], v231 offset:40960
    v_fma_f32 v216, v216, s21, v240
    v_mfma_f32_16x16x32_bf16 v[192:195], a[132:135], v[4:7], v[192:195]
    v_fma_f32 v217, v217, s21, v240
    v_exp_f32 v216, v216
    v_mfma_f32_16x16x32_bf16 v[196:199], a[132:135], v[12:15], 0
    ds_read_b64_tr_b16 a[154:155], v231 offset:43008
    v_cvt_pk_bf16_f32 v189, v206, v207
    v_mfma_f32_16x16x32_bf16 v[196:199], a[128:131], v[8:11], v[196:199]
    v_exp_f32 v217, v217
    v_mfma_f32_16x16x32_bf16 v[200:203], a[128:131], v[16:19], 0
    ds_read_b64_tr_b16 a[156:157], v231 offset:45056
    v_fma_f32 v218, v218, s21, v240
    v_mfma_f32_16x16x32_bf16 v[200:203], a[132:135], v[20:23], v[200:203]
    v_mfma_f32_16x16x32_bf16 v[204:207], a[132:135], v[28:31], 0
    ds_read_b64_tr_b16 a[158:159], v231 offset:47104
    v_fma_f32 v219, v219, s21, v240
    v_mfma_f32_16x16x32_bf16 v[204:207], a[128:131], v[24:27], v[204:207]
    v_exp_f32 v218, v218
    v_mfma_f32_16x16x32_bf16 v[204:207], a[136:139], v[56:59], v[204:207]
    ds_read_b64_tr_b16 a[128:129], v231 offset:49152
    v_mfma_f32_16x16x32_bf16 v[204:207], a[140:143], v[60:63], v[204:207]
    v_exp_f32 v219, v219
    v_cvt_pk_bf16_f32 v182, v216, v217
    v_mfma_f32_16x16x32_bf16 v[200:203], a[140:143], v[52:55], v[200:203]
    ds_read_b64_tr_b16 a[130:131], v231 offset:51200
    v_cvt_pk_bf16_f32 v183, v218, v219
    v_mfma_f32_16x16x32_bf16 v[200:203], a[136:139], v[48:51], v[200:203]
    v_fma_f32 v208, v208, s21, v238
    v_mfma_f32_16x16x32_bf16 v[196:199], a[136:139], v[40:43], v[196:199]
    ds_read_b64_tr_b16 a[132:133], v231 offset:53248
    v_fma_f32 v209, v209, s21, v238
    v_mfma_f32_16x16x32_bf16 v[196:199], a[140:143], v[44:47], v[196:199]
    v_exp_f32 v208, v208
    v_mfma_f32_16x16x32_bf16 v[192:195], a[140:143], v[36:39], v[192:195]
    ds_read_b64_tr_b16 a[134:135], v231 offset:55296
    v_mfma_f32_16x16x32_bf16 v[192:195], a[136:139], v[32:35], v[192:195]
    s_waitcnt lgkmcnt(4)
    v_exp_f32 v209, v209
    v_smfmac_f32_16x16x64_bf16 a[200:203], a[208:211], v[176:183], v254
    v_fma_f32 v210, v210, s21, v238
    v_mfma_f32_16x16x32_bf16 v[192:195], a[144:147], v[64:67], v[192:195]
    ds_read_b64_tr_b16 a[136:137], v231 offset:57344
    v_fma_f32 v211, v211, s21, v238
    v_mfma_f32_16x16x32_bf16 v[192:195], a[148:151], v[68:71], v[192:195]
    v_exp_f32 v210, v210
    v_mfma_f32_16x16x32_bf16 v[196:199], a[148:151], v[76:79], v[196:199]
    ds_read_b64_tr_b16 a[138:139], v231 offset:59392
    v_exp_f32 v211, v211
    v_mfma_f32_16x16x32_bf16 v[196:199], a[144:147], v[72:75], v[196:199]
    v_cvt_pk_bf16_f32 v166, v208, v209
    v_cvt_pk_bf16_f32 v167, v210, v211
    v_mfma_f32_16x16x32_bf16 v[200:203], a[144:147], v[80:83], v[200:203]
    ds_read_b64_tr_b16 a[140:141], v231 offset:61440
    v_fma_f32 v212, v212, s21, v239
    v_mfma_f32_16x16x32_bf16 v[200:203], a[148:151], v[84:87], v[200:203]
    v_fma_f32 v213, v213, s21, v239
    v_exp_f32 v212, v212
    v_mfma_f32_16x16x32_bf16 v[204:207], a[148:151], v[92:95], v[204:207]
    ds_read_b64_tr_b16 a[142:143], v231 offset:63488
    v_xor_b32 v230, 32, v230
    v_mfma_f32_16x16x32_bf16 v[204:207], a[144:147], v[88:91], v[204:207]
    v_exp_f32 v213, v213
    v_smfmac_f32_16x16x64_bf16 a[192:195], a[208:211], v[160:167], v254
    v_xor_b32 v231, 32, v231
    v_fma_f32 v214, v214, s21, v239
    v_mfma_f32_16x16x32_bf16 v[204:207], a[152:155], v[120:123], v[204:207]
    ds_read_b64_tr_b16 a[144:145], v231 offset:16384
    v_fma_f32 v215, v215, s21, v239
    v_mfma_f32_16x16x32_bf16 v[204:207], a[156:159], v[124:127], v[204:207]
    v_exp_f32 v214, v214
    v_mfma_f32_16x16x32_bf16 v[200:203], a[156:159], v[116:119], v[200:203]
    ds_read_b64_tr_b16 a[146:147], v231 offset:18432
    v_mfma_f32_16x16x32_bf16 v[200:203], a[152:155], v[112:115], v[200:203]
    v_exp_f32 v215, v215
    v_cvt_pk_bf16_f32 v174, v212, v213
    v_mfma_f32_16x16x32_bf16 v[196:199], a[152:155], v[104:107], v[196:199]
    ds_read_b64_tr_b16 a[148:149], v231 offset:20480
    v_cvt_pk_bf16_f32 v175, v214, v215
    v_mfma_f32_16x16x32_bf16 v[196:199], a[156:159], v[108:111], v[196:199]
    v_fma_f32 v220, v220, s21, v241
    v_fma_f32 v221, v221, s21, v241
    v_mfma_f32_16x16x32_bf16 v[192:195], a[156:159], v[100:103], v[192:195]
    ds_read_b64_tr_b16 a[150:151], v231 offset:22528
    v_exp_f32 v220, v220
    v_mfma_f32_16x16x32_bf16 v[192:195], a[152:155], v[96:99], v[192:195]
    s_waitcnt lgkmcnt(4)
    v_exp_f32 v221, v221
    v_smfmac_f32_16x16x64_bf16 a[196:199], a[208:211], v[168:175], v254
    v_fma_f32 v222, v222, s21, v241
    v_mfma_f32_16x16x32_bf16 v[192:195], a[128:131], v[128:131], v[192:195]
    ds_read_b64_tr_b16 a[152:153], v231 offset:24576
    v_fma_f32 v223, v223, s21, v241
    v_mfma_f32_16x16x32_bf16 v[192:195], a[132:135], v[132:135], v[192:195]
    v_exp_f32 v222, v222
    v_mfma_f32_16x16x32_bf16 v[196:199], a[132:135], v[140:143], v[196:199]
    ds_read_b64_tr_b16 a[154:155], v231 offset:26624
    v_mfma_f32_16x16x32_bf16 v[196:199], a[128:131], v[136:139], v[196:199]
    v_exp_f32 v223, v223
    v_mfma_f32_16x16x32_bf16 v[200:203], a[128:131], v[144:147], v[200:203]
    ds_read_b64_tr_b16 a[156:157], v231 offset:28672
    v_cvt_pk_bf16_f32 v190, v220, v221
    v_mfma_f32_16x16x32_bf16 v[200:203], a[132:135], v[148:151], v[200:203]
    v_cvt_pk_bf16_f32 v191, v222, v223
    v_mfma_f32_16x16x32_bf16 v[204:207], a[132:135], v[156:159], v[204:207]
    ds_read_b64_tr_b16 a[158:159], v231 offset:30720
    v_accvgpr_read_b32 v248, a200
    v_mfma_f32_16x16x32_bf16 v[204:207], a[128:131], v[152:155], v[204:207]
    v_accvgpr_read_b32 v244, a201
    v_add_f32 v248, v248, v244
    v_accvgpr_read_b32 v246, a192
    v_accvgpr_read_b32 v242, a193
    v_add_f32 v246, v246, v242
    v_smfmac_f32_16x16x64_bf16 a[204:207], a[208:211], v[184:191], v254
    v_rcp_f32 v244, v248
    v_rcp_f32 v242, v246
    v_mfma_f32_16x16x32_bf16 v[204:207], a[136:139], v[184:187], v[204:207]
    ds_read_b64_tr_b16 a[128:129], v231 offset:32768
    v_accvgpr_read_b32 v247, a196
    v_mfma_f32_16x16x32_bf16 v[204:207], a[140:143], v[188:191], v[204:207]
    v_accvgpr_read_b32 v243, a197
    v_add_f32 v247, v247, v243
    v_rcp_f32 v243, v247
    v_max3_f32 v250, v246, v247, v248
    v_mfma_f32_16x16x32_bf16 v[200:203], a[140:143], v[180:183], v[200:203]
    ds_read_b64_tr_b16 a[130:131], v231 offset:34816
    v_max3_f32 v246, v242, v243, v244
    v_mfma_f32_16x16x32_bf16 v[200:203], a[136:139], v[176:179], v[200:203]
    v_accvgpr_read_b32 v249, a204
    v_accvgpr_read_b32 v245, a205
    v_mfma_f32_16x16x32_bf16 v[196:199], a[136:139], v[168:171], v[196:199]
    ds_read_b64_tr_b16 a[132:133], v231 offset:36864
    v_add_f32 v249, v249, v245
    v_mfma_f32_16x16x32_bf16 v[196:199], a[140:143], v[172:175], v[196:199]
    v_rcp_f32 v245, v249
    v_max_f32 v250, v250, v249
    v_mul_f32 v250, s22, v250
    v_max3_f32 v246, v246, v245, v250
    v_mfma_f32_16x16x32_bf16 v[192:195], a[140:143], v[164:167], v[192:195]
    ds_read_b64_tr_b16 a[134:135], v231 offset:38912
    v_cmp_lt_f32 vcc, 4.0, v246
    v_mfma_f32_16x16x32_bf16 v[192:195], a[136:139], v[160:163], v[192:195]
    s_waitcnt lgkmcnt(4)
    s_cbranch_vccnz L_slow
L_back_last:
    v_mfma_f32_16x16x32_bf16 v[208:211], a[144:147], v[0:3], 0
    ds_read_b64_tr_b16 a[136:137], v231 offset:40960
    v_xor_b32 v236, 0x60, v236
    v_mfma_f32_16x16x32_bf16 v[208:211], a[148:151], v[4:7], v[208:211]
    s_add_u32 m0, s23, 0x10000
    v_mul_f32 v200, v244, v200
    v_mfma_f32_16x16x32_bf16 v[212:215], a[148:151], v[12:15], 0
    ds_read_b64_tr_b16 a[138:139], v231 offset:43008
    v_mul_f32 v201, v244, v201
    v_mfma_f32_16x16x32_bf16 v[212:215], a[144:147], v[8:11], v[212:215]
    v_mfma_f32_16x16x32_bf16 v[216:219], a[144:147], v[16:19], 0
    s_add_u32 s34, s42, 0x10000
    ds_read_b64_tr_b16 a[140:141], v231 offset:45056
    v_cvt_pk_bf16_f32 v200, v200, v201
    v_mfma_f32_16x16x32_bf16 v[216:219], a[148:151], v[20:23], v[216:219]
    ds_write_b32 v236, v200 offset:16384
    v_mfma_f32_16x16x32_bf16 v[220:223], a[148:151], v[28:31], 0
    ds_read_b64_tr_b16 a[142:143], v231 offset:47104
    v_mul_f32 v202, v244, v202
    v_mfma_f32_16x16x32_bf16 v[220:223], a[144:147], v[24:27], v[220:223]
    v_mfma_f32_16x16x32_bf16 v[220:223], a[152:155], v[56:59], v[220:223]
    ds_read_b64_tr_b16 a[144:145], v231 offset:49152
    v_mul_f32 v203, v244, v203
    v_mfma_f32_16x16x32_bf16 v[220:223], a[156:159], v[60:63], v[220:223]
    v_mfma_f32_16x16x32_bf16 v[216:219], a[156:159], v[52:55], v[216:219]
    ds_read_b64_tr_b16 a[146:147], v231 offset:51200
    v_cvt_pk_bf16_f32 v202, v202, v203
    v_mfma_f32_16x16x32_bf16 v[216:219], a[152:155], v[48:51], v[216:219]
    ds_write_b32 v236, v202 offset:16388
    v_mfma_f32_16x16x32_bf16 v[212:215], a[152:155], v[40:43], v[212:215]
    ds_read_b64_tr_b16 a[148:149], v231 offset:53248
    v_mfma_f32_16x16x32_bf16 v[212:215], a[156:159], v[44:47], v[212:215]
    v_mfma_f32_16x16x32_bf16 v[208:211], a[156:159], v[36:39], v[208:211]
    ds_read_b64_tr_b16 a[150:151], v231 offset:55296
    v_mul_f32 v192, v242, v192
    v_mfma_f32_16x16x32_bf16 v[208:211], a[152:155], v[32:35], v[208:211]
    s_waitcnt lgkmcnt(5)
    v_mul_f32 v193, v242, v193
    v_mfma_f32_16x16x32_bf16 v[208:211], a[128:131], v[64:67], v[208:211]
    ds_read_b64_tr_b16 a[152:153], v231 offset:57344
    v_cvt_pk_bf16_f32 v192, v192, v193
    v_mfma_f32_16x16x32_bf16 v[208:211], a[132:135], v[68:71], v[208:211]
    buffer_load_dwordx4 v232, s[12:15], s34 offen nt lds
    v_mfma_f32_16x16x32_bf16 v[212:215], a[132:135], v[76:79], v[212:215]
    ds_read_b64_tr_b16 a[154:155], v231 offset:59392
    v_mfma_f32_16x16x32_bf16 v[212:215], a[128:131], v[72:75], v[212:215]
    ds_write_b32 v236, v192 offset:0
    v_mfma_f32_16x16x32_bf16 v[216:219], a[128:131], v[80:83], v[216:219]
    ds_read_b64_tr_b16 a[156:157], v231 offset:61440
    v_mul_f32 v194, v242, v194
    v_mfma_f32_16x16x32_bf16 v[216:219], a[132:135], v[84:87], v[216:219]
    v_mfma_f32_16x16x32_bf16 v[220:223], a[132:135], v[92:95], v[220:223]
    ds_read_b64_tr_b16 a[158:159], v231 offset:63488
    v_xor_b32 v230, 0x60, v230
    v_mfma_f32_16x16x32_bf16 v[220:223], a[128:131], v[88:91], v[220:223]
    v_xor_b32 v231, 0x60, v231
    v_mul_f32 v195, v242, v195
    v_mfma_f32_16x16x32_bf16 v[220:223], a[136:139], v[120:123], v[220:223]
    ds_read_b64_tr_b16 a[128:129], v231 offset:16384
    v_cvt_pk_bf16_f32 v194, v194, v195
    v_mfma_f32_16x16x32_bf16 v[220:223], a[140:143], v[124:127], v[220:223]
    ds_write_b32 v236, v194 offset:4
    v_mfma_f32_16x16x32_bf16 v[216:219], a[140:143], v[116:119], v[216:219]
    ds_read_b64_tr_b16 a[130:131], v231 offset:18432
    v_mul_f32 v196, v243, v196
    v_mfma_f32_16x16x32_bf16 v[216:219], a[136:139], v[112:115], v[216:219]
    v_mul_f32 v197, v243, v197
    v_mfma_f32_16x16x32_bf16 v[212:215], a[136:139], v[104:107], v[212:215]
    ds_read_b64_tr_b16 a[132:133], v231 offset:20480
    v_cvt_pk_bf16_f32 v196, v196, v197
    v_mfma_f32_16x16x32_bf16 v[212:215], a[140:143], v[108:111], v[212:215]
    ds_write_b32 v236, v196 offset:2048
    v_mfma_f32_16x16x32_bf16 v[208:211], a[140:143], v[100:103], v[208:211]
    ds_read_b64_tr_b16 a[134:135], v231 offset:22528
    v_mfma_f32_16x16x32_bf16 v[208:211], a[136:139], v[96:99], v[208:211]
    s_waitcnt lgkmcnt(6)
    v_mul_f32 v198, v243, v198
    v_mul_f32 v199, v243, v199
    v_mfma_f32_16x16x32_bf16 v[208:211], a[144:147], v[128:131], v[208:211]
    ds_read_b64_tr_b16 a[136:137], v231 offset:24576
    v_cvt_pk_bf16_f32 v198, v198, v199
    v_mfma_f32_16x16x32_bf16 v[208:211], a[148:151], v[132:135], v[208:211]
    ds_write_b32 v236, v198 offset:2052
    v_mfma_f32_16x16x32_bf16 v[212:215], a[148:151], v[140:143], v[212:215]
    ds_read_b64_tr_b16 a[138:139], v231 offset:26624
    v_mul_f32 v204, v245, v204
    v_mfma_f32_16x16x32_bf16 v[212:215], a[144:147], v[136:139], v[212:215]
    v_mfma_f32_16x16x32_bf16 v[216:219], a[144:147], v[144:147], v[216:219]
    ds_read_b64_tr_b16 a[140:141], v231 offset:28672
    v_mul_f32 v205, v245, v205
    v_mfma_f32_16x16x32_bf16 v[216:219], a[148:151], v[148:151], v[216:219]
    v_mfma_f32_16x16x32_bf16 v[220:223], a[148:151], v[156:159], v[220:223]
    ds_read_b64_tr_b16 a[142:143], v231 offset:30720
    v_cvt_pk_bf16_f32 v204, v204, v205
    v_mfma_f32_16x16x32_bf16 v[220:223], a[144:147], v[152:155], v[220:223]
    ds_write_b32 v236, v204 offset:18432
    v_mfma_f32_16x16x32_bf16 v[220:223], a[152:155], v[184:187], v[220:223]
    ds_read_b64_tr_b16 a[144:145], v231 offset:32768
    v_mfma_f32_16x16x32_bf16 v[220:223], a[156:159], v[188:191], v[220:223]
    buffer_load_dwordx4 v233, s[12:15], s34 offen offset:1024 nt lds
    v_mfma_f32_16x16x32_bf16 v[216:219], a[156:159], v[180:183], v[216:219]
    ds_read_b64_tr_b16 a[146:147], v231 offset:34816
    v_mul_f32 v206, v245, v206
    v_mfma_f32_16x16x32_bf16 v[216:219], a[152:155], v[176:179], v[216:219]
    v_mfma_f32_16x16x32_bf16 v[212:215], a[152:155], v[168:171], v[212:215]
    ds_read_b64_tr_b16 a[148:149], v231 offset:36864
    v_mul_f32 v207, v245, v207
    v_mfma_f32_16x16x32_bf16 v[212:215], a[156:159], v[172:175], v[212:215]
    v_mfma_f32_16x16x32_bf16 v[208:211], a[156:159], v[164:167], v[208:211]
    ds_read_b64_tr_b16 a[150:151], v231 offset:38912
    v_cvt_pk_bf16_f32 v206, v206, v207
    v_mfma_f32_16x16x32_bf16 v[208:211], a[152:155], v[160:163], v[208:211]
    s_waitcnt lgkmcnt(5)
    ds_write_b32 v236, v206 offset:18436
    v_mfma_f32_16x16x32_bf16 v[192:195], a[128:131], v[0:3], 0
    ds_read_b64_tr_b16 a[152:153], v231 offset:40960
    v_xor_b32 v236, 32, v236
    v_mfma_f32_16x16x32_bf16 v[192:195], a[132:135], v[4:7], v[192:195]
    v_mfma_f32_16x16x32_bf16 v[196:199], a[132:135], v[12:15], 0
    ds_read_b64_tr_b16 a[154:155], v231 offset:43008
    v_mul_f32 v216, v244, v216
    v_mfma_f32_16x16x32_bf16 v[196:199], a[128:131], v[8:11], v[196:199]
    v_mfma_f32_16x16x32_bf16 v[200:203], a[128:131], v[16:19], 0
    ds_read_b64_tr_b16 a[156:157], v231 offset:45056
    v_mul_f32 v217, v244, v217
    v_mfma_f32_16x16x32_bf16 v[200:203], a[132:135], v[20:23], v[200:203]
    v_mfma_f32_16x16x32_bf16 v[204:207], a[132:135], v[28:31], 0
    ds_read_b64_tr_b16 a[158:159], v231 offset:47104
    v_cvt_pk_bf16_f32 v216, v216, v217
    v_mfma_f32_16x16x32_bf16 v[204:207], a[128:131], v[24:27], v[204:207]
    ds_write_b32 v236, v216 offset:16384
    v_mfma_f32_16x16x32_bf16 v[204:207], a[136:139], v[56:59], v[204:207]
    ds_read_b64_tr_b16 a[128:129], v231 offset:49152
    v_mul_f32 v218, v244, v218
    v_mfma_f32_16x16x32_bf16 v[204:207], a[140:143], v[60:63], v[204:207]
    v_mul_f32 v219, v244, v219
    v_mfma_f32_16x16x32_bf16 v[200:203], a[140:143], v[52:55], v[200:203]
    ds_read_b64_tr_b16 a[130:131], v231 offset:51200
    v_cvt_pk_bf16_f32 v218, v218, v219
    v_mfma_f32_16x16x32_bf16 v[200:203], a[136:139], v[48:51], v[200:203]
    ds_write_b32 v236, v218 offset:16388
    v_mfma_f32_16x16x32_bf16 v[196:199], a[136:139], v[40:43], v[196:199]
    ds_read_b64_tr_b16 a[132:133], v231 offset:53248
    v_mfma_f32_16x16x32_bf16 v[196:199], a[140:143], v[44:47], v[196:199]
    buffer_load_dwordx4 v234, s[12:15], s34 offen offset:2048 nt lds
    v_mfma_f32_16x16x32_bf16 v[192:195], a[140:143], v[36:39], v[192:195]
    ds_read_b64_tr_b16 a[134:135], v231 offset:55296
    v_mul_f32 v208, v242, v208
    v_mfma_f32_16x16x32_bf16 v[192:195], a[136:139], v[32:35], v[192:195]
    s_waitcnt lgkmcnt(6)
    v_mul_f32 v209, v242, v209
    v_mfma_f32_16x16x32_bf16 v[192:195], a[144:147], v[64:67], v[192:195]
    ds_read_b64_tr_b16 a[136:137], v231 offset:57344
    v_cvt_pk_bf16_f32 v208, v208, v209
    v_mfma_f32_16x16x32_bf16 v[192:195], a[148:151], v[68:71], v[192:195]
    ds_write_b32 v236, v208 offset:0
    v_mfma_f32_16x16x32_bf16 v[196:199], a[148:151], v[76:79], v[196:199]
    ds_read_b64_tr_b16 a[138:139], v231 offset:59392
    v_mul_f32 v210, v242, v210
    v_mfma_f32_16x16x32_bf16 v[196:199], a[144:147], v[72:75], v[196:199]
    v_mfma_f32_16x16x32_bf16 v[200:203], a[144:147], v[80:83], v[200:203]
    ds_read_b64_tr_b16 a[140:141], v231 offset:61440
    v_mul_f32 v211, v242, v211
    v_mfma_f32_16x16x32_bf16 v[200:203], a[148:151], v[84:87], v[200:203]
    v_mfma_f32_16x16x32_bf16 v[204:207], a[148:151], v[92:95], v[204:207]
    ds_read_b64_tr_b16 a[142:143], v231 offset:63488
    v_xor_b32 v230, 32, v230
    v_mfma_f32_16x16x32_bf16 v[204:207], a[144:147], v[88:91], v[204:207]
    v_xor_b32 v231, 32, v231
    v_cvt_pk_bf16_f32 v210, v210, v211
    v_mfma_f32_16x16x32_bf16 v[204:207], a[152:155], v[120:123], v[204:207]
    ds_read_b64_tr_b16 a[144:145], v231 offset:16384
    v_mfma_f32_16x16x32_bf16 v[204:207], a[156:159], v[124:127], v[204:207]
    ds_write_b32 v236, v210 offset:4
    v_mfma_f32_16x16x32_bf16 v[200:203], a[156:159], v[116:119], v[200:203]
    ds_read_b64_tr_b16 a[146:147], v231 offset:18432
    v_mul_f32 v212, v243, v212
    v_mfma_f32_16x16x32_bf16 v[200:203], a[152:155], v[112:115], v[200:203]
    v_mul_f32 v213, v243, v213
    v_mfma_f32_16x16x32_bf16 v[196:199], a[152:155], v[104:107], v[196:199]
    ds_read_b64_tr_b16 a[148:149], v231 offset:20480
    v_cvt_pk_bf16_f32 v212, v212, v213
    v_mfma_f32_16x16x32_bf16 v[196:199], a[156:159], v[108:111], v[196:199]
    ds_write_b32 v236, v212 offset:2048
    v_mfma_f32_16x16x32_bf16 v[192:195], a[156:159], v[100:103], v[192:195]
    ds_read_b64_tr_b16 a[150:151], v231 offset:22528
    v_mfma_f32_16x16x32_bf16 v[192:195], a[152:155], v[96:99], v[192:195]
    s_waitcnt lgkmcnt(6)
    v_mul_f32 v214, v243, v214
    v_mfma_f32_16x16x32_bf16 v[192:195], a[128:131], v[128:131], v[192:195]
    ds_read_b64_tr_b16 a[152:153], v231 offset:24576
    v_mul_f32 v215, v243, v215
    v_mfma_f32_16x16x32_bf16 v[192:195], a[132:135], v[132:135], v[192:195]
    v_mfma_f32_16x16x32_bf16 v[196:199], a[132:135], v[140:143], v[196:199]
    ds_read_b64_tr_b16 a[154:155], v231 offset:26624
    v_cvt_pk_bf16_f32 v214, v214, v215
    v_mfma_f32_16x16x32_bf16 v[196:199], a[128:131], v[136:139], v[196:199]
    ds_write_b32 v236, v214 offset:2052
    v_mfma_f32_16x16x32_bf16 v[200:203], a[128:131], v[144:147], v[200:203]
    ds_read_b64_tr_b16 a[156:157], v231 offset:28672
    v_mul_f32 v220, v245, v220
    v_mfma_f32_16x16x32_bf16 v[200:203], a[132:135], v[148:151], v[200:203]
    buffer_load_dwordx4 v235, s[12:15], s34 offen offset:3072 nt lds
    v_mfma_f32_16x16x32_bf16 v[204:207], a[132:135], v[156:159], v[204:207]
    ds_read_b64_tr_b16 a[158:159], v231 offset:30720
    v_mul_f32 v221, v245, v221
    v_mfma_f32_16x16x32_bf16 v[204:207], a[128:131], v[152:155], v[204:207]
    v_mfma_f32_16x16x32_bf16 v[204:207], a[136:139], v[184:187], v[204:207]
    ds_read_b64_tr_b16 a[128:129], v231 offset:32768
    v_cvt_pk_bf16_f32 v220, v220, v221
    v_mfma_f32_16x16x32_bf16 v[204:207], a[140:143], v[188:191], v[204:207]
    ds_write_b32 v236, v220 offset:18432
    v_mfma_f32_16x16x32_bf16 v[200:203], a[140:143], v[180:183], v[200:203]
    ds_read_b64_tr_b16 a[130:131], v231 offset:34816
    v_mul_f32 v222, v245, v222
    v_mfma_f32_16x16x32_bf16 v[200:203], a[136:139], v[176:179], v[200:203]
    v_mfma_f32_16x16x32_bf16 v[196:199], a[136:139], v[168:171], v[196:199]
    ds_read_b64_tr_b16 a[132:133], v231 offset:36864
    v_mul_f32 v223, v245, v223
    v_mfma_f32_16x16x32_bf16 v[196:199], a[140:143], v[172:175], v[196:199]
    v_mfma_f32_16x16x32_bf16 v[192:195], a[140:143], v[164:167], v[192:195]
    ds_read_b64_tr_b16 a[134:135], v231 offset:38912
    v_cvt_pk_bf16_f32 v222, v222, v223
    v_mfma_f32_16x16x32_bf16 v[192:195], a[136:139], v[160:163], v[192:195]
    s_waitcnt lgkmcnt(5)
    ds_write_b32 v236, v222 offset:18436
    v_mfma_f32_16x16x32_bf16 v[208:211], a[144:147], v[0:3], 0
    ds_read_b64_tr_b16 a[136:137], v231 offset:40960
    v_xor_b32 v236, 0x60, v236
    v_mfma_f32_16x16x32_bf16 v[208:211], a[148:151], v[4:7], v[208:211]
    v_mfma_f32_16x16x32_bf16 v[212:215], a[148:151], v[12:15], 0
    ds_read_b64_tr_b16 a[138:139], v231 offset:43008
    v_mul_f32 v200, v244, v200
    v_mfma_f32_16x16x32_bf16 v[212:215], a[144:147], v[8:11], v[212:215]
    v_mfma_f32_16x16x32_bf16 v[216:219], a[144:147], v[16:19], 0
    ds_read_b64_tr_b16 a[140:141], v231 offset:45056
    v_mul_f32 v201, v244, v201
    v_mfma_f32_16x16x32_bf16 v[216:219], a[148:151], v[20:23], v[216:219]
    v_mfma_f32_16x16x32_bf16 v[220:223], a[148:151], v[28:31], 0
    ds_read_b64_tr_b16 a[142:143], v231 offset:47104
    v_cvt_pk_bf16_f32 v200, v200, v201
    v_mfma_f32_16x16x32_bf16 v[220:223], a[144:147], v[24:27], v[220:223]
    ds_write_b32 v236, v200 offset:16384
    v_mfma_f32_16x16x32_bf16 v[220:223], a[152:155], v[56:59], v[220:223]
    ds_read_b64_tr_b16 a[144:145], v231 offset:49152
    v_mul_f32 v202, v244, v202
    v_mfma_f32_16x16x32_bf16 v[220:223], a[156:159], v[60:63], v[220:223]
    v_mfma_f32_16x16x32_bf16 v[216:219], a[156:159], v[52:55], v[216:219]
    ds_read_b64_tr_b16 a[146:147], v231 offset:51200
    v_mul_f32 v203, v244, v203
    v_mfma_f32_16x16x32_bf16 v[216:219], a[152:155], v[48:51], v[216:219]
    v_mfma_f32_16x16x32_bf16 v[212:215], a[152:155], v[40:43], v[212:215]
    ds_read_b64_tr_b16 a[148:149], v231 offset:53248
    v_cvt_pk_bf16_f32 v202, v202, v203
    v_mfma_f32_16x16x32_bf16 v[212:215], a[156:159], v[44:47], v[212:215]
    ds_write_b32 v236, v202 offset:16388
    v_mfma_f32_16x16x32_bf16 v[208:211], a[156:159], v[36:39], v[208:211]
    ds_read_b64_tr_b16 a[150:151], v231 offset:55296
    v_mul_f32 v192, v242, v192
    v_mfma_f32_16x16x32_bf16 v[208:211], a[152:155], v[32:35], v[208:211]
    s_waitcnt lgkmcnt(6)
    v_mul_f32 v193, v242, v193
    v_mfma_f32_16x16x32_bf16 v[208:211], a[128:131], v[64:67], v[208:211]
    ds_read_b64_tr_b16 a[152:153], v231 offset:57344
    v_cvt_pk_bf16_f32 v192, v192, v193
    v_mfma_f32_16x16x32_bf16 v[208:211], a[132:135], v[68:71], v[208:211]
    ds_write_b32 v236, v192 offset:0
    v_mfma_f32_16x16x32_bf16 v[212:215], a[132:135], v[76:79], v[212:215]
    ds_read_b64_tr_b16 a[154:155], v231 offset:59392
    v_mul_f32 v194, v242, v194
    v_mfma_f32_16x16x32_bf16 v[212:215], a[128:131], v[72:75], v[212:215]
    v_mfma_f32_16x16x32_bf16 v[216:219], a[128:131], v[80:83], v[216:219]
    ds_read_b64_tr_b16 a[156:157], v231 offset:61440
    v_mul_f32 v195, v242, v195
    v_mfma_f32_16x16x32_bf16 v[216:219], a[132:135], v[84:87], v[216:219]
    v_mfma_f32_16x16x32_bf16 v[220:223], a[132:135], v[92:95], v[220:223]
    ds_read_b64_tr_b16 a[158:159], v231 offset:63488
    v_xor_b32 v230, 0x60, v230
    v_mfma_f32_16x16x32_bf16 v[220:223], a[128:131], v[88:91], v[220:223]
    v_xor_b32 v231, 0x60, v231
    v_cvt_pk_bf16_f32 v194, v194, v195
    v_mfma_f32_16x16x32_bf16 v[220:223], a[136:139], v[120:123], v[220:223]
    ds_write_b32 v236, v194 offset:4
    v_mfma_f32_16x16x32_bf16 v[220:223], a[140:143], v[124:127], v[220:223]
    v_mul_f32 v196, v243, v196
    v_mfma_f32_16x16x32_bf16 v[216:219], a[140:143], v[116:119], v[216:219]
    v_mfma_f32_16x16x32_bf16 v[216:219], a[136:139], v[112:115], v[216:219]
    v_mul_f32 v197, v243, v197
    v_cvt_pk_bf16_f32 v196, v196, v197
    v_mfma_f32_16x16x32_bf16 v[212:215], a[136:139], v[104:107], v[212:215]
    v_mfma_f32_16x16x32_bf16 v[212:215], a[140:143], v[108:111], v[212:215]
    ds_write_b32 v236, v196 offset:2048
    v_mfma_f32_16x16x32_bf16 v[208:211], a[140:143], v[100:103], v[208:211]
    v_mfma_f32_16x16x32_bf16 v[208:211], a[136:139], v[96:99], v[208:211]
    s_waitcnt vmcnt(9) lgkmcnt(2)
    s_barrier
    v_mfma_f32_16x16x32_bf16 v[208:211], a[144:147], v[128:131], v[208:211]
    s_add_u32 m0, s23, 0x14000
    ds_read_b64_tr_b16 a[128:129], v230 offset:0
    v_mul_f32 v198, v243, v198
    v_mfma_f32_16x16x32_bf16 v[208:211], a[148:151], v[132:135], v[208:211]
    ds_read_b64_tr_b16 a[130:131], v230 offset:2048
    v_mul_f32 v199, v243, v199
    v_mfma_f32_16x16x32_bf16 v[212:215], a[148:151], v[140:143], v[212:215]
    s_add_u32 s34, s42, 0x20000
    ds_read_b64_tr_b16 a[132:133], v230 offset:4096
    v_cvt_pk_bf16_f32 v198, v198, v199
    v_mfma_f32_16x16x32_bf16 v[212:215], a[144:147], v[136:139], v[212:215]
    ds_read_b64_tr_b16 a[134:135], v230 offset:6144
    ds_write_b32 v236, v198 offset:2052
    v_mfma_f32_16x16x32_bf16 v[216:219], a[144:147], v[144:147], v[216:219]
    ds_read_b64_tr_b16 a[136:137], v230 offset:8192
    v_mfma_f32_16x16x32_bf16 v[216:219], a[148:151], v[148:151], v[216:219]
    ds_read_b64_tr_b16 a[138:139], v230 offset:10240
    v_mul_f32 v204, v245, v204
    v_mfma_f32_16x16x32_bf16 v[220:223], a[148:151], v[156:159], v[220:223]
    ds_read_b64_tr_b16 a[140:141], v230 offset:12288
    v_mul_f32 v205, v245, v205
    v_mfma_f32_16x16x32_bf16 v[220:223], a[144:147], v[152:155], v[220:223]
    ds_read_b64_tr_b16 a[142:143], v230 offset:14336
    v_mfma_f32_16x16x32_bf16 v[220:223], a[152:155], v[184:187], v[220:223]
    ds_read_b64_tr_b16 a[144:145], v230 offset:16384
    v_cvt_pk_bf16_f32 v204, v204, v205
    v_mfma_f32_16x16x32_bf16 v[220:223], a[156:159], v[188:191], v[220:223]
    buffer_load_dwordx4 v232, s[12:15], s34 offen nt lds
    v_mfma_f32_16x16x32_bf16 v[216:219], a[156:159], v[180:183], v[216:219]
    ds_read_b64_tr_b16 a[146:147], v230 offset:18432
    v_mfma_f32_16x16x32_bf16 v[216:219], a[152:155], v[176:179], v[216:219]
    ds_write_b32 v236, v204 offset:18432
    v_mfma_f32_16x16x32_bf16 v[212:215], a[152:155], v[168:171], v[212:215]
    ds_read_b64_tr_b16 a[148:149], v230 offset:20480
    v_mul_f32 v206, v245, v206
    v_mfma_f32_16x16x32_bf16 v[212:215], a[156:159], v[172:175], v[212:215]
    v_mul_f32 v207, v245, v207
    v_cvt_pk_bf16_f32 v206, v206, v207
    v_mfma_f32_16x16x32_bf16 v[208:211], a[156:159], v[164:167], v[208:211]
    ds_read_b64_tr_b16 a[150:151], v230 offset:22528
    v_mfma_f32_16x16x32_bf16 v[208:211], a[152:155], v[160:163], v[208:211]
    s_waitcnt lgkmcnt(5)
    ds_write_b32 v236, v206 offset:18436
    v_mfma_f32_16x16x32_bf16 v[192:195], a[128:131], v[0:3], 0
    ds_read_b64_tr_b16 a[152:153], v230 offset:24576
    v_xor_b32 v236, 32, v236
    v_mfma_f32_16x16x32_bf16 v[192:195], a[132:135], v[4:7], v[192:195]
    v_mfma_f32_16x16x32_bf16 v[196:199], a[132:135], v[12:15], 0
    ds_read_b64_tr_b16 a[154:155], v230 offset:26624
    v_mul_f32 v216, v244, v216
    v_mfma_f32_16x16x32_bf16 v[196:199], a[128:131], v[8:11], v[196:199]
    buffer_load_dwordx4 v233, s[12:15], s34 offen offset:1024 nt lds
    v_mfma_f32_16x16x32_bf16 v[200:203], a[128:131], v[16:19], 0
    ds_read_b64_tr_b16 a[156:157], v230 offset:28672
    v_mul_f32 v217, v244, v217
    v_mfma_f32_16x16x32_bf16 v[200:203], a[132:135], v[20:23], v[200:203]
    v_mul_f32 v218, v244, v218
    v_mul_f32 v219, v244, v219
    v_mfma_f32_16x16x32_bf16 v[204:207], a[132:135], v[28:31], 0
    ds_read_b64_tr_b16 a[158:159], v230 offset:30720
    v_cvt_pk_bf16_f32 v216, v216, v217
    v_mfma_f32_16x16x32_bf16 v[204:207], a[128:131], v[24:27], v[204:207]
    v_mfma_f32_16x16x32_bf16 v[204:207], a[136:139], v[56:59], v[204:207]
    ds_read_b64_tr_b16 a[128:129], v230 offset:32768
    v_cvt_pk_bf16_f32 v217, v218, v219
    v_mfma_f32_16x16x32_bf16 v[204:207], a[140:143], v[60:63], v[204:207]
    ds_write_b64 v236, v[216:217] offset:16384
    v_mfma_f32_16x16x32_bf16 v[200:203], a[140:143], v[52:55], v[200:203]
    ds_read_b64_tr_b16 a[130:131], v230 offset:34816
    v_mul_f32 v208, v242, v208
    v_mfma_f32_16x16x32_bf16 v[200:203], a[136:139], v[48:51], v[200:203]
    v_mfma_f32_16x16x32_bf16 v[196:199], a[136:139], v[40:43], v[196:199]
    ds_read_b64_tr_b16 a[132:133], v230 offset:36864
    v_mul_f32 v209, v242, v209
    v_mfma_f32_16x16x32_bf16 v[196:199], a[140:143], v[44:47], v[196:199]
    buffer_load_dwordx4 v234, s[12:15], s34 offen offset:2048 nt lds
    v_mfma_f32_16x16x32_bf16 v[192:195], a[140:143], v[36:39], v[192:195]
    ds_read_b64_tr_b16 a[134:135], v230 offset:38912
    v_mul_f32 v210, v242, v210
    v_mfma_f32_16x16x32_bf16 v[192:195], a[136:139], v[32:35], v[192:195]
    s_waitcnt lgkmcnt(5)
    v_mul_f32 v211, v242, v211
    v_mfma_f32_16x16x32_bf16 v[192:195], a[144:147], v[64:67], v[192:195]
    ds_read_b64_tr_b16 a[136:137], v230 offset:40960
    v_cvt_pk_bf16_f32 v208, v208, v209
    v_mfma_f32_16x16x32_bf16 v[192:195], a[148:151], v[68:71], v[192:195]
    v_mfma_f32_16x16x32_bf16 v[196:199], a[148:151], v[76:79], v[196:199]
    ds_read_b64_tr_b16 a[138:139], v230 offset:43008
    v_cvt_pk_bf16_f32 v209, v210, v211
    v_mfma_f32_16x16x32_bf16 v[196:199], a[144:147], v[72:75], v[196:199]
    ds_write_b64 v236, v[208:209] offset:0
    v_mfma_f32_16x16x32_bf16 v[200:203], a[144:147], v[80:83], v[200:203]
    ds_read_b64_tr_b16 a[140:141], v230 offset:45056
    v_mul_f32 v212, v243, v212
    v_mfma_f32_16x16x32_bf16 v[200:203], a[148:151], v[84:87], v[200:203]
    v_mul_f32 v213, v243, v213
    v_mul_f32 v214, v243, v214
    v_mfma_f32_16x16x32_bf16 v[204:207], a[148:151], v[92:95], v[204:207]
    ds_read_b64_tr_b16 a[142:143], v230 offset:47104
    v_xor_b32 v230, 32, v230
    v_mfma_f32_16x16x32_bf16 v[204:207], a[144:147], v[88:91], v[204:207]
    v_xor_b32 v231, 32, v231
    v_mul_f32 v215, v243, v215
    v_mfma_f32_16x16x32_bf16 v[204:207], a[152:155], v[120:123], v[204:207]
    ds_read_b64_tr_b16 a[144:145], v230 offset:0
    v_cvt_pk_bf16_f32 v212, v212, v213
    v_mfma_f32_16x16x32_bf16 v[204:207], a[156:159], v[124:127], v[204:207]
    buffer_load_dwordx4 v235, s[12:15], s34 offen offset:3072 nt lds
    v_mfma_f32_16x16x32_bf16 v[200:203], a[156:159], v[116:119], v[200:203]
    ds_read_b64_tr_b16 a[146:147], v230 offset:2048
    v_cvt_pk_bf16_f32 v213, v214, v215
    v_mfma_f32_16x16x32_bf16 v[200:203], a[152:155], v[112:115], v[200:203]
    ds_write_b64 v236, v[212:213] offset:2048
    v_mfma_f32_16x16x32_bf16 v[196:199], a[152:155], v[104:107], v[196:199]
L_hop12:
    s_cbranch_execz L_hopret3
    ds_read_b64_tr_b16 a[148:149], v230 offset:4096
    v_mfma_f32_16x16x32_bf16 v[196:199], a[156:159], v[108:111], v[196:199]
    v_mul_f32 v220, v245, v220
    v_mul_f32 v221, v245, v221
    v_mfma_f32_16x16x32_bf16 v[192:195], a[156:159], v[100:103], v[192:195]
    ds_read_b64_tr_b16 a[150:151], v230 offset:6144
    v_mul_f32 v222, v245, v222
    v_mfma_f32_16x16x32_bf16 v[192:195], a[152:155], v[96:99], v[192:195]
    s_waitcnt lgkmcnt(5)
    v_mul_f32 v223, v245, v223
    v_cvt_pk_bf16_f32 v220, v220, v221
    v_mfma_f32_16x16x32_bf16 v[192:195], a[128:131], v[128:131], v[192:195]
    ds_read_b64_tr_b16 a[152:153], v230 offset:8192
    v_cvt_pk_bf16_f32 v221, v222, v223
    v_mfma_f32_16x16x32_bf16 v[192:195], a[132:135], v[132:135], v[192:195]
    ds_write_b64 v236, v[220:221] offset:18432
    v_mfma_f32_16x16x32_bf16 v[196:199], a[132:135], v[140:143], v[196:199]
    ds_read_b64_tr_b16 a[154:155], v230 offset:10240
    v_mfma_f32_16x16x32_bf16 v[196:199], a[128:131], v[136:139], v[196:199]
    ds_read_b128 a[212:215], v237 offset:0
    v_mfma_f32_16x16x32_bf16 v[200:203], a[128:131], v[144:147], v[200:203]
    ds_read_b64_tr_b16 a[156:157], v230 offset:12288
    v_mfma_f32_16x16x32_bf16 v[200:203], a[132:135], v[148:151], v[200:203]
    ds_read_b128 a[216:219], v237 offset:1024
    v_mfma_f32_16x16x32_bf16 v[204:207], a[132:135], v[156:159], v[204:207]
    ds_read_b64_tr_b16 a[158:159], v230 offset:14336
    v_mfma_f32_16x16x32_bf16 v[204:207], a[128:131], v[152:155], v[204:207]
    ds_read_b128 a[220:223], v237 offset:2048
    v_mfma_f32_16x16x32_bf16 v[204:207], a[136:139], v[184:187], v[204:207]
    s_add_u32 m0, s23, 0x18000
    ds_read_b64_tr_b16 a[128:129], v230 offset:16384
    v_mfma_f32_16x16x32_bf16 v[204:207], a[140:143], v[188:191], v[204:207]
    ds_read_b128 a[224:227], v237 offset:3072
    v_mfma_f32_16x16x32_bf16 v[200:203], a[140:143], v[180:183], v[200:203]
    s_add_u32 s34, s43, 0
    ds_read_b64_tr_b16 a[130:131], v230 offset:18432
    v_mfma_f32_16x16x32_bf16 v[200:203], a[136:139], v[176:179], v[200:203]
    ds_read_b128 a[228:231], v237 offset:16384
    v_mfma_f32_16x16x32_bf16 v[196:199], a[136:139], v[168:171], v[196:199]
    ds_read_b64_tr_b16 a[132:133], v230 offset:20480
    v_mfma_f32_16x16x32_bf16 v[196:199], a[140:143], v[172:175], v[196:199]
    ds_read_b128 a[232:235], v237 offset:17408
    ds_read_b128 a[236:239], v237 offset:18432
    v_mfma_f32_16x16x32_bf16 v[192:195], a[140:143], v[164:167], v[192:195]
    ds_read_b64_tr_b16 a[134:135], v230 offset:22528
    v_mfma_f32_16x16x32_bf16 v[192:195], a[136:139], v[160:163], v[192:195]
    s_waitcnt lgkmcnt(9)
    ds_read_b128 a[240:243], v237 offset:19456
    buffer_load_dwordx4 v232, s[12:15], s34 offen nt lds
    v_mfma_f32_16x16x32_bf16 v[208:211], a[144:147], v[0:3], 0
    ds_read_b64_tr_b16 a[136:137], v230 offset:24576
    v_xor_b32 v236, 0x60, v236
    v_mfma_f32_16x16x32_bf16 v[208:211], a[148:151], v[4:7], v[208:211]
    v_mfma_f32_16x16x32_bf16 v[212:215], a[148:151], v[12:15], 0
    ds_read_b64_tr_b16 a[138:139], v230 offset:26624
    v_mul_f32 v200, v244, v200
    v_mfma_f32_16x16x32_bf16 v[212:215], a[144:147], v[8:11], v[212:215]
    v_mfma_f32_16x16x32_bf16 v[216:219], a[144:147], v[16:19], 0
    ds_read_b64_tr_b16 a[140:141], v230 offset:28672
    v_mul_f32 v201, v244, v201
    v_mfma_f32_16x16x32_bf16 v[216:219], a[148:151], v[20:23], v[216:219]
    v_mfma_f32_16x16x32_bf16 v[220:223], a[148:151], v[28:31], 0
    ds_read_b64_tr_b16 a[142:143], v230 offset:30720
    v_cvt_pk_bf16_f32 v200, v200, v201
    v_mfma_f32_16x16x32_bf16 v[220:223], a[144:147], v[24:27], v[220:223]
    ds_write_b32 v236, v200 offset:16384
    v_mfma_f32_16x16x32_bf16 v[220:223], a[152:155], v[56:59], v[220:223]
    ds_read_b64_tr_b16 a[144:145], v230 offset:32768
    v_mul_f32 v202, v244, v202
    v_mfma_f32_16x16x32_bf16 v[220:223], a[156:159], v[60:63], v[220:223]
    v_mfma_f32_16x16x32_bf16 v[216:219], a[156:159], v[52:55], v[216:219]
    ds_read_b64_tr_b16 a[146:147], v230 offset:34816
    v_mul_f32 v203, v244, v203
    v_mfma_f32_16x16x32_bf16 v[216:219], a[152:155], v[48:51], v[216:219]
    buffer_load_dwordx4 v233, s[12:15], s34 offen offset:1024 nt lds
    v_mfma_f32_16x16x32_bf16 v[212:215], a[152:155], v[40:43], v[212:215]
    ds_read_b64_tr_b16 a[148:149], v230 offset:36864
    v_cvt_pk_bf16_f32 v202, v202, v203
    v_mfma_f32_16x16x32_bf16 v[212:215], a[156:159], v[44:47], v[212:215]
    ds_write_b32 v236, v202 offset:16388
    v_mfma_f32_16x16x32_bf16 v[208:211], a[156:159], v[36:39], v[208:211]
    ds_read_b64_tr_b16 a[150:151], v230 offset:38912
    v_mul_f32 v192, v242, v192
    v_mfma_f32_16x16x32_bf16 v[208:211], a[152:155], v[32:35], v[208:211]
    s_waitcnt lgkmcnt(6)
    v_mul_f32 v193, v242, v193
    v_mfma_f32_16x16x32_bf16 v[208:211], a[128:131], v[64:67], v[208:211]
    ds_read_b64_tr_b16 a[152:153], v230 offset:40960
    v_cvt_pk_bf16_f32 v192, v192, v193
    v_mfma_f32_16x16x32_bf16 v[208:211], a[132:135], v[68:71], v[208:211]
    buffer_store_dwordx4 a[212:215], v232, s[16:19], s44 offen sc1
    v_mfma_f32_16x16x32_bf16 v[212:215], a[132:135], v[76:79], v[212:215]
    ds_read_b64_tr_b16 a[154:155], v230 offset:43008
    v_mfma_f32_16x16x32_bf16 v[212:215], a[128:131], v[72:75], v[212:215]
    ds_write_b32 v236, v192 offset:0
    v_mfma_f32_16x16x32_bf16 v[216:219], a[128:131], v[80:83], v[216:219]
    ds_read_b64_tr_b16 a[156:157], v230 offset:45056
    v_mul_f32 v194, v242, v194
    v_mfma_f32_16x16x32_bf16 v[216:219], a[132:135], v[84:87], v[216:219]
    buffer_load_dwordx4 v234, s[12:15], s34 offen offset:2048 nt lds
    v_mfma_f32_16x16x32_bf16 v[220:223], a[132:135], v[92:95], v[220:223]
    ds_read_b64_tr_b16 a[158:159], v230 offset:47104
    v_xor_b32 v230, 0x60, v230
    v_mfma_f32_16x16x32_bf16 v[220:223], a[128:131], v[88:91], v[220:223]
    v_xor_b32 v231, 0x60, v231
    v_mul_f32 v195, v242, v195
    v_mfma_f32_16x16x32_bf16 v[220:223], a[136:139], v[120:123], v[220:223]
    ds_read_b64_tr_b16 a[128:129], v230 offset:0
    v_cvt_pk_bf16_f32 v194, v194, v195
    v_mfma_f32_16x16x32_bf16 v[220:223], a[140:143], v[124:127], v[220:223]
    ds_write_b32 v236, v194 offset:4
    v_mfma_f32_16x16x32_bf16 v[216:219], a[140:143], v[116:119], v[216:219]
    ds_read_b64_tr_b16 a[130:131], v230 offset:2048
    v_mul_f32 v196, v243, v196
    v_mfma_f32_16x16x32_bf16 v[216:219], a[136:139], v[112:115], v[216:219]
    v_mul_f32 v197, v243, v197
    v_mfma_f32_16x16x32_bf16 v[212:215], a[136:139], v[104:107], v[212:215]
    ds_read_b64_tr_b16 a[132:133], v230 offset:4096
    v_cvt_pk_bf16_f32 v196, v196, v197
    v_mfma_f32_16x16x32_bf16 v[212:215], a[140:143], v[108:111], v[212:215]
    ds_write_b32 v236, v196 offset:2048
    v_mfma_f32_16x16x32_bf16 v[208:211], a[140:143], v[100:103], v[208:211]
    ds_read_b64_tr_b16 a[134:135], v230 offset:6144
    v_mfma_f32_16x16x32_bf16 v[208:211], a[136:139], v[96:99], v[208:211]
    s_waitcnt lgkmcnt(6)
    v_mul_f32 v198, v243, v198
    v_mfma_f32_16x16x32_bf16 v[208:211], a[144:147], v[128:131], v[208:211]
    ds_read_b64_tr_b16 a[136:137], v230 offset:8192
    v_mul_f32 v199, v243, v199
    v_mfma_f32_16x16x32_bf16 v[208:211], a[148:151], v[132:135], v[208:211]
    buffer_load_dwordx4 v235, s[12:15], s34 offen offset:3072 nt lds
    v_mfma_f32_16x16x32_bf16 v[212:215], a[148:151], v[140:143], v[212:215]
    ds_read_b64_tr_b16 a[138:139], v230 offset:10240
    v_cvt_pk_bf16_f32 v198, v198, v199
    v_mfma_f32_16x16x32_bf16 v[212:215], a[144:147], v[136:139], v[212:215]
    ds_write_b32 v236, v198 offset:2052
    v_mfma_f32_16x16x32_bf16 v[216:219], a[144:147], v[144:147], v[216:219]
    ds_read_b64_tr_b16 a[140:141], v230 offset:12288
    v_mfma_f32_16x16x32_bf16 v[216:219], a[148:151], v[148:151], v[216:219]
    buffer_store_dwordx4 a[216:219], v233, s[16:19], s44 offen offset:1024 sc1
    v_mul_f32 v204, v245, v204
    v_mfma_f32_16x16x32_bf16 v[220:223], a[148:151], v[156:159], v[220:223]
    ds_read_b64_tr_b16 a[142:143], v230 offset:14336
    v_mul_f32 v205, v245, v205
    v_mfma_f32_16x16x32_bf16 v[220:223], a[144:147], v[152:155], v[220:223]
    v_mfma_f32_16x16x32_bf16 v[220:223], a[152:155], v[184:187], v[220:223]
    ds_read_b64_tr_b16 a[144:145], v230 offset:16384
    v_cvt_pk_bf16_f32 v204, v204, v205
    v_mfma_f32_16x16x32_bf16 v[220:223], a[156:159], v[188:191], v[220:223]
    ds_write_b32 v236, v204 offset:18432
    v_mfma_f32_16x16x32_bf16 v[216:219], a[156:159], v[180:183], v[216:219]
    ds_read_b64_tr_b16 a[146:147], v230 offset:18432
    v_mul_f32 v206, v245, v206
    v_mfma_f32_16x16x32_bf16 v[216:219], a[152:155], v[176:179], v[216:219]
    v_mfma_f32_16x16x32_bf16 v[212:215], a[152:155], v[168:171], v[212:215]
    ds_read_b64_tr_b16 a[148:149], v230 offset:20480
    v_mul_f32 v207, v245, v207
    v_mfma_f32_16x16x32_bf16 v[212:215], a[156:159], v[172:175], v[212:215]
    v_mfma_f32_16x16x32_bf16 v[208:211], a[156:159], v[164:167], v[208:211]
    ds_read_b64_tr_b16 a[150:151], v230 offset:22528
    v_cvt_pk_bf16_f32 v206, v206, v207
    v_mfma_f32_16x16x32_bf16 v[208:211], a[152:155], v[160:163], v[208:211]
    s_waitcnt lgkmcnt(5)
    ds_write_b32 v236, v206 offset:18436
    v_mfma_f32_16x16x32_bf16 v[192:195], a[128:131], v[0:3], 0
    s_add_u32 m0, s23, 0x1c000
    ds_read_b64_tr_b16 a[152:153], v230 offset:24576
    v_xor_b32 v236, 32, v236
    v_mfma_f32_16x16x32_bf16 v[192:195], a[132:135], v[4:7], v[192:195]
    v_mfma_f32_16x16x32_bf16 v[196:199], a[132:135], v[12:15], 0
    s_add_u32 s34, s43, 0x10000
    ds_read_b64_tr_b16 a[154:155], v230 offset:26624
    v_mul_f32 v216, v244, v216
    v_mfma_f32_16x16x32_bf16 v[196:199], a[128:131], v[8:11], v[196:199]
    v_mfma_f32_16x16x32_bf16 v[200:203], a[128:131], v[16:19], 0
    ds_read_b64_tr_b16 a[156:157], v230 offset:28672
    v_mul_f32 v217, v244, v217
    v_mfma_f32_16x16x32_bf16 v[200:203], a[132:135], v[20:23], v[200:203]
    buffer_load_dwordx4 v232, s[12:15], s34 offen nt lds
    v_mfma_f32_16x16x32_bf16 v[204:207], a[132:135], v[28:31], 0
    ds_read_b64_tr_b16 a[158:159], v230 offset:30720
    v_cvt_pk_bf16_f32 v216, v216, v217
    v_mfma_f32_16x16x32_bf16 v[204:207], a[128:131], v[24:27], v[204:207]
    ds_write_b32 v236, v216 offset:16384
    v_mfma_f32_16x16x32_bf16 v[204:207], a[136:139], v[56:59], v[204:207]
    ds_read_b64_tr_b16 a[128:129], v230 offset:32768
    v_mul_f32 v218, v244, v218
    v_mfma_f32_16x16x32_bf16 v[204:207], a[140:143], v[60:63], v[204:207]
    buffer_store_dwordx4 a[220:223], v234, s[16:19], s44 offen offset:2048 sc1
    v_mul_f32 v219, v244, v219
    v_mfma_f32_16x16x32_bf16 v[200:203], a[140:143], v[52:55], v[200:203]
    ds_read_b64_tr_b16 a[130:131], v230 offset:34816
    v_cvt_pk_bf16_f32 v218, v218, v219
    v_mfma_f32_16x16x32_bf16 v[200:203], a[136:139], v[48:51], v[200:203]
    ds_write_b32 v236, v218 offset:16388
    v_mfma_f32_16x16x32_bf16 v[196:199], a[136:139], v[40:43], v[196:199]
    ds_read_b64_tr_b16 a[132:133], v230 offset:36864
    v_mfma_f32_16x16x32_bf16 v[196:199], a[140:143], v[44:47], v[196:199]
    v_mfma_f32_16x16x32_bf16 v[192:195], a[140:143], v[36:39], v[192:195]
    ds_read_b64_tr_b16 a[134:135], v230 offset:38912
    v_mul_f32 v208, v242, v208
    v_mfma_f32_16x16x32_bf16 v[192:195], a[136:139], v[32:35], v[192:195]
    s_waitcnt lgkmcnt(6)
    v_mul_f32 v209, v242, v209
    v_mfma_f32_16x16x32_bf16 v[192:195], a[144:147], v[64:67], v[192:195]
    ds_read_b64_tr_b16 a[136:137], v230 offset:40960
    v_cvt_pk_bf16_f32 v208, v208, v209
    v_mfma_f32_16x16x32_bf16 v[192:195], a[148:151], v[68:71], v[192:195]
    ds_write_b32 v236, v208 offset:0
    v_mfma_f32_16x16x32_bf16 v[196:199], a[148:151], v[76:79], v[196:199]
    ds_read_b64_tr_b16 a[138:139], v230 offset:43008
    v_mul_f32 v210, v242, v210
    v_mfma_f32_16x16x32_bf16 v[196:199], a[144:147], v[72:75], v[196:199]
    buffer_load_dwordx4 v233, s[12:15], s34 offen offset:1024 nt lds
    v_mfma_f32_16x16x32_bf16 v[200:203], a[144:147], v[80:83], v[200:203]
    ds_read_b64_tr_b16 a[140:141], v230 offset:45056
    v_mul_f32 v211, v242, v211
    v_mfma_f32_16x16x32_bf16 v[200:203], a[148:151], v[84:87], v[200:203]
    v_mfma_f32_16x16x32_bf16 v[204:207], a[148:151], v[92:95], v[204:207]
    ds_read_b64_tr_b16 a[142:143], v230 offset:47104
    v_xor_b32 v230, 32, v230
    v_mfma_f32_16x16x32_bf16 v[204:207], a[144:147], v[88:91], v[204:207]
    v_xor_b32 v231, 32, v231
    v_cvt_pk_bf16_f32 v210, v210, v211
    v_mfma_f32_16x16x32_bf16 v[204:207], a[152:155], v[120:123], v[204:207]
    ds_read_b64_tr_b16 a[144:145], v230 offset:0
    v_mfma_f32_16x16x32_bf16 v[204:207], a[156:159], v[124:127], v[204:207]
    ds_write_b32 v236, v210 offset:4
    v_mfma_f32_16x16x32_bf16 v[200:203], a[156:159], v[116:119], v[200:203]
    ds_read_b64_tr_b16 a[146:147], v230 offset:2048
    v_mul_f32 v212, v243, v212
    v_mfma_f32_16x16x32_bf16 v[200:203], a[152:155], v[112:115], v[200:203]
    v_mfma_f32_16x16x32_bf16 v[196:199], a[152:155], v[104:107], v[196:199]
    ds_read_b64_tr_b16 a[148:149], v230 offset:4096
    v_mul_f32 v213, v243, v213
    v_mfma_f32_16x16x32_bf16 v[196:199], a[156:159], v[108:111], v[196:199]
    buffer_store_dwordx4 a[224:227], v235, s[16:19], s44 offen offset:3072 sc1
    v_cvt_pk_bf16_f32 v212, v212, v213
    v_mfma_f32_16x16x32_bf16 v[192:195], a[156:159], v[100:103], v[192:195]
    ds_read_b64_tr_b16 a[150:151], v230 offset:6144
    v_mfma_f32_16x16x32_bf16 v[192:195], a[152:155], v[96:99], v[192:195]
    s_waitcnt lgkmcnt(5)
    ds_write_b32 v236, v212 offset:2048
    v_mfma_f32_16x16x32_bf16 v[192:195], a[128:131], v[128:131], v[192:195]
    ds_read_b64_tr_b16 a[152:153], v230 offset:8192
    v_mul_f32 v214, v243, v214
    v_mfma_f32_16x16x32_bf16 v[192:195], a[132:135], v[132:135], v[192:195]
    buffer_load_dwordx4 v234, s[12:15], s34 offen offset:2048 nt lds
    v_mfma_f32_16x16x32_bf16 v[196:199], a[132:135], v[140:143], v[196:199]
    ds_read_b64_tr_b16 a[154:155], v230 offset:10240
    v_mul_f32 v215, v243, v215
    v_mfma_f32_16x16x32_bf16 v[196:199], a[128:131], v[136:139], v[196:199]
    v_mfma_f32_16x16x32_bf16 v[200:203], a[128:131], v[144:147], v[200:203]
    ds_read_b64_tr_b16 a[156:157], v230 offset:12288
    v_cvt_pk_bf16_f32 v214, v214, v215
    v_mfma_f32_16x16x32_bf16 v[200:203], a[132:135], v[148:151], v[200:203]
    ds_write_b32 v236, v214 offset:2052
    v_mfma_f32_16x16x32_bf16 v[204:207], a[132:135], v[156:159], v[204:207]
    ds_read_b64_tr_b16 a[158:159], v230 offset:14336
    v_mul_f32 v220, v245, v220
    v_mfma_f32_16x16x32_bf16 v[204:207], a[128:131], v[152:155], v[204:207]
    v_mfma_f32_16x16x32_bf16 v[204:207], a[136:139], v[184:187], v[204:207]
    ds_read_b64_tr_b16 a[128:129], v230 offset:16384
    v_mul_f32 v221, v245, v221
    v_mfma_f32_16x16x32_bf16 v[204:207], a[140:143], v[188:191], v[204:207]
    buffer_load_dwordx4 v235, s[12:15], s34 offen offset:3072 nt lds
    v_mfma_f32_16x16x32_bf16 v[200:203], a[140:143], v[180:183], v[200:203]
    s_add_u32 s35, s44, 0x4000
    ds_read_b64_tr_b16 a[130:131], v230 offset:18432
    v_cvt_pk_bf16_f32 v220, v220, v221
    v_mfma_f32_16x16x32_bf16 v[200:203], a[136:139], v[176:179], v[200:203]
    ds_write_b32 v236, v220 offset:18432
    v_mfma_f32_16x16x32_bf16 v[196:199], a[136:139], v[168:171], v[196:199]
    ds_read_b64_tr_b16 a[132:133], v230 offset:20480
    v_mul_f32 v222, v245, v222
    v_mfma_f32_16x16x32_bf16 v[196:199], a[140:143], v[172:175], v[196:199]
    v_mul_f32 v223, v245, v223
    v_cvt_pk_bf16_f32 v222, v222, v223
    v_mfma_f32_16x16x32_bf16 v[192:195], a[140:143], v[164:167], v[192:195]
    ds_read_b64_tr_b16 a[134:135], v230 offset:22528
    v_mfma_f32_16x16x32_bf16 v[192:195], a[136:139], v[160:163], v[192:195]
    s_waitcnt lgkmcnt(5)
    ds_write_b32 v236, v222 offset:18436
    v_mfma_f32_16x16x32_bf16 v[208:211], a[144:147], v[0:3], 0
    ds_read_b64_tr_b16 a[136:137], v230 offset:24576
    v_xor_b32 v236, 0x60, v236
    v_mfma_f32_16x16x32_bf16 v[208:211], a[148:151], v[4:7], v[208:211]
    v_mfma_f32_16x16x32_bf16 v[212:215], a[148:151], v[12:15], 0
    ds_read_b64_tr_b16 a[138:139], v230 offset:26624
    v_mul_f32 v200, v244, v200
    v_mfma_f32_16x16x32_bf16 v[212:215], a[144:147], v[8:11], v[212:215]
    v_mfma_f32_16x16x32_bf16 v[216:219], a[144:147], v[16:19], 0
    ds_read_b64_tr_b16 a[140:141], v230 offset:28672
    v_mul_f32 v201, v244, v201
    v_mfma_f32_16x16x32_bf16 v[216:219], a[148:151], v[20:23], v[216:219]
    buffer_store_dwordx4 a[228:231], v232, s[16:19], s35 offen sc1
    v_cvt_pk_bf16_f32 v200, v200, v201
    v_mfma_f32_16x16x32_bf16 v[220:223], a[148:151], v[28:31], 0
    ds_read_b64_tr_b16 a[142:143], v230 offset:30720
    v_mfma_f32_16x16x32_bf16 v[220:223], a[144:147], v[24:27], v[220:223]
    ds_write_b32 v236, v200 offset:16384
    v_mfma_f32_16x16x32_bf16 v[220:223], a[152:155], v[56:59], v[220:223]
    ds_read_b64_tr_b16 a[144:145], v230 offset:32768
    v_mul_f32 v202, v244, v202
    v_mfma_f32_16x16x32_bf16 v[220:223], a[156:159], v[60:63], v[220:223]
    v_mfma_f32_16x16x32_bf16 v[216:219], a[156:159], v[52:55], v[216:219]
    ds_read_b64_tr_b16 a[146:147], v230 offset:34816
    v_mul_f32 v203, v244, v203
    v_mfma_f32_16x16x32_bf16 v[216:219], a[152:155], v[48:51], v[216:219]
    v_mfma_f32_16x16x32_bf16 v[212:215], a[152:155], v[40:43], v[212:215]
    ds_read_b64_tr_b16 a[148:149], v230 offset:36864
    v_cvt_pk_bf16_f32 v202, v202, v203
    v_mfma_f32_16x16x32_bf16 v[212:215], a[156:159], v[44:47], v[212:215]
    ds_write_b32 v236, v202 offset:16388
    v_mfma_f32_16x16x32_bf16 v[208:211], a[156:159], v[36:39], v[208:211]
    ds_read_b64_tr_b16 a[150:151], v230 offset:38912
    v_mul_f32 v192, v242, v192
    v_mfma_f32_16x16x32_bf16 v[208:211], a[152:155], v[32:35], v[208:211]
    s_waitcnt lgkmcnt(6)
    v_mul_f32 v193, v242, v193
    v_mfma_f32_16x16x32_bf16 v[208:211], a[128:131], v[64:67], v[208:211]
    ds_read_b64_tr_b16 a[152:153], v230 offset:40960
    v_cvt_pk_bf16_f32 v192, v192, v193
    v_mfma_f32_16x16x32_bf16 v[208:211], a[132:135], v[68:71], v[208:211]
    ds_write_b32 v236, v192 offset:0
    v_mfma_f32_16x16x32_bf16 v[212:215], a[132:135], v[76:79], v[212:215]
    ds_read_b64_tr_b16 a[154:155], v230 offset:43008
    v_mul_f32 v194, v242, v194
    v_mfma_f32_16x16x32_bf16 v[212:215], a[128:131], v[72:75], v[212:215]
    v_mfma_f32_16x16x32_bf16 v[216:219], a[128:131], v[80:83], v[216:219]
    ds_read_b64_tr_b16 a[156:157], v230 offset:45056
    v_mul_f32 v195, v242, v195
    v_mfma_f32_16x16x32_bf16 v[216:219], a[132:135], v[84:87], v[216:219]
    v_mfma_f32_16x16x32_bf16 v[220:223], a[132:135], v[92:95], v[220:223]
    ds_read_b64_tr_b16 a[158:159], v230 offset:47104
    v_xor_b32 v230, 0x60, v230
    v_mfma_f32_16x16x32_bf16 v[220:223], a[128:131], v[88:91], v[220:223]
    v_xor_b32 v231, 0x60, v231
    v_cvt_pk_bf16_f32 v194, v194, v195
    v_mfma_f32_16x16x32_bf16 v[220:223], a[136:139], v[120:123], v[220:223]
    ds_write_b32 v236, v194 offset:4
    v_mfma_f32_16x16x32_bf16 v[220:223], a[140:143], v[124:127], v[220:223]
    buffer_store_dwordx4 a[232:235], v233, s[16:19], s35 offen offset:1024 sc1
    v_mul_f32 v196, v243, v196
    v_mul_f32 v197, v243, v197
    v_cvt_pk_bf16_f32 v196, v196, v197
    v_mfma_f32_16x16x32_bf16 v[216:219], a[140:143], v[116:119], v[216:219]
    v_mfma_f32_16x16x32_bf16 v[216:219], a[136:139], v[112:115], v[216:219]
    v_mfma_f32_16x16x32_bf16 v[212:215], a[136:139], v[104:107], v[212:215]
    v_mfma_f32_16x16x32_bf16 v[212:215], a[140:143], v[108:111], v[212:215]
    ds_write_b32 v236, v196 offset:2048
    v_mfma_f32_16x16x32_bf16 v[208:211], a[140:143], v[100:103], v[208:211]
    v_mfma_f32_16x16x32_bf16 v[208:211], a[136:139], v[96:99], v[208:211]
    s_waitcnt vmcnt(14) lgkmcnt(2)
    s_barrier
    v_mfma_f32_16x16x32_bf16 v[208:211], a[144:147], v[128:131], v[208:211]
    s_add_u32 m0, s23, 0
    ds_read_b64_tr_b16 a[128:129], v230 offset:49152
    v_mul_f32 v198, v243, v198
    v_mfma_f32_16x16x32_bf16 v[208:211], a[148:151], v[132:135], v[208:211]
    ds_read_b64_tr_b16 a[130:131], v230 offset:51200
    v_mul_f32 v199, v243, v199
    v_mfma_f32_16x16x32_bf16 v[212:215], a[148:151], v[140:143], v[212:215]
    s_add_u32 s34, s43, 0x20000
    ds_read_b64_tr_b16 a[132:133], v230 offset:53248
    v_cvt_pk_bf16_f32 v198, v198, v199
    v_mfma_f32_16x16x32_bf16 v[212:215], a[144:147], v[136:139], v[212:215]
    ds_read_b64_tr_b16 a[134:135], v230 offset:55296
    ds_write_b32 v236, v198 offset:2052
    v_mfma_f32_16x16x32_bf16 v[216:219], a[144:147], v[144:147], v[216:219]
    ds_read_b64_tr_b16 a[136:137], v230 offset:57344
    v_mfma_f32_16x16x32_bf16 v[216:219], a[148:151], v[148:151], v[216:219]
    ds_read_b64_tr_b16 a[138:139], v230 offset:59392
    v_mul_f32 v204, v245, v204
    v_mfma_f32_16x16x32_bf16 v[220:223], a[148:151], v[156:159], v[220:223]
    ds_read_b64_tr_b16 a[140:141], v230 offset:61440
    v_mul_f32 v205, v245, v205
    v_mfma_f32_16x16x32_bf16 v[220:223], a[144:147], v[152:155], v[220:223]
    ds_read_b64_tr_b16 a[142:143], v230 offset:63488
    v_mfma_f32_16x16x32_bf16 v[220:223], a[152:155], v[184:187], v[220:223]
    ds_read_b64_tr_b16 a[144:145], v231 offset:0
    v_cvt_pk_bf16_f32 v204, v204, v205
    v_mfma_f32_16x16x32_bf16 v[220:223], a[156:159], v[188:191], v[220:223]
    buffer_load_dwordx4 v232, s[12:15], s34 offen nt lds
    v_mfma_f32_16x16x32_bf16 v[216:219], a[156:159], v[180:183], v[216:219]
    ds_read_b64_tr_b16 a[146:147], v231 offset:2048
    v_mfma_f32_16x16x32_bf16 v[216:219], a[152:155], v[176:179], v[216:219]
    ds_write_b32 v236, v204 offset:18432
    v_mfma_f32_16x16x32_bf16 v[212:215], a[152:155], v[168:171], v[212:215]
    ds_read_b64_tr_b16 a[148:149], v231 offset:4096
    v_mul_f32 v206, v245, v206
    v_mfma_f32_16x16x32_bf16 v[212:215], a[156:159], v[172:175], v[212:215]
    buffer_store_dwordx4 a[236:239], v234, s[16:19], s35 offen offset:2048 sc1
    v_mul_f32 v207, v245, v207
    v_cvt_pk_bf16_f32 v206, v206, v207
    v_mfma_f32_16x16x32_bf16 v[208:211], a[156:159], v[164:167], v[208:211]
    ds_read_b64_tr_b16 a[150:151], v231 offset:6144
    v_mfma_f32_16x16x32_bf16 v[208:211], a[152:155], v[160:163], v[208:211]
    s_waitcnt lgkmcnt(5)
    ds_write_b32 v236, v206 offset:18436
    v_mfma_f32_16x16x32_bf16 v[192:195], a[128:131], v[0:3], 0
    ds_read_b64_tr_b16 a[152:153], v231 offset:8192
    v_xor_b32 v236, 32, v236
    v_mfma_f32_16x16x32_bf16 v[192:195], a[132:135], v[4:7], v[192:195]
    v_mfma_f32_16x16x32_bf16 v[196:199], a[132:135], v[12:15], 0
    ds_read_b64_tr_b16 a[154:155], v231 offset:10240
    v_mul_f32 v216, v244, v216
    v_mfma_f32_16x16x32_bf16 v[196:199], a[128:131], v[8:11], v[196:199]
    buffer_load_dwordx4 v233, s[12:15], s34 offen offset:1024 nt lds
    v_mfma_f32_16x16x32_bf16 v[200:203], a[128:131], v[16:19], 0
    ds_read_b64_tr_b16 a[156:157], v231 offset:12288
    v_mul_f32 v217, v244, v217
    v_mfma_f32_16x16x32_bf16 v[200:203], a[132:135], v[20:23], v[200:203]
    v_mul_f32 v218, v244, v218
    v_mul_f32 v219, v244, v219
    v_mfma_f32_16x16x32_bf16 v[204:207], a[132:135], v[28:31], 0
    ds_read_b64_tr_b16 a[158:159], v231 offset:14336
    v_cvt_pk_bf16_f32 v216, v216, v217
    v_mfma_f32_16x16x32_bf16 v[204:207], a[128:131], v[24:27], v[204:207]
    v_mfma_f32_16x16x32_bf16 v[204:207], a[136:139], v[56:59], v[204:207]
    ds_read_b64_tr_b16 a[128:129], v231 offset:16384
    v_cvt_pk_bf16_f32 v217, v218, v219
    v_mfma_f32_16x16x32_bf16 v[204:207], a[140:143], v[60:63], v[204:207]
    ds_write_b64 v236, v[216:217] offset:16384
    v_mfma_f32_16x16x32_bf16 v[200:203], a[140:143], v[52:55], v[200:203]
    ds_read_b64_tr_b16 a[130:131], v231 offset:18432
    v_mul_f32 v208, v242, v208
    v_mfma_f32_16x16x32_bf16 v[200:203], a[136:139], v[48:51], v[200:203]
    v_mfma_f32_16x16x32_bf16 v[196:199], a[136:139], v[40:43], v[196:199]
    ds_read_b64_tr_b16 a[132:133], v231 offset:20480
    v_mul_f32 v209, v242, v209
    v_mfma_f32_16x16x32_bf16 v[196:199], a[140:143], v[44:47], v[196:199]
    buffer_load_dwordx4 v234, s[12:15], s34 offen offset:2048 nt lds
    v_mfma_f32_16x16x32_bf16 v[192:195], a[140:143], v[36:39], v[192:195]
    ds_read_b64_tr_b16 a[134:135], v231 offset:22528
    v_mul_f32 v210, v242, v210
    v_mfma_f32_16x16x32_bf16 v[192:195], a[136:139], v[32:35], v[192:195]
    s_waitcnt lgkmcnt(5)
    v_mul_f32 v211, v242, v211
    v_mfma_f32_16x16x32_bf16 v[192:195], a[144:147], v[64:67], v[192:195]
    ds_read_b64_tr_b16 a[136:137], v231 offset:24576
    v_cvt_pk_bf16_f32 v208, v208, v209
    v_mfma_f32_16x16x32_bf16 v[192:195], a[148:151], v[68:71], v[192:195]
    buffer_store_dwordx4 a[240:243], v235, s[16:19], s35 offen offset:3072 sc1
    v_cvt_pk_bf16_f32 v209, v210, v211
    v_mfma_f32_16x16x32_bf16 v[196:199], a[148:151], v[76:79], v[196:199]
    ds_read_b64_tr_b16 a[138:139], v231 offset:26624
    v_mfma_f32_16x16x32_bf16 v[196:199], a[144:147], v[72:75], v[196:199]
    ds_write_b64 v236, v[208:209] offset:0
    v_mfma_f32_16x16x32_bf16 v[200:203], a[144:147], v[80:83], v[200:203]
    ds_read_b64_tr_b16 a[140:141], v231 offset:28672
    v_mul_f32 v212, v243, v212
    v_mfma_f32_16x16x32_bf16 v[200:203], a[148:151], v[84:87], v[200:203]
    v_mul_f32 v213, v243, v213
    v_mul_f32 v214, v243, v214
    v_mfma_f32_16x16x32_bf16 v[204:207], a[148:151], v[92:95], v[204:207]
    ds_read_b64_tr_b16 a[142:143], v231 offset:30720
    v_xor_b32 v230, 32, v230
    v_mfma_f32_16x16x32_bf16 v[204:207], a[144:147], v[88:91], v[204:207]
    v_xor_b32 v231, 32, v231
    v_mul_f32 v215, v243, v215
    v_mfma_f32_16x16x32_bf16 v[204:207], a[152:155], v[120:123], v[204:207]
    ds_read_b64_tr_b16 a[144:145], v230 offset:49152
    v_cvt_pk_bf16_f32 v212, v212, v213
    v_mfma_f32_16x16x32_bf16 v[204:207], a[156:159], v[124:127], v[204:207]
    buffer_load_dwordx4 v235, s[12:15], s34 offen offset:3072 nt lds
    v_mfma_f32_16x16x32_bf16 v[200:203], a[156:159], v[116:119], v[200:203]
    ds_read_b64_tr_b16 a[146:147], v230 offset:51200
    v_cvt_pk_bf16_f32 v213, v214, v215
    v_mfma_f32_16x16x32_bf16 v[200:203], a[152:155], v[112:115], v[200:203]
    ds_write_b64 v236, v[212:213] offset:2048
    v_mfma_f32_16x16x32_bf16 v[196:199], a[152:155], v[104:107], v[196:199]
    ds_read_b64_tr_b16 a[148:149], v230 offset:53248
    v_mfma_f32_16x16x32_bf16 v[196:199], a[156:159], v[108:111], v[196:199]
    v_mul_f32 v220, v245, v220
    v_mul_f32 v221, v245, v221
    v_mfma_f32_16x16x32_bf16 v[192:195], a[156:159], v[100:103], v[192:195]
    ds_read_b64_tr_b16 a[150:151], v230 offset:55296
    v_mul_f32 v222, v245, v222
    v_mfma_f32_16x16x32_bf16 v[192:195], a[152:155], v[96:99], v[192:195]
    s_waitcnt lgkmcnt(5)
    v_mul_f32 v223, v245, v223
    v_cvt_pk_bf16_f32 v220, v220, v221
    v_mfma_f32_16x16x32_bf16 v[192:195], a[128:131], v[128:131], v[192:195]
    ds_read_b64_tr_b16 a[152:153], v230 offset:57344
    v_cvt_pk_bf16_f32 v221, v222, v223
    v_mfma_f32_16x16x32_bf16 v[192:195], a[132:135], v[132:135], v[192:195]
    ds_write_b64 v236, v[220:221] offset:18432
    v_mfma_f32_16x16x32_bf16 v[196:199], a[132:135], v[140:143], v[196:199]
    ds_read_b64_tr_b16 a[154:155], v230 offset:59392
    v_mfma_f32_16x16x32_bf16 v[196:199], a[128:131], v[136:139], v[196:199]
    ds_read_b128 a[160:163], v237 offset:0
    v_mfma_f32_16x16x32_bf16 v[200:203], a[128:131], v[144:147], v[200:203]
    ds_read_b64_tr_b16 a[156:157], v230 offset:61440
    v_mfma_f32_16x16x32_bf16 v[200:203], a[132:135], v[148:151], v[200:203]
    ds_read_b128 a[164:167], v237 offset:1024
    v_mfma_f32_16x16x32_bf16 v[204:207], a[132:135], v[156:159], v[204:207]
    ds_read_b64_tr_b16 a[158:159], v230 offset:63488
    v_mfma_f32_16x16x32_bf16 v[204:207], a[128:131], v[152:155], v[204:207]
    ds_read_b128 a[168:171], v237 offset:2048
    v_mfma_f32_16x16x32_bf16 v[204:207], a[136:139], v[184:187], v[204:207]
    ds_read_b64_tr_b16 a[128:129], v231 offset:0
    v_mfma_f32_16x16x32_bf16 v[204:207], a[140:143], v[188:191], v[204:207]
    ds_read_b128 a[172:175], v237 offset:3072
    v_mfma_f32_16x16x32_bf16 v[200:203], a[140:143], v[180:183], v[200:203]
    ds_read_b64_tr_b16 a[130:131], v231 offset:2048
    v_mfma_f32_16x16x32_bf16 v[200:203], a[136:139], v[176:179], v[200:203]
    ds_read_b128 a[176:179], v237 offset:16384
    v_mfma_f32_16x16x32_bf16 v[196:199], a[136:139], v[168:171], v[196:199]
    ds_read_b64_tr_b16 a[132:133], v231 offset:4096
    v_mfma_f32_16x16x32_bf16 v[196:199], a[140:143], v[172:175], v[196:199]
    ds_read_b128 a[180:183], v237 offset:17408
    ds_read_b128 a[184:187], v237 offset:18432
    v_mfma_f32_16x16x32_bf16 v[192:195], a[140:143], v[164:167], v[192:195]
    ds_read_b64_tr_b16 a[134:135], v231 offset:6144
    v_mfma_f32_16x16x32_bf16 v[192:195], a[136:139], v[160:163], v[192:195]
    s_waitcnt lgkmcnt(9)
    ds_read_b128 a[188:191], v237 offset:19456
    v_mfma_f32_16x16x32_bf16 v[208:211], a[144:147], v[0:3], 0
    ds_read_b64_tr_b16 a[136:137], v231 offset:8192
    v_xor_b32 v236, 0x60, v236
    v_mfma_f32_16x16x32_bf16 v[208:211], a[148:151], v[4:7], v[208:211]
    v_mfma_f32_16x16x32_bf16 v[212:215], a[148:151], v[12:15], 0
    ds_read_b64_tr_b16 a[138:139], v231 offset:10240
    v_mul_f32 v200, v244, v200
    v_mfma_f32_16x16x32_bf16 v[212:215], a[144:147], v[8:11], v[212:215]
    v_mfma_f32_16x16x32_bf16 v[216:219], a[144:147], v[16:19], 0
    ds_read_b64_tr_b16 a[140:141], v231 offset:12288
    v_mul_f32 v201, v244, v201
    v_mfma_f32_16x16x32_bf16 v[216:219], a[148:151], v[20:23], v[216:219]
    v_mfma_f32_16x16x32_bf16 v[220:223], a[148:151], v[28:31], 0
    ds_read_b64_tr_b16 a[142:143], v231 offset:14336
    v_cvt_pk_bf16_f32 v200, v200, v201
    v_mfma_f32_16x16x32_bf16 v[220:223], a[144:147], v[24:27], v[220:223]
    ds_write_b32 v236, v200 offset:16384
    v_mfma_f32_16x16x32_bf16 v[220:223], a[152:155], v[56:59], v[220:223]
    ds_read_b64_tr_b16 a[144:145], v231 offset:16384
    v_mul_f32 v202, v244, v202
    v_mfma_f32_16x16x32_bf16 v[220:223], a[156:159], v[60:63], v[220:223]
    v_mfma_f32_16x16x32_bf16 v[216:219], a[156:159], v[52:55], v[216:219]
    ds_read_b64_tr_b16 a[146:147], v231 offset:18432
    v_mul_f32 v203, v244, v203
    v_mfma_f32_16x16x32_bf16 v[216:219], a[152:155], v[48:51], v[216:219]
    v_mfma_f32_16x16x32_bf16 v[212:215], a[152:155], v[40:43], v[212:215]
    ds_read_b64_tr_b16 a[148:149], v231 offset:20480
    v_cvt_pk_bf16_f32 v202, v202, v203
    v_mfma_f32_16x16x32_bf16 v[212:215], a[156:159], v[44:47], v[212:215]
    ds_write_b32 v236, v202 offset:16388
    v_mfma_f32_16x16x32_bf16 v[208:211], a[156:159], v[36:39], v[208:211]
    ds_read_b64_tr_b16 a[150:151], v231 offset:22528
    v_mul_f32 v192, v242, v192
    v_mfma_f32_16x16x32_bf16 v[208:211], a[152:155], v[32:35], v[208:211]
    s_waitcnt lgkmcnt(6)
    v_mul_f32 v193, v242, v193
    v_mfma_f32_16x16x32_bf16 v[208:211], a[128:131], v[64:67], v[208:211]
    ds_read_b64_tr_b16 a[152:153], v231 offset:24576
    v_cvt_pk_bf16_f32 v192, v192, v193
    v_mfma_f32_16x16x32_bf16 v[208:211], a[132:135], v[68:71], v[208:211]
    buffer_store_dwordx4 a[160:163], v232, s[16:19], s45 offen sc1
    v_mfma_f32_16x16x32_bf16 v[212:215], a[132:135], v[76:79], v[212:215]
L_hop13:
    s_cbranch_execz L_hopret3
    ds_read_b64_tr_b16 a[154:155], v231 offset:26624
    v_mfma_f32_16x16x32_bf16 v[212:215], a[128:131], v[72:75], v[212:215]
    ds_write_b32 v236, v192 offset:0
    v_mfma_f32_16x16x32_bf16 v[216:219], a[128:131], v[80:83], v[216:219]
    ds_read_b64_tr_b16 a[156:157], v231 offset:28672
    v_mul_f32 v194, v242, v194
    v_mfma_f32_16x16x32_bf16 v[216:219], a[132:135], v[84:87], v[216:219]
    v_mfma_f32_16x16x32_bf16 v[220:223], a[132:135], v[92:95], v[220:223]
    ds_read_b64_tr_b16 a[158:159], v231 offset:30720
    v_xor_b32 v230, 0x60, v230
    v_mfma_f32_16x16x32_bf16 v[220:223], a[128:131], v[88:91], v[220:223]
    v_xor_b32 v231, 0x60, v231
    v_mul_f32 v195, v242, v195
    v_mfma_f32_16x16x32_bf16 v[220:223], a[136:139], v[120:123], v[220:223]
    ds_read_b64_tr_b16 a[128:129], v230 offset:49152
    v_cvt_pk_bf16_f32 v194, v194, v195
    v_mfma_f32_16x16x32_bf16 v[220:223], a[140:143], v[124:127], v[220:223]
    ds_write_b32 v236, v194 offset:4
    v_mfma_f32_16x16x32_bf16 v[216:219], a[140:143], v[116:119], v[216:219]
    ds_read_b64_tr_b16 a[130:131], v230 offset:51200
    v_mul_f32 v196, v243, v196
    v_mfma_f32_16x16x32_bf16 v[216:219], a[136:139], v[112:115], v[216:219]
    v_mul_f32 v197, v243, v197
    v_mfma_f32_16x16x32_bf16 v[212:215], a[136:139], v[104:107], v[212:215]
    ds_read_b64_tr_b16 a[132:133], v230 offset:53248
    v_cvt_pk_bf16_f32 v196, v196, v197
    v_mfma_f32_16x16x32_bf16 v[212:215], a[140:143], v[108:111], v[212:215]
    ds_write_b32 v236, v196 offset:2048
    v_mfma_f32_16x16x32_bf16 v[208:211], a[140:143], v[100:103], v[208:211]
    ds_read_b64_tr_b16 a[134:135], v230 offset:55296
    v_mfma_f32_16x16x32_bf16 v[208:211], a[136:139], v[96:99], v[208:211]
    s_waitcnt lgkmcnt(6)
    v_mul_f32 v198, v243, v198
    v_mfma_f32_16x16x32_bf16 v[208:211], a[144:147], v[128:131], v[208:211]
    ds_read_b64_tr_b16 a[136:137], v230 offset:57344
    v_mul_f32 v199, v243, v199
    v_mfma_f32_16x16x32_bf16 v[208:211], a[148:151], v[132:135], v[208:211]
    v_mfma_f32_16x16x32_bf16 v[212:215], a[148:151], v[140:143], v[212:215]
    ds_read_b64_tr_b16 a[138:139], v230 offset:59392
    v_cvt_pk_bf16_f32 v198, v198, v199
    v_mfma_f32_16x16x32_bf16 v[212:215], a[144:147], v[136:139], v[212:215]
    ds_write_b32 v236, v198 offset:2052
    v_mfma_f32_16x16x32_bf16 v[216:219], a[144:147], v[144:147], v[216:219]
    ds_read_b64_tr_b16 a[140:141], v230 offset:61440
    v_mfma_f32_16x16x32_bf16 v[216:219], a[148:151], v[148:151], v[216:219]
    buffer_store_dwordx4 a[164:167], v233, s[16:19], s45 offen offset:1024 sc1
    v_mul_f32 v204, v245, v204
    v_mfma_f32_16x16x32_bf16 v[220:223], a[148:151], v[156:159], v[220:223]
    ds_read_b64_tr_b16 a[142:143], v230 offset:63488
    v_mul_f32 v205, v245, v205
    v_mfma_f32_16x16x32_bf16 v[220:223], a[144:147], v[152:155], v[220:223]
    v_mfma_f32_16x16x32_bf16 v[220:223], a[152:155], v[184:187], v[220:223]
    ds_read_b64_tr_b16 a[144:145], v231 offset:0
    v_cvt_pk_bf16_f32 v204, v204, v205
    v_mfma_f32_16x16x32_bf16 v[220:223], a[156:159], v[188:191], v[220:223]
    ds_write_b32 v236, v204 offset:18432
    v_mfma_f32_16x16x32_bf16 v[216:219], a[156:159], v[180:183], v[216:219]
    ds_read_b64_tr_b16 a[146:147], v231 offset:2048
    v_mul_f32 v206, v245, v206
    v_mfma_f32_16x16x32_bf16 v[216:219], a[152:155], v[176:179], v[216:219]
    v_mfma_f32_16x16x32_bf16 v[212:215], a[152:155], v[168:171], v[212:215]
    ds_read_b64_tr_b16 a[148:149], v231 offset:4096
    v_mul_f32 v207, v245, v207
    v_mfma_f32_16x16x32_bf16 v[212:215], a[156:159], v[172:175], v[212:215]
    v_mfma_f32_16x16x32_bf16 v[208:211], a[156:159], v[164:167], v[208:211]
    ds_read_b64_tr_b16 a[150:151], v231 offset:6144
    v_cvt_pk_bf16_f32 v206, v206, v207
    v_mfma_f32_16x16x32_bf16 v[208:211], a[152:155], v[160:163], v[208:211]
    s_waitcnt lgkmcnt(5)
    ds_write_b32 v236, v206 offset:18436
    v_mfma_f32_16x16x32_bf16 v[192:195], a[128:131], v[0:3], 0
    ds_read_b64_tr_b16 a[152:153], v231 offset:8192
    v_xor_b32 v236, 32, v236
    v_mfma_f32_16x16x32_bf16 v[192:195], a[132:135], v[4:7], v[192:195]
    v_mfma_f32_16x16x32_bf16 v[196:199], a[132:135], v[12:15], 0
    ds_read_b64_tr_b16 a[154:155], v231 offset:10240
    v_mul_f32 v216, v244, v216
    v_mfma_f32_16x16x32_bf16 v[196:199], a[128:131], v[8:11], v[196:199]
    v_mfma_f32_16x16x32_bf16 v[200:203], a[128:131], v[16:19], 0
    ds_read_b64_tr_b16 a[156:157], v231 offset:12288
    v_mul_f32 v217, v244, v217
    v_mfma_f32_16x16x32_bf16 v[200:203], a[132:135], v[20:23], v[200:203]
    v_mfma_f32_16x16x32_bf16 v[204:207], a[132:135], v[28:31], 0
    ds_read_b64_tr_b16 a[158:159], v231 offset:14336
    v_cvt_pk_bf16_f32 v216, v216, v217
    v_mfma_f32_16x16x32_bf16 v[204:207], a[128:131], v[24:27], v[204:207]
    ds_write_b32 v236, v216 offset:16384
    v_mfma_f32_16x16x32_bf16 v[204:207], a[136:139], v[56:59], v[204:207]
    ds_read_b64_tr_b16 a[128:129], v231 offset:16384
    v_mul_f32 v218, v244, v218
    v_mfma_f32_16x16x32_bf16 v[204:207], a[140:143], v[60:63], v[204:207]
    v_mfma_f32_16x16x32_bf16 v[200:203], a[140:143], v[52:55], v[200:203]
    ds_read_b64_tr_b16 a[130:131], v231 offset:18432
    v_mul_f32 v219, v244, v219
    v_mfma_f32_16x16x32_bf16 v[200:203], a[136:139], v[48:51], v[200:203]
    buffer_store_dwordx4 a[168:171], v234, s[16:19], s45 offen offset:2048 sc1
    v_cvt_pk_bf16_f32 v218, v218, v219
    v_mfma_f32_16x16x32_bf16 v[196:199], a[136:139], v[40:43], v[196:199]
    ds_read_b64_tr_b16 a[132:133], v231 offset:20480
    v_mfma_f32_16x16x32_bf16 v[196:199], a[140:143], v[44:47], v[196:199]
    ds_write_b32 v236, v218 offset:16388
    v_mfma_f32_16x16x32_bf16 v[192:195], a[140:143], v[36:39], v[192:195]
    ds_read_b64_tr_b16 a[134:135], v231 offset:22528
    v_mul_f32 v208, v242, v208
    v_mfma_f32_16x16x32_bf16 v[192:195], a[136:139], v[32:35], v[192:195]
    s_waitcnt lgkmcnt(6)
    v_mul_f32 v209, v242, v209
    v_mfma_f32_16x16x32_bf16 v[192:195], a[144:147], v[64:67], v[192:195]
    ds_read_b64_tr_b16 a[136:137], v231 offset:24576
    v_cvt_pk_bf16_f32 v208, v208, v209
    v_mfma_f32_16x16x32_bf16 v[192:195], a[148:151], v[68:71], v[192:195]
    ds_write_b32 v236, v208 offset:0
    v_mfma_f32_16x16x32_bf16 v[196:199], a[148:151], v[76:79], v[196:199]
    ds_read_b64_tr_b16 a[138:139], v231 offset:26624
    v_mul_f32 v210, v242, v210
    v_mfma_f32_16x16x32_bf16 v[196:199], a[144:147], v[72:75], v[196:199]
    v_mfma_f32_16x16x32_bf16 v[200:203], a[144:147], v[80:83], v[200:203]
    ds_read_b64_tr_b16 a[140:141], v231 offset:28672
    v_mul_f32 v211, v242, v211
    v_mfma_f32_16x16x32_bf16 v[200:203], a[148:151], v[84:87], v[200:203]
    v_mfma_f32_16x16x32_bf16 v[204:207], a[148:151], v[92:95], v[204:207]
    ds_read_b64_tr_b16 a[142:143], v231 offset:30720
    v_xor_b32 v230, 32, v230
    v_mfma_f32_16x16x32_bf16 v[204:207], a[144:147], v[88:91], v[204:207]
    v_xor_b32 v231, 32, v231
    v_cvt_pk_bf16_f32 v210, v210, v211
    v_mfma_f32_16x16x32_bf16 v[204:207], a[152:155], v[120:123], v[204:207]
    ds_read_b64_tr_b16 a[144:145], v230 offset:49152
    v_mfma_f32_16x16x32_bf16 v[204:207], a[156:159], v[124:127], v[204:207]
    ds_write_b32 v236, v210 offset:4
    v_mfma_f32_16x16x32_bf16 v[200:203], a[156:159], v[116:119], v[200:203]
    ds_read_b64_tr_b16 a[146:147], v230 offset:51200
    v_mul_f32 v212, v243, v212
    v_mfma_f32_16x16x32_bf16 v[200:203], a[152:155], v[112:115], v[200:203]
    v_mfma_f32_16x16x32_bf16 v[196:199], a[152:155], v[104:107], v[196:199]
    ds_read_b64_tr_b16 a[148:149], v230 offset:53248
    v_mul_f32 v213, v243, v213
    v_mfma_f32_16x16x32_bf16 v[196:199], a[156:159], v[108:111], v[196:199]
    v_mfma_f32_16x16x32_bf16 v[192:195], a[156:159], v[100:103], v[192:195]
    ds_read_b64_tr_b16 a[150:151], v230 offset:55296
    v_cvt_pk_bf16_f32 v212, v212, v213
    v_mfma_f32_16x16x32_bf16 v[192:195], a[152:155], v[96:99], v[192:195]
    s_waitcnt lgkmcnt(5)
    ds_write_b32 v236, v212 offset:2048
    v_mfma_f32_16x16x32_bf16 v[192:195], a[128:131], v[128:131], v[192:195]
    ds_read_b64_tr_b16 a[152:153], v230 offset:57344
    v_mul_f32 v214, v243, v214
    v_mfma_f32_16x16x32_bf16 v[192:195], a[132:135], v[132:135], v[192:195]
    buffer_store_dwordx4 a[172:175], v235, s[16:19], s45 offen offset:3072 sc1
    v_mul_f32 v215, v243, v215
    v_mfma_f32_16x16x32_bf16 v[196:199], a[132:135], v[140:143], v[196:199]
    ds_read_b64_tr_b16 a[154:155], v230 offset:59392
    v_cvt_pk_bf16_f32 v214, v214, v215
    v_mfma_f32_16x16x32_bf16 v[196:199], a[128:131], v[136:139], v[196:199]
    ds_write_b32 v236, v214 offset:2052
    v_mfma_f32_16x16x32_bf16 v[200:203], a[128:131], v[144:147], v[200:203]
    ds_read_b64_tr_b16 a[156:157], v230 offset:61440
    v_mul_f32 v220, v245, v220
    v_mfma_f32_16x16x32_bf16 v[200:203], a[132:135], v[148:151], v[200:203]
    v_mfma_f32_16x16x32_bf16 v[204:207], a[132:135], v[156:159], v[204:207]
    ds_read_b64_tr_b16 a[158:159], v230 offset:63488
    v_mul_f32 v221, v245, v221
    v_mfma_f32_16x16x32_bf16 v[204:207], a[128:131], v[152:155], v[204:207]
    v_mfma_f32_16x16x32_bf16 v[204:207], a[136:139], v[184:187], v[204:207]
    ds_read_b64_tr_b16 a[128:129], v231 offset:0
    v_cvt_pk_bf16_f32 v220, v220, v221
    v_mfma_f32_16x16x32_bf16 v[204:207], a[140:143], v[188:191], v[204:207]
    ds_write_b32 v236, v220 offset:18432
    v_mfma_f32_16x16x32_bf16 v[200:203], a[140:143], v[180:183], v[200:203]
    ds_read_b64_tr_b16 a[130:131], v231 offset:2048
    v_mul_f32 v222, v245, v222
    v_mfma_f32_16x16x32_bf16 v[200:203], a[136:139], v[176:179], v[200:203]
    v_mfma_f32_16x16x32_bf16 v[196:199], a[136:139], v[168:171], v[196:199]
    s_add_u32 s35, s45, 0x4000
    ds_read_b64_tr_b16 a[132:133], v231 offset:4096
    v_mul_f32 v223, v245, v223
    v_mfma_f32_16x16x32_bf16 v[196:199], a[140:143], v[172:175], v[196:199]
    v_mfma_f32_16x16x32_bf16 v[192:195], a[140:143], v[164:167], v[192:195]
    ds_read_b64_tr_b16 a[134:135], v231 offset:6144
    v_cvt_pk_bf16_f32 v222, v222, v223
    v_mfma_f32_16x16x32_bf16 v[192:195], a[136:139], v[160:163], v[192:195]
    s_waitcnt lgkmcnt(5)
    ds_write_b32 v236, v222 offset:18436
    v_mfma_f32_16x16x32_bf16 v[208:211], a[144:147], v[0:3], 0
    ds_read_b64_tr_b16 a[136:137], v231 offset:8192
    v_xor_b32 v236, 0x60, v236
    v_mfma_f32_16x16x32_bf16 v[208:211], a[148:151], v[4:7], v[208:211]
    v_mfma_f32_16x16x32_bf16 v[212:215], a[148:151], v[12:15], 0
    ds_read_b64_tr_b16 a[138:139], v231 offset:10240
    v_mul_f32 v200, v244, v200
    v_mfma_f32_16x16x32_bf16 v[212:215], a[144:147], v[8:11], v[212:215]
    v_mfma_f32_16x16x32_bf16 v[216:219], a[144:147], v[16:19], 0
    ds_read_b64_tr_b16 a[140:141], v231 offset:12288
    v_mul_f32 v201, v244, v201
    v_mfma_f32_16x16x32_bf16 v[216:219], a[148:151], v[20:23], v[216:219]
    v_mfma_f32_16x16x32_bf16 v[220:223], a[148:151], v[28:31], 0
    ds_read_b64_tr_b16 a[142:143], v231 offset:14336
    v_cvt_pk_bf16_f32 v200, v200, v201
    v_mfma_f32_16x16x32_bf16 v[220:223], a[144:147], v[24:27], v[220:223]
    ds_write_b32 v236, v200 offset:16384
    v_mfma_f32_16x16x32_bf16 v[220:223], a[152:155], v[56:59], v[220:223]
    ds_read_b64_tr_b16 a[144:145], v231 offset:16384
    v_mul_f32 v202, v244, v202
    v_mfma_f32_16x16x32_bf16 v[220:223], a[156:159], v[60:63], v[220:223]
    buffer_store_dwordx4 a[176:179], v232, s[16:19], s35 offen sc1
    v_mul_f32 v203, v244, v203
    v_mfma_f32_16x16x32_bf16 v[216:219], a[156:159], v[52:55], v[216:219]
    ds_read_b64_tr_b16 a[146:147], v231 offset:18432
    v_cvt_pk_bf16_f32 v202, v202, v203
    v_mfma_f32_16x16x32_bf16 v[216:219], a[152:155], v[48:51], v[216:219]
    ds_write_b32 v236, v202 offset:16388
    v_mfma_f32_16x16x32_bf16 v[212:215], a[152:155], v[40:43], v[212:215]
    ds_read_b64_tr_b16 a[148:149], v231 offset:20480
    v_mfma_f32_16x16x32_bf16 v[212:215], a[156:159], v[44:47], v[212:215]
    v_mfma_f32_16x16x32_bf16 v[208:211], a[156:159], v[36:39], v[208:211]
    ds_read_b64_tr_b16 a[150:151], v231 offset:22528
    v_mul_f32 v192, v242, v192
    v_mfma_f32_16x16x32_bf16 v[208:211], a[152:155], v[32:35], v[208:211]
    s_waitcnt lgkmcnt(6)
    v_mul_f32 v193, v242, v193
    v_mfma_f32_16x16x32_bf16 v[208:211], a[128:131], v[64:67], v[208:211]
    ds_read_b64_tr_b16 a[152:153], v231 offset:24576
    v_cvt_pk_bf16_f32 v192, v192, v193
    v_mfma_f32_16x16x32_bf16 v[208:211], a[132:135], v[68:71], v[208:211]
    ds_write_b32 v236, v192 offset:0
    v_mfma_f32_16x16x32_bf16 v[212:215], a[132:135], v[76:79], v[212:215]
    ds_read_b64_tr_b16 a[154:155], v231 offset:26624
    v_mul_f32 v194, v242, v194
    v_mfma_f32_16x16x32_bf16 v[212:215], a[128:131], v[72:75], v[212:215]
    v_mfma_f32_16x16x32_bf16 v[216:219], a[128:131], v[80:83], v[216:219]
    ds_read_b64_tr_b16 a[156:157], v231 offset:28672
    v_mul_f32 v195, v242, v195
    v_mfma_f32_16x16x32_bf16 v[216:219], a[132:135], v[84:87], v[216:219]
    v_mfma_f32_16x16x32_bf16 v[220:223], a[132:135], v[92:95], v[220:223]
    ds_read_b64_tr_b16 a[158:159], v231 offset:30720
    v_xor_b32 v230, 0x60, v230
    v_mfma_f32_16x16x32_bf16 v[220:223], a[128:131], v[88:91], v[220:223]
    v_xor_b32 v231, 0x60, v231
    v_cvt_pk_bf16_f32 v194, v194, v195
    v_mfma_f32_16x16x32_bf16 v[220:223], a[136:139], v[120:123], v[220:223]
    ds_write_b32 v236, v194 offset:4
    v_mfma_f32_16x16x32_bf16 v[220:223], a[140:143], v[124:127], v[220:223]
    v_mfma_f32_16x16x32_bf16 v[216:219], a[140:143], v[116:119], v[216:219]
    v_mfma_f32_16x16x32_bf16 v[216:219], a[136:139], v[112:115], v[216:219]
    buffer_store_dwordx4 a[180:183], v233, s[16:19], s35 offen offset:1024 sc1
    v_mul_f32 v196, v243, v196
    v_mul_f32 v197, v243, v197
    v_cvt_pk_bf16_f32 v196, v196, v197
    v_mfma_f32_16x16x32_bf16 v[212:215], a[136:139], v[104:107], v[212:215]
    v_mfma_f32_16x16x32_bf16 v[212:215], a[140:143], v[108:111], v[212:215]
    ds_write_b32 v236, v196 offset:2048
    v_mfma_f32_16x16x32_bf16 v[208:211], a[140:143], v[100:103], v[208:211]
    v_mfma_f32_16x16x32_bf16 v[208:211], a[136:139], v[96:99], v[208:211]
    s_waitcnt vmcnt(6) lgkmcnt(2)
    s_barrier
    v_mfma_f32_16x16x32_bf16 v[208:211], a[144:147], v[128:131], v[208:211]
    ds_read_b64_tr_b16 a[128:129], v231 offset:32768
    v_mul_f32 v198, v243, v198
    v_mfma_f32_16x16x32_bf16 v[208:211], a[148:151], v[132:135], v[208:211]
    ds_read_b64_tr_b16 a[130:131], v231 offset:34816
    v_mul_f32 v199, v243, v199
    v_mfma_f32_16x16x32_bf16 v[212:215], a[148:151], v[140:143], v[212:215]
    ds_read_b64_tr_b16 a[132:133], v231 offset:36864
    v_cvt_pk_bf16_f32 v198, v198, v199
    v_mfma_f32_16x16x32_bf16 v[212:215], a[144:147], v[136:139], v[212:215]
    ds_read_b64_tr_b16 a[134:135], v231 offset:38912
    ds_write_b32 v236, v198 offset:2052
    v_mfma_f32_16x16x32_bf16 v[216:219], a[144:147], v[144:147], v[216:219]
    ds_read_b64_tr_b16 a[136:137], v231 offset:40960
    v_mfma_f32_16x16x32_bf16 v[216:219], a[148:151], v[148:151], v[216:219]
    ds_read_b64_tr_b16 a[138:139], v231 offset:43008
    v_mul_f32 v204, v245, v204
    v_mfma_f32_16x16x32_bf16 v[220:223], a[148:151], v[156:159], v[220:223]
    ds_read_b64_tr_b16 a[140:141], v231 offset:45056
    v_mul_f32 v205, v245, v205
    v_mfma_f32_16x16x32_bf16 v[220:223], a[144:147], v[152:155], v[220:223]
    ds_read_b64_tr_b16 a[142:143], v231 offset:47104
    v_mfma_f32_16x16x32_bf16 v[220:223], a[152:155], v[184:187], v[220:223]
    ds_read_b64_tr_b16 a[144:145], v231 offset:49152
    v_cvt_pk_bf16_f32 v204, v204, v205
    v_mfma_f32_16x16x32_bf16 v[220:223], a[156:159], v[188:191], v[220:223]
    ds_write_b32 v236, v204 offset:18432
    v_mfma_f32_16x16x32_bf16 v[216:219], a[156:159], v[180:183], v[216:219]
    ds_read_b64_tr_b16 a[146:147], v231 offset:51200
    v_mul_f32 v206, v245, v206
    v_mfma_f32_16x16x32_bf16 v[216:219], a[152:155], v[176:179], v[216:219]
    v_mfma_f32_16x16x32_bf16 v[212:215], a[152:155], v[168:171], v[212:215]
    ds_read_b64_tr_b16 a[148:149], v231 offset:53248
    v_mul_f32 v207, v245, v207
    v_mfma_f32_16x16x32_bf16 v[212:215], a[156:159], v[172:175], v[212:215]
    v_mfma_f32_16x16x32_bf16 v[208:211], a[156:159], v[164:167], v[208:211]
    ds_read_b64_tr_b16 a[150:151], v231 offset:55296
    v_cvt_pk_bf16_f32 v206, v206, v207
    v_mfma_f32_16x16x32_bf16 v[208:211], a[152:155], v[160:163], v[208:211]
    s_waitcnt lgkmcnt(5)
    ds_write_b32 v236, v206 offset:18436
    v_mfma_f32_16x16x32_bf16 v[192:195], a[128:131], v[0:3], 0
    ds_read_b64_tr_b16 a[152:153], v231 offset:57344
    v_xor_b32 v236, 32, v236
    v_mfma_f32_16x16x32_bf16 v[192:195], a[132:135], v[4:7], v[192:195]
    buffer_store_dwordx4 a[184:187], v234, s[16:19], s35 offen offset:2048 sc1
    v_mul_f32 v216, v244, v216
    v_mul_f32 v217, v244, v217
    v_mfma_f32_16x16x32_bf16 v[196:199], a[132:135], v[12:15], 0
    ds_read_b64_tr_b16 a[154:155], v231 offset:59392
    v_mul_f32 v218, v244, v218
    v_mfma_f32_16x16x32_bf16 v[196:199], a[128:131], v[8:11], v[196:199]
    v_mfma_f32_16x16x32_bf16 v[200:203], a[128:131], v[16:19], 0
    ds_read_b64_tr_b16 a[156:157], v231 offset:61440
    v_mul_f32 v219, v244, v219
    v_mfma_f32_16x16x32_bf16 v[200:203], a[132:135], v[20:23], v[200:203]
    v_mfma_f32_16x16x32_bf16 v[204:207], a[132:135], v[28:31], 0
    ds_read_b64_tr_b16 a[158:159], v231 offset:63488
    v_cvt_pk_bf16_f32 v216, v216, v217
    v_mfma_f32_16x16x32_bf16 v[204:207], a[128:131], v[24:27], v[204:207]
    v_mfma_f32_16x16x32_bf16 v[204:207], a[136:139], v[56:59], v[204:207]
    ds_read_b64_tr_b16 a[128:129], v230 offset:0
    v_cvt_pk_bf16_f32 v217, v218, v219
    v_mfma_f32_16x16x32_bf16 v[204:207], a[140:143], v[60:63], v[204:207]
    ds_write_b64 v236, v[216:217] offset:16384
    v_mfma_f32_16x16x32_bf16 v[200:203], a[140:143], v[52:55], v[200:203]
    ds_read_b64_tr_b16 a[130:131], v230 offset:2048
    v_mul_f32 v208, v242, v208
    v_mfma_f32_16x16x32_bf16 v[200:203], a[136:139], v[48:51], v[200:203]
    v_mfma_f32_16x16x32_bf16 v[196:199], a[136:139], v[40:43], v[196:199]
    ds_read_b64_tr_b16 a[132:133], v230 offset:4096
    v_mul_f32 v209, v242, v209
    v_mfma_f32_16x16x32_bf16 v[196:199], a[140:143], v[44:47], v[196:199]
    v_mfma_f32_16x16x32_bf16 v[192:195], a[140:143], v[36:39], v[192:195]
    ds_read_b64_tr_b16 a[134:135], v230 offset:6144
    v_mul_f32 v210, v242, v210
    v_mfma_f32_16x16x32_bf16 v[192:195], a[136:139], v[32:35], v[192:195]
    s_waitcnt lgkmcnt(5)
    v_mul_f32 v211, v242, v211
    v_mfma_f32_16x16x32_bf16 v[192:195], a[144:147], v[64:67], v[192:195]
    ds_read_b64_tr_b16 a[136:137], v230 offset:8192
    v_cvt_pk_bf16_f32 v208, v208, v209
    v_mfma_f32_16x16x32_bf16 v[192:195], a[148:151], v[68:71], v[192:195]
    v_mfma_f32_16x16x32_bf16 v[196:199], a[148:151], v[76:79], v[196:199]
    ds_read_b64_tr_b16 a[138:139], v230 offset:10240
    v_cvt_pk_bf16_f32 v209, v210, v211
    v_mfma_f32_16x16x32_bf16 v[196:199], a[144:147], v[72:75], v[196:199]
    ds_write_b64 v236, v[208:209] offset:0
    v_mfma_f32_16x16x32_bf16 v[200:203], a[144:147], v[80:83], v[200:203]
    ds_read_b64_tr_b16 a[140:141], v230 offset:12288
    v_mul_f32 v212, v243, v212
    v_mfma_f32_16x16x32_bf16 v[200:203], a[148:151], v[84:87], v[200:203]
    buffer_store_dwordx4 a[188:191], v235, s[16:19], s35 offen offset:3072 sc1
    v_mul_f32 v213, v243, v213
    v_mul_f32 v214, v243, v214
    v_mul_f32 v215, v243, v215
    v_mfma_f32_16x16x32_bf16 v[204:207], a[148:151], v[92:95], v[204:207]
    ds_read_b64_tr_b16 a[142:143], v230 offset:14336
    v_xor_b32 v230, 32, v230
    v_mfma_f32_16x16x32_bf16 v[204:207], a[144:147], v[88:91], v[204:207]
    v_xor_b32 v231, 32, v231
    v_cvt_pk_bf16_f32 v212, v212, v213
    v_mfma_f32_16x16x32_bf16 v[204:207], a[152:155], v[120:123], v[204:207]
    ds_read_b64_tr_b16 a[144:145], v231 offset:32768
    v_cvt_pk_bf16_f32 v213, v214, v215
    v_mfma_f32_16x16x32_bf16 v[204:207], a[156:159], v[124:127], v[204:207]
    ds_write_b64 v236, v[212:213] offset:2048
    v_mfma_f32_16x16x32_bf16 v[200:203], a[156:159], v[116:119], v[200:203]
    ds_read_b64_tr_b16 a[146:147], v231 offset:34816
    v_mul_f32 v220, v245, v220
    v_mfma_f32_16x16x32_bf16 v[200:203], a[152:155], v[112:115], v[200:203]
    v_mfma_f32_16x16x32_bf16 v[196:199], a[152:155], v[104:107], v[196:199]
    ds_read_b64_tr_b16 a[148:149], v231 offset:36864
    v_mul_f32 v221, v245, v221
    v_mfma_f32_16x16x32_bf16 v[196:199], a[156:159], v[108:111], v[196:199]
    v_mfma_f32_16x16x32_bf16 v[192:195], a[156:159], v[100:103], v[192:195]
    ds_read_b64_tr_b16 a[150:151], v231 offset:38912
    v_mul_f32 v222, v245, v222
    v_mfma_f32_16x16x32_bf16 v[192:195], a[152:155], v[96:99], v[192:195]
    s_waitcnt lgkmcnt(5)
    v_mul_f32 v223, v245, v223
    v_cvt_pk_bf16_f32 v220, v220, v221
    v_mfma_f32_16x16x32_bf16 v[192:195], a[128:131], v[128:131], v[192:195]
    ds_read_b64_tr_b16 a[152:153], v231 offset:40960
    v_cvt_pk_bf16_f32 v221, v222, v223
    v_mfma_f32_16x16x32_bf16 v[192:195], a[132:135], v[132:135], v[192:195]
    ds_write_b64 v236, v[220:221] offset:18432
    v_mfma_f32_16x16x32_bf16 v[196:199], a[132:135], v[140:143], v[196:199]
    ds_read_b64_tr_b16 a[154:155], v231 offset:43008
    v_mfma_f32_16x16x32_bf16 v[196:199], a[128:131], v[136:139], v[196:199]
    ds_read_b128 a[212:215], v237 offset:0
    v_mfma_f32_16x16x32_bf16 v[200:203], a[128:131], v[144:147], v[200:203]
    ds_read_b64_tr_b16 a[156:157], v231 offset:45056
    v_mfma_f32_16x16x32_bf16 v[200:203], a[132:135], v[148:151], v[200:203]
    ds_read_b128 a[216:219], v237 offset:1024
    v_mfma_f32_16x16x32_bf16 v[204:207], a[132:135], v[156:159], v[204:207]
    ds_read_b64_tr_b16 a[158:159], v231 offset:47104
    v_mfma_f32_16x16x32_bf16 v[204:207], a[128:131], v[152:155], v[204:207]
    ds_read_b128 a[220:223], v237 offset:2048
    v_mfma_f32_16x16x32_bf16 v[204:207], a[136:139], v[184:187], v[204:207]
    ds_read_b64_tr_b16 a[128:129], v231 offset:49152
    v_mfma_f32_16x16x32_bf16 v[204:207], a[140:143], v[188:191], v[204:207]
    ds_read_b128 a[224:227], v237 offset:3072
    v_mfma_f32_16x16x32_bf16 v[200:203], a[140:143], v[180:183], v[200:203]
    ds_read_b64_tr_b16 a[130:131], v231 offset:51200
    v_mfma_f32_16x16x32_bf16 v[200:203], a[136:139], v[176:179], v[200:203]
    ds_read_b128 a[228:231], v237 offset:16384
    v_mfma_f32_16x16x32_bf16 v[196:199], a[136:139], v[168:171], v[196:199]
    ds_read_b64_tr_b16 a[132:133], v231 offset:53248
    v_mfma_f32_16x16x32_bf16 v[196:199], a[140:143], v[172:175], v[196:199]
    ds_read_b128 a[232:235], v237 offset:17408
    ds_read_b128 a[236:239], v237 offset:18432
    v_mfma_f32_16x16x32_bf16 v[192:195], a[140:143], v[164:167], v[192:195]
    ds_read_b64_tr_b16 a[134:135], v231 offset:55296
    v_mfma_f32_16x16x32_bf16 v[192:195], a[136:139], v[160:163], v[192:195]
    s_waitcnt lgkmcnt(9)
    ds_read_b128 a[240:243], v237 offset:19456
    v_mfma_f32_16x16x32_bf16 v[208:211], a[144:147], v[0:3], 0
    ds_read_b64_tr_b16 a[136:137], v231 offset:57344
    v_xor_b32 v236, 0x60, v236
    v_mfma_f32_16x16x32_bf16 v[208:211], a[148:151], v[4:7], v[208:211]
    v_mfma_f32_16x16x32_bf16 v[212:215], a[148:151], v[12:15], 0
    ds_read_b64_tr_b16 a[138:139], v231 offset:59392
    v_mul_f32 v200, v244, v200
    v_mfma_f32_16x16x32_bf16 v[212:215], a[144:147], v[8:11], v[212:215]
    v_mfma_f32_16x16x32_bf16 v[216:219], a[144:147], v[16:19], 0
    ds_read_b64_tr_b16 a[140:141], v231 offset:61440
    v_mul_f32 v201, v244, v201
    v_mfma_f32_16x16x32_bf16 v[216:219], a[148:151], v[20:23], v[216:219]
    buffer_store_dwordx4 a[212:215], v232, s[16:19], s46 offen sc1
    v_cvt_pk_bf16_f32 v200, v200, v201
    v_mfma_f32_16x16x32_bf16 v[220:223], a[148:151], v[28:31], 0
    ds_read_b64_tr_b16 a[142:143], v231 offset:63488
    v_mfma_f32_16x16x32_bf16 v[220:223], a[144:147], v[24:27], v[220:223]
    ds_write_b32 v236, v200 offset:16384
    v_mfma_f32_16x16x32_bf16 v[220:223], a[152:155], v[56:59], v[220:223]
    ds_read_b64_tr_b16 a[144:145], v230 offset:0
    v_mul_f32 v202, v244, v202
    v_mfma_f32_16x16x32_bf16 v[220:223], a[156:159], v[60:63], v[220:223]
    v_mul_f32 v203, v244, v203
    v_mfma_f32_16x16x32_bf16 v[216:219], a[156:159], v[52:55], v[216:219]
    ds_read_b64_tr_b16 a[146:147], v230 offset:2048
    v_cvt_pk_bf16_f32 v202, v202, v203
    v_mfma_f32_16x16x32_bf16 v[216:219], a[152:155], v[48:51], v[216:219]
    ds_write_b32 v236, v202 offset:16388
    v_mfma_f32_16x16x32_bf16 v[212:215], a[152:155], v[40:43], v[212:215]
    ds_read_b64_tr_b16 a[148:149], v230 offset:4096
    v_mfma_f32_16x16x32_bf16 v[212:215], a[156:159], v[44:47], v[212:215]
    v_mul_f32 v192, v242, v192
    v_mul_f32 v193, v242, v193
    v_mfma_f32_16x16x32_bf16 v[208:211], a[156:159], v[36:39], v[208:211]
    ds_read_b64_tr_b16 a[150:151], v230 offset:6144
    v_cvt_pk_bf16_f32 v192, v192, v193
    v_mfma_f32_16x16x32_bf16 v[208:211], a[152:155], v[32:35], v[208:211]
    s_waitcnt lgkmcnt(6)
    ds_write_b32 v236, v192 offset:0
    v_mfma_f32_16x16x32_bf16 v[208:211], a[128:131], v[64:67], v[208:211]
    ds_read_b64_tr_b16 a[152:153], v230 offset:8192
    v_mfma_f32_16x16x32_bf16 v[208:211], a[132:135], v[68:71], v[208:211]
    buffer_store_dwordx4 a[216:219], v233, s[16:19], s46 offen offset:1024 sc1
    v_mul_f32 v194, v242, v194
    v_mfma_f32_16x16x32_bf16 v[212:215], a[132:135], v[76:79], v[212:215]
    ds_read_b64_tr_b16 a[154:155], v230 offset:10240
    v_mul_f32 v195, v242, v195
    v_mfma_f32_16x16x32_bf16 v[212:215], a[128:131], v[72:75], v[212:215]
    v_mfma_f32_16x16x32_bf16 v[216:219], a[128:131], v[80:83], v[216:219]
    ds_read_b64_tr_b16 a[156:157], v230 offset:12288
    v_cvt_pk_bf16_f32 v194, v194, v195
    v_mfma_f32_16x16x32_bf16 v[216:219], a[132:135], v[84:87], v[216:219]
    ds_write_b32 v236, v194 offset:4
    v_mfma_f32_16x16x32_bf16 v[220:223], a[132:135], v[92:95], v[220:223]
    ds_read_b64_tr_b16 a[158:159], v230 offset:14336
    v_xor_b32 v230, 0x60, v230
    v_mfma_f32_16x16x32_bf16 v[220:223], a[128:131], v[88:91], v[220:223]
    v_xor_b32 v231, 0x60, v231
    v_mfma_f32_16x16x32_bf16 v[220:223], a[136:139], v[120:123], v[220:223]
    ds_read_b64_tr_b16 a[128:129], v231 offset:32768
    v_mfma_f32_16x16x32_bf16 v[220:223], a[140:143], v[124:127], v[220:223]
    buffer_store_dwordx4 a[220:223], v234, s[16:19], s46 offen offset:2048 sc1
    v_mul_f32 v196, v243, v196
    v_mfma_f32_16x16x32_bf16 v[216:219], a[140:143], v[116:119], v[216:219]
    ds_read_b64_tr_b16 a[130:131], v231 offset:34816
    v_mul_f32 v197, v243, v197
    v_mfma_f32_16x16x32_bf16 v[216:219], a[136:139], v[112:115], v[216:219]
    v_mfma_f32_16x16x32_bf16 v[212:215], a[136:139], v[104:107], v[212:215]
    ds_read_b64_tr_b16 a[132:133], v231 offset:36864
    v_cvt_pk_bf16_f32 v196, v196, v197
    v_mfma_f32_16x16x32_bf16 v[212:215], a[140:143], v[108:111], v[212:215]
    ds_write_b32 v236, v196 offset:2048
    v_mfma_f32_16x16x32_bf16 v[208:211], a[140:143], v[100:103], v[208:211]
    ds_read_b64_tr_b16 a[134:135], v231 offset:38912
    v_mfma_f32_16x16x32_bf16 v[208:211], a[136:139], v[96:99], v[208:211]
    s_waitcnt lgkmcnt(5)
    v_mul_f32 v198, v243, v198
    v_mul_f32 v199, v243, v199
    v_mfma_f32_16x16x32_bf16 v[208:211], a[144:147], v[128:131], v[208:211]
    ds_read_b64_tr_b16 a[136:137], v231 offset:40960
    v_cvt_pk_bf16_f32 v198, v198, v199
    v_mfma_f32_16x16x32_bf16 v[208:211], a[148:151], v[132:135], v[208:211]
    ds_write_b32 v236, v198 offset:2052
    v_mfma_f32_16x16x32_bf16 v[212:215], a[148:151], v[140:143], v[212:215]
    ds_read_b64_tr_b16 a[138:139], v231 offset:43008
    v_mfma_f32_16x16x32_bf16 v[212:215], a[144:147], v[136:139], v[212:215]
    buffer_store_dwordx4 a[224:227], v235, s[16:19], s46 offen offset:3072 sc1
    v_mul_f32 v204, v245, v204
    v_mfma_f32_16x16x32_bf16 v[216:219], a[144:147], v[144:147], v[216:219]
    ds_read_b64_tr_b16 a[140:141], v231 offset:45056
    v_mul_f32 v205, v245, v205
    v_mfma_f32_16x16x32_bf16 v[216:219], a[148:151], v[148:151], v[216:219]
    v_mfma_f32_16x16x32_bf16 v[220:223], a[148:151], v[156:159], v[220:223]
    ds_read_b64_tr_b16 a[142:143], v231 offset:47104
    v_cvt_pk_bf16_f32 v204, v204, v205
    v_mfma_f32_16x16x32_bf16 v[220:223], a[144:147], v[152:155], v[220:223]
    ds_write_b32 v236, v204 offset:18432
    v_mfma_f32_16x16x32_bf16 v[220:223], a[152:155], v[184:187], v[220:223]
    ds_read_b64_tr_b16 a[144:145], v231 offset:49152
    v_mul_f32 v206, v245, v206
    v_mfma_f32_16x16x32_bf16 v[220:223], a[156:159], v[188:191], v[220:223]
    v_mfma_f32_16x16x32_bf16 v[216:219], a[156:159], v[180:183], v[216:219]
    s_add_u32 s35, s46, 0x4000
    ds_read_b64_tr_b16 a[146:147], v231 offset:51200
    v_mul_f32 v207, v245, v207
    v_mfma_f32_16x16x32_bf16 v[216:219], a[152:155], v[176:179], v[216:219]
    v_mfma_f32_16x16x32_bf16 v[212:215], a[152:155], v[168:171], v[212:215]
    ds_read_b64_tr_b16 a[148:149], v231 offset:53248
    v_cvt_pk_bf16_f32 v206, v206, v207
    v_mfma_f32_16x16x32_bf16 v[212:215], a[156:159], v[172:175], v[212:215]
    ds_write_b32 v236, v206 offset:18436
    v_mfma_f32_16x16x32_bf16 v[208:211], a[156:159], v[164:167], v[208:211]
    ds_read_b64_tr_b16 a[150:151], v231 offset:55296
    v_mfma_f32_16x16x32_bf16 v[208:211], a[152:155], v[160:163], v[208:211]
    s_waitcnt lgkmcnt(6)
    buffer_store_dwordx4 a[228:231], v232, s[16:19], s35 offen sc1
    v_mfma_f32_16x16x32_bf16 v[192:195], a[128:131], v[0:3], 0
    ds_read_b64_tr_b16 a[152:153], v231 offset:57344
    v_xor_b32 v236, 32, v236
    v_mfma_f32_16x16x32_bf16 v[192:195], a[132:135], v[4:7], v[192:195]
    v_mfma_f32_16x16x32_bf16 v[196:199], a[132:135], v[12:15], 0
    ds_read_b64_tr_b16 a[154:155], v231 offset:59392
    v_mul_f32 v216, v244, v216
    v_mfma_f32_16x16x32_bf16 v[196:199], a[128:131], v[8:11], v[196:199]
    v_mfma_f32_16x16x32_bf16 v[200:203], a[128:131], v[16:19], 0
    ds_read_b64_tr_b16 a[156:157], v231 offset:61440
    v_mul_f32 v217, v244, v217
    v_mfma_f32_16x16x32_bf16 v[200:203], a[132:135], v[20:23], v[200:203]
    v_mfma_f32_16x16x32_bf16 v[204:207], a[132:135], v[28:31], 0
    ds_read_b64_tr_b16 a[158:159], v231 offset:63488
    v_cvt_pk_bf16_f32 v216, v216, v217
    v_mfma_f32_16x16x32_bf16 v[204:207], a[128:131], v[24:27], v[204:207]
    ds_write_b32 v236, v216 offset:16384
    v_mfma_f32_16x16x32_bf16 v[204:207], a[136:139], v[56:59], v[204:207]
    ds_read_b64_tr_b16 a[128:129], v230 offset:0
    v_mul_f32 v218, v244, v218
    v_mfma_f32_16x16x32_bf16 v[204:207], a[140:143], v[60:63], v[204:207]
    buffer_store_dwordx4 a[232:235], v233, s[16:19], s35 offen offset:1024 sc1
    v_mul_f32 v219, v244, v219
    v_mfma_f32_16x16x32_bf16 v[200:203], a[140:143], v[52:55], v[200:203]
    ds_read_b64_tr_b16 a[130:131], v230 offset:2048
    v_cvt_pk_bf16_f32 v218, v218, v219
    v_mfma_f32_16x16x32_bf16 v[200:203], a[136:139], v[48:51], v[200:203]
    ds_write_b32 v236, v218 offset:16388
    v_mfma_f32_16x16x32_bf16 v[196:199], a[136:139], v[40:43], v[196:199]
    ds_read_b64_tr_b16 a[132:133], v230 offset:4096
    v_mfma_f32_16x16x32_bf16 v[196:199], a[140:143], v[44:47], v[196:199]
    v_mfma_f32_16x16x32_bf16 v[192:195], a[140:143], v[36:39], v[192:195]
    ds_read_b64_tr_b16 a[134:135], v230 offset:6144
    v_mul_f32 v208, v242, v208
    v_mfma_f32_16x16x32_bf16 v[192:195], a[136:139], v[32:35], v[192:195]
L_hop14:
    s_cbranch_execz L_hopret3
    s_waitcnt lgkmcnt(6)
    v_mul_f32 v209, v242, v209
    v_mfma_f32_16x16x32_bf16 v[192:195], a[144:147], v[64:67], v[192:195]
    ds_read_b64_tr_b16 a[136:137], v230 offset:8192
    v_cvt_pk_bf16_f32 v208, v208, v209
    v_mfma_f32_16x16x32_bf16 v[192:195], a[148:151], v[68:71], v[192:195]
    ds_write_b32 v236, v208 offset:0
    v_mfma_f32_16x16x32_bf16 v[196:199], a[148:151], v[76:79], v[196:199]
    ds_read_b64_tr_b16 a[138:139], v230 offset:10240
    v_mfma_f32_16x16x32_bf16 v[196:199], a[144:147], v[72:75], v[196:199]
    buffer_store_dwordx4 a[236:239], v234, s[16:19], s35 offen offset:2048 sc1
    v_mul_f32 v210, v242, v210
    v_mul_f32 v211, v242, v211
    v_mfma_f32_16x16x32_bf16 v[200:203], a[144:147], v[80:83], v[200:203]
    ds_read_b64_tr_b16 a[140:141], v230 offset:12288
    v_cvt_pk_bf16_f32 v210, v210, v211
    v_mfma_f32_16x16x32_bf16 v[200:203], a[148:151], v[84:87], v[200:203]
    ds_write_b32 v236, v210 offset:4
    v_mfma_f32_16x16x32_bf16 v[204:207], a[148:151], v[92:95], v[204:207]
    ds_read_b64_tr_b16 a[142:143], v230 offset:14336
    v_xor_b32 v230, 32, v230
    v_mfma_f32_16x16x32_bf16 v[204:207], a[144:147], v[88:91], v[204:207]
    v_xor_b32 v231, 32, v231
    v_mul_f32 v212, v243, v212
    v_mfma_f32_16x16x32_bf16 v[204:207], a[152:155], v[120:123], v[204:207]
    ds_read_b64_tr_b16 a[144:145], v231 offset:32768
    v_mul_f32 v213, v243, v213
    v_mfma_f32_16x16x32_bf16 v[204:207], a[156:159], v[124:127], v[204:207]
    v_mfma_f32_16x16x32_bf16 v[200:203], a[156:159], v[116:119], v[200:203]
    ds_read_b64_tr_b16 a[146:147], v231 offset:34816
    v_cvt_pk_bf16_f32 v212, v212, v213
    v_mfma_f32_16x16x32_bf16 v[200:203], a[152:155], v[112:115], v[200:203]
    ds_write_b32 v236, v212 offset:2048
    v_mfma_f32_16x16x32_bf16 v[196:199], a[152:155], v[104:107], v[196:199]
    ds_read_b64_tr_b16 a[148:149], v231 offset:36864
    v_mfma_f32_16x16x32_bf16 v[196:199], a[156:159], v[108:111], v[196:199]
    buffer_store_dwordx4 a[240:243], v235, s[16:19], s35 offen offset:3072 sc1
    v_mfma_f32_16x16x32_bf16 v[192:195], a[156:159], v[100:103], v[192:195]
    ds_read_b64_tr_b16 a[150:151], v231 offset:38912
    v_mfma_f32_16x16x32_bf16 v[192:195], a[152:155], v[96:99], v[192:195]
    s_waitcnt lgkmcnt(5)
    v_mul_f32 v214, v243, v214
    v_mfma_f32_16x16x32_bf16 v[192:195], a[128:131], v[128:131], v[192:195]
    ds_read_b64_tr_b16 a[152:153], v231 offset:40960
    v_mul_f32 v215, v243, v215
    v_mfma_f32_16x16x32_bf16 v[192:195], a[132:135], v[132:135], v[192:195]
    v_mfma_f32_16x16x32_bf16 v[196:199], a[132:135], v[140:143], v[196:199]
    ds_read_b64_tr_b16 a[154:155], v231 offset:43008
    v_cvt_pk_bf16_f32 v214, v214, v215
    v_mfma_f32_16x16x32_bf16 v[196:199], a[128:131], v[136:139], v[196:199]
    ds_write_b32 v236, v214 offset:2052
    v_mfma_f32_16x16x32_bf16 v[200:203], a[128:131], v[144:147], v[200:203]
    ds_read_b64_tr_b16 a[156:157], v231 offset:45056
    v_mul_f32 v220, v245, v220
    v_mfma_f32_16x16x32_bf16 v[200:203], a[132:135], v[148:151], v[200:203]
    v_mfma_f32_16x16x32_bf16 v[204:207], a[132:135], v[156:159], v[204:207]
    ds_read_b64_tr_b16 a[158:159], v231 offset:47104
    v_mul_f32 v221, v245, v221
    v_mfma_f32_16x16x32_bf16 v[204:207], a[128:131], v[152:155], v[204:207]
    v_mfma_f32_16x16x32_bf16 v[204:207], a[136:139], v[184:187], v[204:207]
    ds_read_b64_tr_b16 a[128:129], v231 offset:49152
    v_cvt_pk_bf16_f32 v220, v220, v221
    v_mfma_f32_16x16x32_bf16 v[204:207], a[140:143], v[188:191], v[204:207]
    ds_write_b32 v236, v220 offset:18432
    v_mfma_f32_16x16x32_bf16 v[200:203], a[140:143], v[180:183], v[200:203]
    ds_read_b64_tr_b16 a[130:131], v231 offset:51200
    v_mul_f32 v222, v245, v222
    v_mfma_f32_16x16x32_bf16 v[200:203], a[136:139], v[176:179], v[200:203]
    v_mfma_f32_16x16x32_bf16 v[196:199], a[136:139], v[168:171], v[196:199]
    ds_read_b64_tr_b16 a[132:133], v231 offset:53248
    v_mul_f32 v223, v245, v223
    v_mfma_f32_16x16x32_bf16 v[196:199], a[140:143], v[172:175], v[196:199]
    v_mfma_f32_16x16x32_bf16 v[192:195], a[140:143], v[164:167], v[192:195]
    ds_read_b64_tr_b16 a[134:135], v231 offset:55296
    v_cvt_pk_bf16_f32 v222, v222, v223
    v_mfma_f32_16x16x32_bf16 v[192:195], a[136:139], v[160:163], v[192:195]
    s_waitcnt lgkmcnt(5)
    ds_write_b32 v236, v222 offset:18436
    v_mfma_f32_16x16x32_bf16 v[208:211], a[144:147], v[0:3], 0
    ds_read_b64_tr_b16 a[136:137], v231 offset:57344
    v_xor_b32 v236, 0x60, v236
    v_mfma_f32_16x16x32_bf16 v[208:211], a[148:151], v[4:7], v[208:211]
    v_mul_f32 v200, v244, v200
    v_mul_f32 v201, v244, v201
    v_mfma_f32_16x16x32_bf16 v[212:215], a[148:151], v[12:15], 0
    ds_read_b64_tr_b16 a[138:139], v231 offset:59392
    v_cvt_pk_bf16_f32 v200, v200, v201
    v_mfma_f32_16x16x32_bf16 v[212:215], a[144:147], v[8:11], v[212:215]
    ds_write_b32 v236, v200 offset:16384
    v_mfma_f32_16x16x32_bf16 v[216:219], a[144:147], v[16:19], 0
    ds_read_b64_tr_b16 a[140:141], v231 offset:61440
    v_mul_f32 v202, v244, v202
    v_mfma_f32_16x16x32_bf16 v[216:219], a[148:151], v[20:23], v[216:219]
    v_mfma_f32_16x16x32_bf16 v[220:223], a[148:151], v[28:31], 0
    ds_read_b64_tr_b16 a[142:143], v231 offset:63488
    v_mul_f32 v203, v244, v203
    v_mfma_f32_16x16x32_bf16 v[220:223], a[144:147], v[24:27], v[220:223]
    v_mfma_f32_16x16x32_bf16 v[220:223], a[152:155], v[56:59], v[220:223]
    ds_read_b64_tr_b16 a[144:145], v230 offset:0
    v_cvt_pk_bf16_f32 v202, v202, v203
    v_mfma_f32_16x16x32_bf16 v[220:223], a[156:159], v[60:63], v[220:223]
    ds_write_b32 v236, v202 offset:16388
    v_mfma_f32_16x16x32_bf16 v[216:219], a[156:159], v[52:55], v[216:219]
    ds_read_b64_tr_b16 a[146:147], v230 offset:2048
    v_mul_f32 v192, v242, v192
    v_mfma_f32_16x16x32_bf16 v[216:219], a[152:155], v[48:51], v[216:219]
    v_mfma_f32_16x16x32_bf16 v[212:215], a[152:155], v[40:43], v[212:215]
    ds_read_b64_tr_b16 a[148:149], v230 offset:4096
    v_mul_f32 v193, v242, v193
    v_mfma_f32_16x16x32_bf16 v[212:215], a[156:159], v[44:47], v[212:215]
    v_mfma_f32_16x16x32_bf16 v[208:211], a[156:159], v[36:39], v[208:211]
    ds_read_b64_tr_b16 a[150:151], v230 offset:6144
    v_cvt_pk_bf16_f32 v192, v192, v193
    v_mfma_f32_16x16x32_bf16 v[208:211], a[152:155], v[32:35], v[208:211]
    s_waitcnt lgkmcnt(5)
    ds_write_b32 v236, v192 offset:0
    v_mfma_f32_16x16x32_bf16 v[208:211], a[128:131], v[64:67], v[208:211]
    ds_read_b64_tr_b16 a[152:153], v230 offset:8192
    v_mul_f32 v194, v242, v194
    v_mfma_f32_16x16x32_bf16 v[208:211], a[132:135], v[68:71], v[208:211]
    v_mfma_f32_16x16x32_bf16 v[212:215], a[132:135], v[76:79], v[212:215]
    ds_read_b64_tr_b16 a[154:155], v230 offset:10240
    v_mul_f32 v195, v242, v195
    v_mfma_f32_16x16x32_bf16 v[212:215], a[128:131], v[72:75], v[212:215]
    v_mfma_f32_16x16x32_bf16 v[216:219], a[128:131], v[80:83], v[216:219]
    ds_read_b64_tr_b16 a[156:157], v230 offset:12288
    v_cvt_pk_bf16_f32 v194, v194, v195
    v_mfma_f32_16x16x32_bf16 v[216:219], a[132:135], v[84:87], v[216:219]
    ds_write_b32 v236, v194 offset:4
    v_mfma_f32_16x16x32_bf16 v[220:223], a[132:135], v[92:95], v[220:223]
    ds_read_b64_tr_b16 a[158:159], v230 offset:14336
    v_mul_f32 v196, v243, v196
    v_mfma_f32_16x16x32_bf16 v[220:223], a[128:131], v[88:91], v[220:223]
    v_mul_f32 v197, v243, v197
    v_cvt_pk_bf16_f32 v196, v196, v197
    v_mfma_f32_16x16x32_bf16 v[220:223], a[136:139], v[120:123], v[220:223]
    ds_write_b32 v236, v196 offset:2048
    v_mfma_f32_16x16x32_bf16 v[220:223], a[140:143], v[124:127], v[220:223]
    v_mfma_f32_16x16x32_bf16 v[216:219], a[140:143], v[116:119], v[216:219]
    v_mul_f32 v198, v243, v198
    v_mul_f32 v199, v243, v199
    v_mfma_f32_16x16x32_bf16 v[216:219], a[136:139], v[112:115], v[216:219]
    v_mfma_f32_16x16x32_bf16 v[212:215], a[136:139], v[104:107], v[212:215]
    v_cvt_pk_bf16_f32 v198, v198, v199
    v_mfma_f32_16x16x32_bf16 v[212:215], a[140:143], v[108:111], v[212:215]
    ds_write_b32 v236, v198 offset:2052
    v_mfma_f32_16x16x32_bf16 v[208:211], a[140:143], v[100:103], v[208:211]
    v_mfma_f32_16x16x32_bf16 v[208:211], a[136:139], v[96:99], v[208:211]
    s_waitcnt lgkmcnt(2)
    v_mul_f32 v204, v245, v204
    v_mul_f32 v205, v245, v205
    v_mfma_f32_16x16x32_bf16 v[208:211], a[144:147], v[128:131], v[208:211]
    v_mfma_f32_16x16x32_bf16 v[208:211], a[148:151], v[132:135], v[208:211]
    v_cvt_pk_bf16_f32 v204, v204, v205
    v_mfma_f32_16x16x32_bf16 v[212:215], a[148:151], v[140:143], v[212:215]
    ds_write_b32 v236, v204 offset:18432
    v_mfma_f32_16x16x32_bf16 v[212:215], a[144:147], v[136:139], v[212:215]
    v_mul_f32 v206, v245, v206
    v_mfma_f32_16x16x32_bf16 v[216:219], a[144:147], v[144:147], v[216:219]
    v_mfma_f32_16x16x32_bf16 v[216:219], a[148:151], v[148:151], v[216:219]
    v_mul_f32 v207, v245, v207
    v_cvt_pk_bf16_f32 v206, v206, v207
    v_mfma_f32_16x16x32_bf16 v[220:223], a[148:151], v[156:159], v[220:223]
    v_mfma_f32_16x16x32_bf16 v[220:223], a[144:147], v[152:155], v[220:223]
    ds_write_b32 v236, v206 offset:18436
    v_mfma_f32_16x16x32_bf16 v[220:223], a[152:155], v[184:187], v[220:223]
    v_mfma_f32_16x16x32_bf16 v[220:223], a[156:159], v[188:191], v[220:223]
    s_nop 2
    v_mfma_f32_16x16x32_bf16 v[216:219], a[156:159], v[180:183], v[216:219]
    v_xor_b32 v236, 32, v236
    v_mfma_f32_16x16x32_bf16 v[216:219], a[152:155], v[176:179], v[216:219]
    s_nop 0
    v_mfma_f32_16x16x32_bf16 v[212:215], a[152:155], v[168:171], v[212:215]
    v_mul_f32 v220, v245, v220
    v_mul_f32 v221, v245, v221
    v_mfma_f32_16x16x32_bf16 v[212:215], a[156:159], v[172:175], v[212:215]
    v_mul_f32 v222, v245, v222
    v_mul_f32 v223, v245, v223
    v_mfma_f32_16x16x32_bf16 v[208:211], a[156:159], v[164:167], v[208:211]
    v_cvt_pk_bf16_f32 v220, v220, v221
    v_cvt_pk_bf16_f32 v221, v222, v223
    v_mfma_f32_16x16x32_bf16 v[208:211], a[152:155], v[160:163], v[208:211]
    s_add_u32 s35, s47, 0x4000
    ds_write_b64 v236, v[220:221] offset:18432
    ds_read_b128 a[184:187], v237 offset:18432
    ds_read_b128 a[188:191], v237 offset:19456
    v_mul_f32 v216, v244, v216
    v_mul_f32 v217, v244, v217
    v_mul_f32 v218, v244, v218
    v_mul_f32 v219, v244, v219
    v_cvt_pk_bf16_f32 v216, v216, v217
    v_cvt_pk_bf16_f32 v217, v218, v219
    ds_write_b64 v236, v[216:217] offset:16384
    ds_read_b128 a[176:179], v237 offset:16384
    ds_read_b128 a[180:183], v237 offset:17408
    v_mul_f32 v212, v243, v212
    v_mul_f32 v213, v243, v213
    v_mul_f32 v214, v243, v214
    v_mul_f32 v215, v243, v215
    s_waitcnt lgkmcnt(4)
    buffer_store_dwordx4 a[184:187], v234, s[16:19], s35 offen offset:2048 sc1
    v_cvt_pk_bf16_f32 v212, v212, v213
    v_cvt_pk_bf16_f32 v213, v214, v215
    ds_write_b64 v236, v[212:213] offset:2048
    ds_read_b128 a[168:171], v237 offset:2048
    ds_read_b128 a[172:175], v237 offset:3072
    s_waitcnt lgkmcnt(6)
    buffer_store_dwordx4 a[188:191], v235, s[16:19], s35 offen offset:3072 sc1
    v_mul_f32 v208, v242, v208
    v_mul_f32 v209, v242, v209
    v_mul_f32 v210, v242, v210
    v_mul_f32 v211, v242, v211
    s_waitcnt lgkmcnt(4)
    buffer_store_dwordx4 a[176:179], v232, s[16:19], s35 offen sc1
    v_cvt_pk_bf16_f32 v208, v208, v209
    v_cvt_pk_bf16_f32 v209, v210, v211
    ds_write_b64 v236, v[208:209] offset:0
    ds_read_b128 a[160:163], v237 offset:0
    ds_read_b128 a[164:167], v237 offset:1024
    s_waitcnt lgkmcnt(6)
    buffer_store_dwordx4 a[180:183], v233, s[16:19], s35 offen offset:1024 sc1
    s_waitcnt lgkmcnt(4)
    buffer_store_dwordx4 a[168:171], v234, s[16:19], s47 offen offset:2048 sc1
    s_waitcnt lgkmcnt(3)
    buffer_store_dwordx4 a[172:175], v235, s[16:19], s47 offen offset:3072 sc1
    s_waitcnt lgkmcnt(1)
    buffer_store_dwordx4 a[160:163], v232, s[16:19], s47 offen sc1
    s_waitcnt lgkmcnt(0)
    buffer_store_dwordx4 a[164:167], v233, s[16:19], s47 offen offset:1024 sc1
L_end:
    s_endpgm
L_slow:
    s_nop 7
    v_mbcnt_lo_u32_b32 v250, -1, 0
    v_mbcnt_hi_u32_b32 v250, -1, v250
    v_lshrrev_b32 v249, 4, v250
    v_and_b32 v250, 15, v250
    v_lshlrev_b32 v250, 9, v250
    v_lshl_add_u32 v250, v249, 4, v250
    v_or_b32 v250, s96, v250
    v_mov_b32 v238, 0xff800000
    v_mov_b32 v239, 0xff800000
    v_mov_b32 v240, 0xff800000
    v_mov_b32 v241, 0xff800000
    s_mov_b32 s36, s27
    s_mov_b32 s39, 0
L_slowA:
    v_xor_b32 v249, 0, v250
    buffer_load_dwordx4 a[212:215], v249, s[8:11], s36 offen offset:0
    buffer_load_dwordx4 a[216:219], v249, s[8:11], s36 offen offset:64
    v_xor_b32 v249, 0x80, v250
    buffer_load_dwordx4 a[220:223], v249, s[8:11], s36 offen offset:0
    buffer_load_dwordx4 a[224:227], v249, s[8:11], s36 offen offset:64
    v_xor_b32 v249, 0x100, v250
    buffer_load_dwordx4 a[228:231], v249, s[8:11], s36 offen offset:0
    buffer_load_dwordx4 a[232:235], v249, s[8:11], s36 offen offset:64
    v_xor_b32 v249, 0x180, v250
    buffer_load_dwordx4 a[236:239], v249, s[8:11], s36 offen offset:0
    buffer_load_dwordx4 a[240:243], v249, s[8:11], s36 offen offset:64
    s_add_u32 s36, s36, 0x2000
    s_waitcnt vmcnt(0)
    v_mfma_f32_16x16x32_bf16 v[208:211], a[212:215], a[0:3], 0
    v_mfma_f32_16x16x32_bf16 v[212:215], a[212:215], a[32:35], 0
    v_mfma_f32_16x16x32_bf16 v[216:219], a[212:215], a[64:67], 0
    v_mfma_f32_16x16x32_bf16 v[220:223], a[212:215], a[96:99], 0
    v_mfma_f32_16x16x32_bf16 v[208:211], a[216:219], a[4:7], v[208:211]
    v_mfma_f32_16x16x32_bf16 v[212:215], a[216:219], a[36:39], v[212:215]
    v_mfma_f32_16x16x32_bf16 v[216:219], a[216:219], a[68:71], v[216:219]
    v_mfma_f32_16x16x32_bf16 v[220:223], a[216:219], a[100:103], v[220:223]
    v_mfma_f32_16x16x32_bf16 v[208:211], a[220:223], a[8:11], v[208:211]
    v_mfma_f32_16x16x32_bf16 v[212:215], a[220:223], a[40:43], v[212:215]
    v_mfma_f32_16x16x32_bf16 v[216:219], a[220:223], a[72:75], v[216:219]
    v_mfma_f32_16x16x32_bf16 v[220:223], a[220:223], a[104:107], v[220:223]
    v_mfma_f32_16x16x32_bf16 v[208:211], a[224:227], a[12:15], v[208:211]
    v_mfma_f32_16x16x32_bf16 v[212:215], a[224:227], a[44:47], v[212:215]
    v_mfma_f32_16x16x32_bf16 v[216:219], a[224:227], a[76:79], v[216:219]
    v_mfma_f32_16x16x32_bf16 v[220:223], a[224:227], a[108:111], v[220:223]
    v_mfma_f32_16x16x32_bf16 v[208:211], a[228:231], a[16:19], v[208:211]
    v_mfma_f32_16x16x32_bf16 v[212:215], a[228:231], a[48:51], v[212:215]
    v_mfma_f32_16x16x32_bf16 v[216:219], a[228:231], a[80:83], v[216:219]
    v_mfma_f32_16x16x32_bf16 v[220:223], a[228:231], a[112:115], v[220:223]
    v_mfma_f32_16x16x32_bf16 v[208:211], a[232:235], a[20:23], v[208:211]
    v_mfma_f32_16x16x32_bf16 v[212:215], a[232:235], a[52:55], v[212:215]
    v_mfma_f32_16x16x32_bf16 v[216:219], a[232:235], a[84:87], v[216:219]
    v_mfma_f32_16x16x32_bf16 v[220:223], a[232:235], a[116:119], v[220:223]
    v_mfma_f32_16x16x32_bf16 v[208:211], a[236:239], a[24:27], v[208:211]
    v_mfma_f32_16x16x32_bf16 v[212:215], a[236:239], a[56:59], v[212:215]
    v_mfma_f32_16x16x32_bf16 v[216:219], a[236:239], a[88:91], v[216:219]
    v_mfma_f32_16x16x32_bf16 v[220:223], a[236:239], a[120:123], v[220:223]
    v_mfma_f32_16x16x32_bf16 v[208:211], a[240:243], a[28:31], v[208:211]
    v_mfma_f32_16x16x32_bf16 v[212:215], a[240:243], a[60:63], v[212:215]
    v_mfma_f32_16x16x32_bf16 v[216:219], a[240:243], a[92:95], v[216:219]
    v_mfma_f32_16x16x32_bf16 v[220:223], a[240:243], a[124:127], v[220:223]
    s_nop 7
    v_max3_f32 v238, v238, v208, v209
    v_max3_f32 v238, v238, v210, v211
    v_max3_f32 v239, v239, v212, v213
    v_max3_f32 v239, v239, v214, v215
    v_max3_f32 v240, v240, v216, v217
    v_max3_f32 v240, v240, v218, v219
    v_max3_f32 v241, v241, v220, v221
    v_max3_f32 v241, v241, v222, v223
    s_add_u32 s39, s39, 1
    s_cmp_lt_u32 s39, 24
    s_cbranch_scc1 L_slowA
    s_nop 1
    v_permlane32_swap_b32 v239, v241
    v_permlane32_swap_b32 v238, v240
    v_max_f32 v239, v239, v241
    v_max_f32 v238, v238, v240
    s_nop 1
    v_permlane16_swap_b32 v238, v239
    v_max_f32 v239, v238, v239
    v_mul_f32 v238, -1.0, v239
    v_mul_f32 v239, -1.0, v239
    s_nop 1
    v_permlane16_swap_b32 v238, v239
    v_mov_b32 v240, v238
    v_mov_b32 v241, v239
    s_nop 1
    v_permlane32_swap_b32 v238, v240
    v_permlane32_swap_b32 v239, v241
    v_accvgpr_write_b32 a192, 0
    v_accvgpr_write_b32 a193, 0
    v_accvgpr_write_b32 a194, 0
    v_accvgpr_write_b32 a195, 0
    v_accvgpr_write_b32 a196, 0
    v_accvgpr_write_b32 a197, 0
    v_accvgpr_write_b32 a198, 0
    v_accvgpr_write_b32 a199, 0
    v_accvgpr_write_b32 a200, 0
    v_accvgpr_write_b32 a201, 0
    v_accvgpr_write_b32 a202, 0
    v_accvgpr_write_b32 a203, 0
    v_accvgpr_write_b32 a204, 0
    v_accvgpr_write_b32 a205, 0
    v_accvgpr_write_b32 a206, 0
    v_accvgpr_write_b32 a207, 0
    s_mov_b32 s36, s27
    s_mov_b32 s39, 0
L_slowB:
    v_mov_b32 v0, v32
    v_mov_b32 v1, v33
    v_mov_b32 v2, v34
    v_mov_b32 v3, v35
    v_mov_b32 v4, v36
    v_mov_b32 v5, v37
    v_mov_b32 v6, v38
    v_mov_b32 v7, v39
    v_mov_b32 v8, v40
    v_mov_b32 v9, v41
    v_mov_b32 v10, v42
    v_mov_b32 v11, v43
    v_mov_b32 v12, v44
    v_mov_b32 v13, v45
    v_mov_b32 v14, v46
    v_mov_b32 v15, v47
    v_mov_b32 v16, v48
    v_mov_b32 v17, v49
    v_mov_b32 v18, v50
    v_mov_b32 v19, v51
    v_mov_b32 v20, v52
    v_mov_b32 v21, v53
    v_mov_b32 v22, v54
    v_mov_b32 v23, v55
    v_mov_b32 v24, v56
    v_mov_b32 v25, v57
    v_mov_b32 v26, v58
    v_mov_b32 v27, v59
    v_mov_b32 v28, v60
    v_mov_b32 v29, v61
    v_mov_b32 v30, v62
    v_mov_b32 v31, v63
    v_mov_b32 v32, v64
    v_mov_b32 v33, v65
    v_mov_b32 v34, v66
    v_mov_b32 v35, v67
    v_mov_b32 v36, v68
    v_mov_b32 v37, v69
    v_mov_b32 v38, v70
    v_mov_b32 v39, v71
    v_mov_b32 v40, v72
    v_mov_b32 v41, v73
    v_mov_b32 v42, v74
    v_mov_b32 v43, v75
    v_mov_b32 v44, v76
    v_mov_b32 v45, v77
    v_mov_b32 v46, v78
    v_mov_b32 v47, v79
    v_mov_b32 v48, v80
    v_mov_b32 v49, v81
    v_mov_b32 v50, v82
    v_mov_b32 v51, v83
    v_mov_b32 v52, v84
    v_mov_b32 v53, v85
    v_mov_b32 v54, v86
    v_mov_b32 v55, v87
    v_mov_b32 v56, v88
    v_mov_b32 v57, v89
    v_mov_b32 v58, v90
    v_mov_b32 v59, v91
    v_mov_b32 v60, v92
    v_mov_b32 v61, v93
    v_mov_b32 v62, v94
    v_mov_b32 v63, v95
    v_mov_b32 v64, v96
    v_mov_b32 v65, v97
    v_mov_b32 v66, v98
    v_mov_b32 v67, v99
    v_mov_b32 v68, v100
    v_mov_b32 v69, v101
    v_mov_b32 v70, v102
    v_mov_b32 v71, v103
    v_mov_b32 v72, v104
    v_mov_b32 v73, v105
    v_mov_b32 v74, v106
    v_mov_b32 v75, v107
    v_mov_b32 v76, v108
    v_mov_b32 v77, v109
    v_mov_b32 v78, v110
    v_mov_b32 v79, v111
    v_mov_b32 v80, v112
    v_mov_b32 v81, v113
    v_mov_b32 v82, v114
    v_mov_b32 v83, v115
    v_mov_b32 v84, v116
    v_mov_b32 v85, v117
    v_mov_b32 v86, v118
    v_mov_b32 v87, v119
    v_mov_b32 v88, v120
    v_mov_b32 v89, v121
    v_mov_b32 v90, v122
    v_mov_b32 v91, v123
    v_mov_b32 v92, v124
    v_mov_b32 v93, v125
    v_mov_b32 v94, v126
    v_mov_b32 v95, v127
    v_mov_b32 v96, v128
    v_mov_b32 v97, v129
    v_mov_b32 v98, v130
    v_mov_b32 v99, v131
    v_mov_b32 v100, v132
    v_mov_b32 v101, v133
    v_mov_b32 v102, v134
    v_mov_b32 v103, v135
    v_mov_b32 v104, v136
    v_mov_b32 v105, v137
    v_mov_b32 v106, v138
    v_mov_b32 v107, v139
    v_mov_b32 v108, v140
    v_mov_b32 v109, v141
    v_mov_b32 v110, v142
    v_mov_b32 v111, v143
    v_mov_b32 v112, v144
    v_mov_b32 v113, v145
    v_mov_b32 v114, v146
    v_mov_b32 v115, v147
    v_mov_b32 v116, v148
    v_mov_b32 v117, v149
    v_mov_b32 v118, v150
    v_mov_b32 v119, v151
    v_mov_b32 v120, v152
    v_mov_b32 v121, v153
    v_mov_b32 v122, v154
    v_mov_b32 v123, v155
    v_mov_b32 v124, v156
    v_mov_b32 v125, v157
    v_mov_b32 v126, v158
    v_mov_b32 v127, v159
    v_mov_b32 v128, v160
    v_mov_b32 v129, v161
    v_mov_b32 v130, v162
    v_mov_b32 v131, v163
    v_mov_b32 v132, v164
    v_mov_b32 v133, v165
    v_mov_b32 v134, v166
    v_mov_b32 v135, v167
    v_mov_b32 v136, v168
    v_mov_b32 v137, v169
    v_mov_b32 v138, v170
    v_mov_b32 v139, v171
    v_mov_b32 v140, v172
    v_mov_b32 v141, v173
    v_mov_b32 v142, v174
    v_mov_b32 v143, v175
    v_mov_b32 v144, v176
    v_mov_b32 v145, v177
    v_mov_b32 v146, v178
    v_mov_b32 v147, v179
    v_mov_b32 v148, v180
    v_mov_b32 v149, v181
    v_mov_b32 v150, v182
    v_mov_b32 v151, v183
    v_mov_b32 v152, v184
    v_mov_b32 v153, v185
    v_mov_b32 v154, v186
    v_mov_b32 v155, v187
    v_mov_b32 v156, v188
    v_mov_b32 v157, v189
    v_mov_b32 v158, v190
    v_mov_b32 v159, v191
    v_xor_b32 v249, 0, v250
    buffer_load_dwordx4 a[212:215], v249, s[8:11], s36 offen offset:0
    buffer_load_dwordx4 a[216:219], v249, s[8:11], s36 offen offset:64
    v_xor_b32 v249, 0x80, v250
    buffer_load_dwordx4 a[220:223], v249, s[8:11], s36 offen offset:0
    buffer_load_dwordx4 a[224:227], v249, s[8:11], s36 offen offset:64
    v_xor_b32 v249, 0x100, v250
    buffer_load_dwordx4 a[228:231], v249, s[8:11], s36 offen offset:0
    buffer_load_dwordx4 a[232:235], v249, s[8:11], s36 offen offset:64
    v_xor_b32 v249, 0x180, v250
    buffer_load_dwordx4 a[236:239], v249, s[8:11], s36 offen offset:0
    buffer_load_dwordx4 a[240:243], v249, s[8:11], s36 offen offset:64
    s_add_u32 s36, s36, 0x2000
    s_waitcnt vmcnt(0)
    v_mfma_f32_16x16x32_bf16 v[208:211], a[212:215], a[0:3], 0
    v_mfma_f32_16x16x32_bf16 v[212:215], a[212:215], a[32:35], 0
    v_mfma_f32_16x16x32_bf16 v[216:219], a[212:215], a[64:67], 0
    v_mfma_f32_16x16x32_bf16 v[220:223], a[212:215], a[96:99], 0
    v_mfma_f32_16x16x32_bf16 v[208:211], a[216:219], a[4:7], v[208:211]
    v_mfma_f32_16x16x32_bf16 v[212:215], a[216:219], a[36:39], v[212:215]
    v_mfma_f32_16x16x32_bf16 v[216:219], a[216:219], a[68:71], v[216:219]
    v_mfma_f32_16x16x32_bf16 v[220:223], a[216:219], a[100:103], v[220:223]
    v_mfma_f32_16x16x32_bf16 v[208:211], a[220:223], a[8:11], v[208:211]
    v_mfma_f32_16x16x32_bf16 v[212:215], a[220:223], a[40:43], v[212:215]
    v_mfma_f32_16x16x32_bf16 v[216:219], a[220:223], a[72:75], v[216:219]
    v_mfma_f32_16x16x32_bf16 v[220:223], a[220:223], a[104:107], v[220:223]
    v_mfma_f32_16x16x32_bf16 v[208:211], a[224:227], a[12:15], v[208:211]
    v_mfma_f32_16x16x32_bf16 v[212:215], a[224:227], a[44:47], v[212:215]
    v_mfma_f32_16x16x32_bf16 v[216:219], a[224:227], a[76:79], v[216:219]
    v_mfma_f32_16x16x32_bf16 v[220:223], a[224:227], a[108:111], v[220:223]
    v_mfma_f32_16x16x32_bf16 v[208:211], a[228:231], a[16:19], v[208:211]
    v_mfma_f32_16x16x32_bf16 v[212:215], a[228:231], a[48:51], v[212:215]
    v_mfma_f32_16x16x32_bf16 v[216:219], a[228:231], a[80:83], v[216:219]
    v_mfma_f32_16x16x32_bf16 v[220:223], a[228:231], a[112:115], v[220:223]
    v_mfma_f32_16x16x32_bf16 v[208:211], a[232:235], a[20:23], v[208:211]
    v_mfma_f32_16x16x32_bf16 v[212:215], a[232:235], a[52:55], v[212:215]
    v_mfma_f32_16x16x32_bf16 v[216:219], a[232:235], a[84:87], v[216:219]
    v_mfma_f32_16x16x32_bf16 v[220:223], a[232:235], a[116:119], v[220:223]
    v_mfma_f32_16x16x32_bf16 v[208:211], a[236:239], a[24:27], v[208:211]
    v_mfma_f32_16x16x32_bf16 v[212:215], a[236:239], a[56:59], v[212:215]
    v_mfma_f32_16x16x32_bf16 v[216:219], a[236:239], a[88:91], v[216:219]
    v_mfma_f32_16x16x32_bf16 v[220:223], a[236:239], a[120:123], v[220:223]
    v_mfma_f32_16x16x32_bf16 v[208:211], a[240:243], a[28:31], v[208:211]
    v_mfma_f32_16x16x32_bf16 v[212:215], a[240:243], a[60:63], v[212:215]
    v_mfma_f32_16x16x32_bf16 v[216:219], a[240:243], a[92:95], v[216:219]
    v_mfma_f32_16x16x32_bf16 v[220:223], a[240:243], a[124:127], v[220:223]
    s_nop 7
    v_add_f32 v208, v238, v208
    v_add_f32 v209, v238, v209
    v_add_f32 v210, v238, v210
    v_add_f32 v211, v238, v211
    v_add_f32 v212, v239, v212
    v_add_f32 v213, v239, v213
    v_add_f32 v214, v239, v214
    v_add_f32 v215, v239, v215
    v_add_f32 v216, v240, v216
    v_add_f32 v217, v240, v217
    v_add_f32 v218, v240, v218
    v_add_f32 v219, v240, v219
    v_add_f32 v220, v241, v220
    v_add_f32 v221, v241, v221
    v_add_f32 v222, v241, v222
    v_add_f32 v223, v241, v223
    v_mul_f32 v208, s21, v208
    v_mul_f32 v209, s21, v209
    v_mul_f32 v210, s21, v210
    v_mul_f32 v211, s21, v211
    v_mul_f32 v212, s21, v212
    v_mul_f32 v213, s21, v213
    v_mul_f32 v214, s21, v214
    v_mul_f32 v215, s21, v215
    v_mul_f32 v216, s21, v216
    v_mul_f32 v217, s21, v217
    v_mul_f32 v218, s21, v218
    v_mul_f32 v219, s21, v219
    v_mul_f32 v220, s21, v220
    v_mul_f32 v221, s21, v221
    v_mul_f32 v222, s21, v222
    v_mul_f32 v223, s21, v223
    v_exp_f32 v216, v216
    v_exp_f32 v217, v217
    v_exp_f32 v218, v218
    v_exp_f32 v219, v219
    v_exp_f32 v208, v208
    v_exp_f32 v209, v209
    v_exp_f32 v210, v210
    v_exp_f32 v211, v211
    v_exp_f32 v212, v212
    v_exp_f32 v213, v213
    v_exp_f32 v214, v214
    v_exp_f32 v215, v215
    v_exp_f32 v220, v220
    v_exp_f32 v221, v221
    v_exp_f32 v222, v222
    v_exp_f32 v223, v223
    v_cvt_pk_bf16_f32 v160, v208, v209
    v_cvt_pk_bf16_f32 v161, v210, v211
    v_cvt_pk_bf16_f32 v168, v212, v213
    v_cvt_pk_bf16_f32 v169, v214, v215
    v_cvt_pk_bf16_f32 v176, v216, v217
    v_cvt_pk_bf16_f32 v177, v218, v219
    v_cvt_pk_bf16_f32 v184, v220, v221
    v_cvt_pk_bf16_f32 v185, v222, v223
    v_xor_b32 v249, 0, v250
    buffer_load_dwordx4 a[212:215], v249, s[8:11], s36 offen offset:0
    buffer_load_dwordx4 a[216:219], v249, s[8:11], s36 offen offset:64
    v_xor_b32 v249, 0x80, v250
    buffer_load_dwordx4 a[220:223], v249, s[8:11], s36 offen offset:0
    buffer_load_dwordx4 a[224:227], v249, s[8:11], s36 offen offset:64
    v_xor_b32 v249, 0x100, v250
    buffer_load_dwordx4 a[228:231], v249, s[8:11], s36 offen offset:0
    buffer_load_dwordx4 a[232:235], v249, s[8:11], s36 offen offset:64
    v_xor_b32 v249, 0x180, v250
    buffer_load_dwordx4 a[236:239], v249, s[8:11], s36 offen offset:0
    buffer_load_dwordx4 a[240:243], v249, s[8:11], s36 offen offset:64
    s_add_u32 s36, s36, 0x2000
    s_waitcnt vmcnt(0)
    v_mfma_f32_16x16x32_bf16 v[208:211], a[212:215], a[0:3], 0
    v_mfma_f32_16x16x32_bf16 v[212:215], a[212:215], a[32:35], 0
    v_mfma_f32_16x16x32_bf16 v[216:219], a[212:215], a[64:67], 0
    v_mfma_f32_16x16x32_bf16 v[220:223], a[212:215], a[96:99], 0
    v_mfma_f32_16x16x32_bf16 v[208:211], a[216:219], a[4:7], v[208:211]
    v_mfma_f32_16x16x32_bf16 v[212:215], a[216:219], a[36:39], v[212:215]
    v_mfma_f32_16x16x32_bf16 v[216:219], a[216:219], a[68:71], v[216:219]
    v_mfma_f32_16x16x32_bf16 v[220:223], a[216:219], a[100:103], v[220:223]
    v_mfma_f32_16x16x32_bf16 v[208:211], a[220:223], a[8:11], v[208:211]
    v_mfma_f32_16x16x32_bf16 v[212:215], a[220:223], a[40:43], v[212:215]
    v_mfma_f32_16x16x32_bf16 v[216:219], a[220:223], a[72:75], v[216:219]
    v_mfma_f32_16x16x32_bf16 v[220:223], a[220:223], a[104:107], v[220:223]
    v_mfma_f32_16x16x32_bf16 v[208:211], a[224:227], a[12:15], v[208:211]
    v_mfma_f32_16x16x32_bf16 v[212:215], a[224:227], a[44:47], v[212:215]
    v_mfma_f32_16x16x32_bf16 v[216:219], a[224:227], a[76:79], v[216:219]
    v_mfma_f32_16x16x32_bf16 v[220:223], a[224:227], a[108:111], v[220:223]
    v_mfma_f32_16x16x32_bf16 v[208:211], a[228:231], a[16:19], v[208:211]
    v_mfma_f32_16x16x32_bf16 v[212:215], a[228:231], a[48:51], v[212:215]
    v_mfma_f32_16x16x32_bf16 v[216:219], a[228:231], a[80:83], v[216:219]
    v_mfma_f32_16x16x32_bf16 v[220:223], a[228:231], a[112:115], v[220:223]
    v_mfma_f32_16x16x32_bf16 v[208:211], a[232:235], a[20:23], v[208:211]
    v_mfma_f32_16x16x32_bf16 v[212:215], a[232:235], a[52:55], v[212:215]
    v_mfma_f32_16x16x32_bf16 v[216:219], a[232:235], a[84:87], v[216:219]
    v_mfma_f32_16x16x32_bf16 v[220:223], a[232:235], a[116:119], v[220:223]
    v_mfma_f32_16x16x32_bf16 v[208:211], a[236:239], a[24:27], v[208:211]
    v_mfma_f32_16x16x32_bf16 v[212:215], a[236:239], a[56:59], v[212:215]
    v_mfma_f32_16x16x32_bf16 v[216:219], a[236:239], a[88:91], v[216:219]
    v_mfma_f32_16x16x32_bf16 v[220:223], a[236:239], a[120:123], v[220:223]
    v_mfma_f32_16x16x32_bf16 v[208:211], a[240:243], a[28:31], v[208:211]
    v_mfma_f32_16x16x32_bf16 v[212:215], a[240:243], a[60:63], v[212:215]
    v_mfma_f32_16x16x32_bf16 v[216:219], a[240:243], a[92:95], v[216:219]
    v_mfma_f32_16x16x32_bf16 v[220:223], a[240:243], a[124:127], v[220:223]
    s_nop 7
    v_add_f32 v208, v238, v208
    v_add_f32 v209, v238, v209
    v_add_f32 v210, v238, v210
    v_add_f32 v211, v238, v211
    v_add_f32 v212, v239, v212
    v_add_f32 v213, v239, v213
    v_add_f32 v214, v239, v214
    v_add_f32 v215, v239, v215
    v_add_f32 v216, v240, v216
    v_add_f32 v217, v240, v217
    v_add_f32 v218, v240, v218
    v_add_f32 v219, v240, v219
    v_add_f32 v220, v241, v220
    v_add_f32 v221, v241, v221
    v_add_f32 v222, v241, v222
    v_add_f32 v223, v241, v223
    v_mul_f32 v208, s21, v208
    v_mul_f32 v209, s21, v209
    v_mul_f32 v210, s21, v210
    v_mul_f32 v211, s21, v211
    v_mul_f32 v212, s21, v212
    v_mul_f32 v213, s21, v213
    v_mul_f32 v214, s21, v214
    v_mul_f32 v215, s21, v215
    v_mul_f32 v216, s21, v216
    v_mul_f32 v217, s21, v217
    v_mul_f32 v218, s21, v218
    v_mul_f32 v219, s21, v219
    v_mul_f32 v220, s21, v220
    v_mul_f32 v221, s21, v221
    v_mul_f32 v222, s21, v222
    v_mul_f32 v223, s21, v223
    v_exp_f32 v216, v216
    v_exp_f32 v217, v217
    v_exp_f32 v218, v218
    v_exp_f32 v219, v219
    v_exp_f32 v208, v208
    v_exp_f32 v209, v209
    v_exp_f32 v210, v210
    v_exp_f32 v211, v211
    v_exp_f32 v212, v212
    v_exp_f32 v213, v213
    v_exp_f32 v214, v214
    v_exp_f32 v215, v215
    v_exp_f32 v220, v220
    v_exp_f32 v221, v221
    v_exp_f32 v222, v222
    v_exp_f32 v223, v223
    v_cvt_pk_bf16_f32 v162, v208, v209
    v_cvt_pk_bf16_f32 v163, v210, v211
    v_cvt_pk_bf16_f32 v170, v212, v213
    v_cvt_pk_bf16_f32 v171, v214, v215
    v_cvt_pk_bf16_f32 v178, v216, v217
    v_cvt_pk_bf16_f32 v179, v218, v219
    v_cvt_pk_bf16_f32 v186, v220, v221
    v_cvt_pk_bf16_f32 v187, v222, v223
    v_xor_b32 v249, 0, v250
    buffer_load_dwordx4 a[212:215], v249, s[8:11], s36 offen offset:0
    buffer_load_dwordx4 a[216:219], v249, s[8:11], s36 offen offset:64
    v_xor_b32 v249, 0x80, v250
    buffer_load_dwordx4 a[220:223], v249, s[8:11], s36 offen offset:0
    buffer_load_dwordx4 a[224:227], v249, s[8:11], s36 offen offset:64
    v_xor_b32 v249, 0x100, v250
    buffer_load_dwordx4 a[228:231], v249, s[8:11], s36 offen offset:0
    buffer_load_dwordx4 a[232:235], v249, s[8:11], s36 offen offset:64
    v_xor_b32 v249, 0x180, v250
    buffer_load_dwordx4 a[236:239], v249, s[8:11], s36 offen offset:0
    buffer_load_dwordx4 a[240:243], v249, s[8:11], s36 offen offset:64
    s_add_u32 s36, s36, 0x2000
    s_waitcnt vmcnt(0)
    v_mfma_f32_16x16x32_bf16 v[208:211], a[212:215], a[0:3], 0
    v_mfma_f32_16x16x32_bf16 v[212:215], a[212:215], a[32:35], 0
    v_mfma_f32_16x16x32_bf16 v[216:219], a[212:215], a[64:67], 0
    v_mfma_f32_16x16x32_bf16 v[220:223], a[212:215], a[96:99], 0
    v_mfma_f32_16x16x32_bf16 v[208:211], a[216:219], a[4:7], v[208:211]
    v_mfma_f32_16x16x32_bf16 v[212:215], a[216:219], a[36:39], v[212:215]
    v_mfma_f32_16x16x32_bf16 v[216:219], a[216:219], a[68:71], v[216:219]
    v_mfma_f32_16x16x32_bf16 v[220:223], a[216:219], a[100:103], v[220:223]
    v_mfma_f32_16x16x32_bf16 v[208:211], a[220:223], a[8:11], v[208:211]
    v_mfma_f32_16x16x32_bf16 v[212:215], a[220:223], a[40:43], v[212:215]
    v_mfma_f32_16x16x32_bf16 v[216:219], a[220:223], a[72:75], v[216:219]
    v_mfma_f32_16x16x32_bf16 v[220:223], a[220:223], a[104:107], v[220:223]
    v_mfma_f32_16x16x32_bf16 v[208:211], a[224:227], a[12:15], v[208:211]
    v_mfma_f32_16x16x32_bf16 v[212:215], a[224:227], a[44:47], v[212:215]
    v_mfma_f32_16x16x32_bf16 v[216:219], a[224:227], a[76:79], v[216:219]
    v_mfma_f32_16x16x32_bf16 v[220:223], a[224:227], a[108:111], v[220:223]
    v_mfma_f32_16x16x32_bf16 v[208:211], a[228:231], a[16:19], v[208:211]
    v_mfma_f32_16x16x32_bf16 v[212:215], a[228:231], a[48:51], v[212:215]
    v_mfma_f32_16x16x32_bf16 v[216:219], a[228:231], a[80:83], v[216:219]
    v_mfma_f32_16x16x32_bf16 v[220:223], a[228:231], a[112:115], v[220:223]
    v_mfma_f32_16x16x32_bf16 v[208:211], a[232:235], a[20:23], v[208:211]
    v_mfma_f32_16x16x32_bf16 v[212:215], a[232:235], a[52:55], v[212:215]
    v_mfma_f32_16x16x32_bf16 v[216:219], a[232:235], a[84:87], v[216:219]
    v_mfma_f32_16x16x32_bf16 v[220:223], a[232:235], a[116:119], v[220:223]
    v_mfma_f32_16x16x32_bf16 v[208:211], a[236:239], a[24:27], v[208:211]
    v_mfma_f32_16x16x32_bf16 v[212:215], a[236:239], a[56:59], v[212:215]
    v_mfma_f32_16x16x32_bf16 v[216:219], a[236:239], a[88:91], v[216:219]
    v_mfma_f32_16x16x32_bf16 v[220:223], a[236:239], a[120:123], v[220:223]
    v_mfma_f32_16x16x32_bf16 v[208:211], a[240:243], a[28:31], v[208:211]
    v_mfma_f32_16x16x32_bf16 v[212:215], a[240:243], a[60:63], v[212:215]
    v_mfma_f32_16x16x32_bf16 v[216:219], a[240:243], a[92:95], v[216:219]
    v_mfma_f32_16x16x32_bf16 v[220:223], a[240:243], a[124:127], v[220:223]
    s_nop 7
    v_add_f32 v208, v238, v208
    v_add_f32 v209, v238, v209
    v_add_f32 v210, v238, v210
    v_add_f32 v211, v238, v211
    v_add_f32 v212, v239, v212
    v_add_f32 v213, v239, v213
    v_add_f32 v214, v239, v214
    v_add_f32 v215, v239, v215
    v_add_f32 v216, v240, v216
    v_add_f32 v217, v240, v217
    v_add_f32 v218, v240, v218
    v_add_f32 v219, v240, v219
    v_add_f32 v220, v241, v220
    v_add_f32 v221, v241, v221
    v_add_f32 v222, v241, v222
    v_add_f32 v223, v241, v223
    v_mul_f32 v208, s21, v208
    v_mul_f32 v209, s21, v209
    v_mul_f32 v210, s21, v210
    v_mul_f32 v211, s21, v211
    v_mul_f32 v212, s21, v212
    v_mul_f32 v213, s21, v213
    v_mul_f32 v214, s21, v214
    v_mul_f32 v215, s21, v215
    v_mul_f32 v216, s21, v216
    v_mul_f32 v217, s21, v217
    v_mul_f32 v218, s21, v218
    v_mul_f32 v219, s21, v219
    v_mul_f32 v220, s21, v220
    v_mul_f32 v221, s21, v221
    v_mul_f32 v222, s21, v222
    v_mul_f32 v223, s21, v223
    v_exp_f32 v216, v216
    v_exp_f32 v217, v217
    v_exp_f32 v218, v218
    v_exp_f32 v219, v219
    v_exp_f32 v208, v208
    v_exp_f32 v209, v209
    v_exp_f32 v210, v210
    v_exp_f32 v211, v211
    v_exp_f32 v212, v212
    v_exp_f32 v213, v213
    v_exp_f32 v214, v214
    v_exp_f32 v215, v215
    v_exp_f32 v220, v220
    v_exp_f32 v221, v221
    v_exp_f32 v222, v222
    v_exp_f32 v223, v223
    v_cvt_pk_bf16_f32 v164, v208, v209
    v_cvt_pk_bf16_f32 v165, v210, v211
    v_cvt_pk_bf16_f32 v172, v212, v213
    v_cvt_pk_bf16_f32 v173, v214, v215
    v_cvt_pk_bf16_f32 v180, v216, v217
    v_cvt_pk_bf16_f32 v181, v218, v219
    v_cvt_pk_bf16_f32 v188, v220, v221
    v_cvt_pk_bf16_f32 v189, v222, v223
    v_xor_b32 v249, 0, v250
    buffer_load_dwordx4 a[212:215], v249, s[8:11], s36 offen offset:0
    buffer_load_dwordx4 a[216:219], v249, s[8:11], s36 offen offset:64
    v_xor_b32 v249, 0x80, v250
    buffer_load_dwordx4 a[220:223], v249, s[8:11], s36 offen offset:0
    buffer_load_dwordx4 a[224:227], v249, s[8:11], s36 offen offset:64
    v_xor_b32 v249, 0x100, v250
    buffer_load_dwordx4 a[228:231], v249, s[8:11], s36 offen offset:0
    buffer_load_dwordx4 a[232:235], v249, s[8:11], s36 offen offset:64
    v_xor_b32 v249, 0x180, v250
    buffer_load_dwordx4 a[236:239], v249, s[8:11], s36 offen offset:0
    buffer_load_dwordx4 a[240:243], v249, s[8:11], s36 offen offset:64
    s_add_u32 s36, s36, 0x2000
    s_waitcnt vmcnt(0)
    v_mfma_f32_16x16x32_bf16 v[208:211], a[212:215], a[0:3], 0
    v_mfma_f32_16x16x32_bf16 v[212:215], a[212:215], a[32:35], 0
    v_mfma_f32_16x16x32_bf16 v[216:219], a[212:215], a[64:67], 0
    v_mfma_f32_16x16x32_bf16 v[220:223], a[212:215], a[96:99], 0
    v_mfma_f32_16x16x32_bf16 v[208:211], a[216:219], a[4:7], v[208:211]
    v_mfma_f32_16x16x32_bf16 v[212:215], a[216:219], a[36:39], v[212:215]
    v_mfma_f32_16x16x32_bf16 v[216:219], a[216:219], a[68:71], v[216:219]
    v_mfma_f32_16x16x32_bf16 v[220:223], a[216:219], a[100:103], v[220:223]
    v_mfma_f32_16x16x32_bf16 v[208:211], a[220:223], a[8:11], v[208:211]
    v_mfma_f32_16x16x32_bf16 v[212:215], a[220:223], a[40:43], v[212:215]
    v_mfma_f32_16x16x32_bf16 v[216:219], a[220:223], a[72:75], v[216:219]
    v_mfma_f32_16x16x32_bf16 v[220:223], a[220:223], a[104:107], v[220:223]
    v_mfma_f32_16x16x32_bf16 v[208:211], a[224:227], a[12:15], v[208:211]
    v_mfma_f32_16x16x32_bf16 v[212:215], a[224:227], a[44:47], v[212:215]
    v_mfma_f32_16x16x32_bf16 v[216:219], a[224:227], a[76:79], v[216:219]
    v_mfma_f32_16x16x32_bf16 v[220:223], a[224:227], a[108:111], v[220:223]
    v_mfma_f32_16x16x32_bf16 v[208:211], a[228:231], a[16:19], v[208:211]
    v_mfma_f32_16x16x32_bf16 v[212:215], a[228:231], a[48:51], v[212:215]
    v_mfma_f32_16x16x32_bf16 v[216:219], a[228:231], a[80:83], v[216:219]
    v_mfma_f32_16x16x32_bf16 v[220:223], a[228:231], a[112:115], v[220:223]
    v_mfma_f32_16x16x32_bf16 v[208:211], a[232:235], a[20:23], v[208:211]
    v_mfma_f32_16x16x32_bf16 v[212:215], a[232:235], a[52:55], v[212:215]
    v_mfma_f32_16x16x32_bf16 v[216:219], a[232:235], a[84:87], v[216:219]
    v_mfma_f32_16x16x32_bf16 v[220:223], a[232:235], a[116:119], v[220:223]
    v_mfma_f32_16x16x32_bf16 v[208:211], a[236:239], a[24:27], v[208:211]
    v_mfma_f32_16x16x32_bf16 v[212:215], a[236:239], a[56:59], v[212:215]
    v_mfma_f32_16x16x32_bf16 v[216:219], a[236:239], a[88:91], v[216:219]
    v_mfma_f32_16x16x32_bf16 v[220:223], a[236:239], a[120:123], v[220:223]
    v_mfma_f32_16x16x32_bf16 v[208:211], a[240:243], a[28:31], v[208:211]
    v_mfma_f32_16x16x32_bf16 v[212:215], a[240:243], a[60:63], v[212:215]
    v_mfma_f32_16x16x32_bf16 v[216:219], a[240:243], a[92:95], v[216:219]
    v_mfma_f32_16x16x32_bf16 v[220:223], a[240:243], a[124:127], v[220:223]
    s_nop 7
    v_add_f32 v208, v238, v208
    v_add_f32 v209, v238, v209
    v_add_f32 v210, v238, v210
    v_add_f32 v211, v238, v211
    v_add_f32 v212, v239, v212
    v_add_f32 v213, v239, v213
    v_add_f32 v214, v239, v214
    v_add_f32 v215, v239, v215
    v_add_f32 v216, v240, v216
    v_add_f32 v217, v240, v217
    v_add_f32 v218, v240, v218
    v_add_f32 v219, v240, v219
    v_add_f32 v220, v241, v220
    v_add_f32 v221, v241, v221
    v_add_f32 v222, v241, v222
    v_add_f32 v223, v241, v223
    v_mul_f32 v208, s21, v208
    v_mul_f32 v209, s21, v209
    v_mul_f32 v210, s21, v210
    v_mul_f32 v211, s21, v211
    v_mul_f32 v212, s21, v212
    v_mul_f32 v213, s21, v213
    v_mul_f32 v214, s21, v214
    v_mul_f32 v215, s21, v215
    v_mul_f32 v216, s21, v216
    v_mul_f32 v217, s21, v217
    v_mul_f32 v218, s21, v218
    v_mul_f32 v219, s21, v219
    v_mul_f32 v220, s21, v220
    v_mul_f32 v221, s21, v221
    v_mul_f32 v222, s21, v222
    v_mul_f32 v223, s21, v223
    v_exp_f32 v216, v216
    v_exp_f32 v217, v217
    v_exp_f32 v218, v218
    v_exp_f32 v219, v219
    v_exp_f32 v208, v208
    v_exp_f32 v209, v209
    v_exp_f32 v210, v210
    v_exp_f32 v211, v211
    v_exp_f32 v212, v212
    v_exp_f32 v213, v213
    v_exp_f32 v214, v214
    v_exp_f32 v215, v215
    v_exp_f32 v220, v220
    v_exp_f32 v221, v221
    v_exp_f32 v222, v222
    v_exp_f32 v223, v223
    v_cvt_pk_bf16_f32 v166, v208, v209
    v_cvt_pk_bf16_f32 v167, v210, v211
    v_cvt_pk_bf16_f32 v174, v212, v213
    v_cvt_pk_bf16_f32 v175, v214, v215
    v_cvt_pk_bf16_f32 v182, v216, v217
    v_cvt_pk_bf16_f32 v183, v218, v219
    v_cvt_pk_bf16_f32 v190, v220, v221
    v_cvt_pk_bf16_f32 v191, v222, v223
    s_nop 1
    v_mfma_f32_16x16x32_bf16 a[192:195], a[208:211], v[160:163], a[192:195]
    v_mfma_f32_16x16x32_bf16 a[196:199], a[208:211], v[168:171], a[196:199]
    v_mfma_f32_16x16x32_bf16 a[200:203], a[208:211], v[176:179], a[200:203]
    v_mfma_f32_16x16x32_bf16 a[204:207], a[208:211], v[184:187], a[204:207]
    v_mfma_f32_16x16x32_bf16 a[192:195], a[208:211], v[164:167], a[192:195]
    v_mfma_f32_16x16x32_bf16 a[196:199], a[208:211], v[172:175], a[196:199]
    v_mfma_f32_16x16x32_bf16 a[200:203], a[208:211], v[180:183], a[200:203]
    v_mfma_f32_16x16x32_bf16 a[204:207], a[208:211], v[188:191], a[204:207]
    s_add_u32 s39, s39, 1
    s_cmp_lt_u32 s39, 6
    s_cbranch_scc1 L_slowB
    s_nop 7
    v_accvgpr_read_b32 v246, a192
    v_accvgpr_read_b32 v247, a196
    v_accvgpr_read_b32 v248, a200
    v_accvgpr_read_b32 v249, a204
    v_rcp_f32 v242, v246
    v_rcp_f32 v243, v247
    v_rcp_f32 v244, v248
    v_rcp_f32 v245, v249
    v_xor_b32 v250, 32, v230
    s_cmp_eq_u32 s25, 2
    s_cselect_b32 s36, 0x14000, 0
    v_add_u32 v250, s36, v250
    ds_read_b64_tr_b16 a[212:213], v250 offset:0
    ds_read_b64_tr_b16 a[214:215], v250 offset:2048
    ds_read_b64_tr_b16 a[216:217], v250 offset:4096
    ds_read_b64_tr_b16 a[218:219], v250 offset:6144
    ds_read_b64_tr_b16 a[220:221], v250 offset:8192
    ds_read_b64_tr_b16 a[222:223], v250 offset:10240
    ds_read_b64_tr_b16 a[224:225], v250 offset:12288
    ds_read_b64_tr_b16 a[226:227], v250 offset:14336
    ds_read_b64_tr_b16 a[228:229], v250 offset:16384
    ds_read_b64_tr_b16 a[230:231], v250 offset:18432
    ds_read_b64_tr_b16 a[232:233], v250 offset:20480
    ds_read_b64_tr_b16 a[234:235], v250 offset:22528
    s_waitcnt lgkmcnt(0)
    v_mfma_f32_16x16x32_bf16 v[192:195], a[212:215], v[0:3], 0
    v_mfma_f32_16x16x32_bf16 v[196:199], a[212:215], v[8:11], 0
    v_mfma_f32_16x16x32_bf16 v[200:203], a[212:215], v[16:19], 0
    v_mfma_f32_16x16x32_bf16 v[204:207], a[212:215], v[24:27], 0
    v_mfma_f32_16x16x32_bf16 v[192:195], a[216:219], v[4:7], v[192:195]
    v_mfma_f32_16x16x32_bf16 v[196:199], a[216:219], v[12:15], v[196:199]
    v_mfma_f32_16x16x32_bf16 v[200:203], a[216:219], v[20:23], v[200:203]
    v_mfma_f32_16x16x32_bf16 v[204:207], a[216:219], v[28:31], v[204:207]
    v_mfma_f32_16x16x32_bf16 v[192:195], a[220:223], v[32:35], v[192:195]
    v_mfma_f32_16x16x32_bf16 v[196:199], a[220:223], v[40:43], v[196:199]
    v_mfma_f32_16x16x32_bf16 v[200:203], a[220:223], v[48:51], v[200:203]
    v_mfma_f32_16x16x32_bf16 v[204:207], a[220:223], v[56:59], v[204:207]
    v_mfma_f32_16x16x32_bf16 v[192:195], a[224:227], v[36:39], v[192:195]
    v_mfma_f32_16x16x32_bf16 v[196:199], a[224:227], v[44:47], v[196:199]
    v_mfma_f32_16x16x32_bf16 v[200:203], a[224:227], v[52:55], v[200:203]
    v_mfma_f32_16x16x32_bf16 v[204:207], a[224:227], v[60:63], v[204:207]
    v_mfma_f32_16x16x32_bf16 v[192:195], a[228:231], v[64:67], v[192:195]
    v_mfma_f32_16x16x32_bf16 v[196:199], a[228:231], v[72:75], v[196:199]
    v_mfma_f32_16x16x32_bf16 v[200:203], a[228:231], v[80:83], v[200:203]
    v_mfma_f32_16x16x32_bf16 v[204:207], a[228:231], v[88:91], v[204:207]
    v_mfma_f32_16x16x32_bf16 v[192:195], a[232:235], v[68:71], v[192:195]
    v_mfma_f32_16x16x32_bf16 v[196:199], a[232:235], v[76:79], v[196:199]
    v_mfma_f32_16x16x32_bf16 v[200:203], a[232:235], v[84:87], v[200:203]
    v_mfma_f32_16x16x32_bf16 v[204:207], a[232:235], v[92:95], v[204:207]
    ds_read_b64_tr_b16 a[212:213], v250 offset:24576
    ds_read_b64_tr_b16 a[214:215], v250 offset:26624
    ds_read_b64_tr_b16 a[216:217], v250 offset:28672
    ds_read_b64_tr_b16 a[218:219], v250 offset:30720
    ds_read_b64_tr_b16 a[220:221], v250 offset:32768
    ds_read_b64_tr_b16 a[222:223], v250 offset:34816
    ds_read_b64_tr_b16 a[224:225], v250 offset:36864
    ds_read_b64_tr_b16 a[226:227], v250 offset:38912
    ds_read_b64_tr_b16 a[228:229], v250 offset:40960
    ds_read_b64_tr_b16 a[230:231], v250 offset:43008
    ds_read_b64_tr_b16 a[232:233], v250 offset:45056
    ds_read_b64_tr_b16 a[234:235], v250 offset:47104
    s_waitcnt lgkmcnt(0)
    v_mfma_f32_16x16x32_bf16 v[192:195], a[212:215], v[96:99], v[192:195]
    v_mfma_f32_16x16x32_bf16 v[196:199], a[212:215], v[104:107], v[196:199]
    v_mfma_f32_16x16x32_bf16 v[200:203], a[212:215], v[112:115], v[200:203]
    v_mfma_f32_16x16x32_bf16 v[204:207], a[212:215], v[120:123], v[204:207]
    v_mfma_f32_16x16x32_bf16 v[192:195], a[216:219], v[100:103], v[192:195]
    v_mfma_f32_16x16x32_bf16 v[196:199], a[216:219], v[108:111], v[196:199]
    v_mfma_f32_16x16x32_bf16 v[200:203], a[216:219], v[116:119], v[200:203]
    v_mfma_f32_16x16x32_bf16 v[204:207], a[216:219], v[124:127], v[204:207]
    v_mfma_f32_16x16x32_bf16 v[192:195], a[220:223], v[128:131], v[192:195]
    v_mfma_f32_16x16x32_bf16 v[196:199], a[220:223], v[136:139], v[196:199]
    v_mfma_f32_16x16x32_bf16 v[200:203], a[220:223], v[144:147], v[200:203]
    v_mfma_f32_16x16x32_bf16 v[204:207], a[220:223], v[152:155], v[204:207]
    v_mfma_f32_16x16x32_bf16 v[192:195], a[224:227], v[132:135], v[192:195]
    v_mfma_f32_16x16x32_bf16 v[196:199], a[224:227], v[140:143], v[196:199]
    v_mfma_f32_16x16x32_bf16 v[200:203], a[224:227], v[148:151], v[200:203]
    v_mfma_f32_16x16x32_bf16 v[204:207], a[224:227], v[156:159], v[204:207]
    v_mfma_f32_16x16x32_bf16 v[192:195], a[228:231], v[160:163], v[192:195]
    v_mfma_f32_16x16x32_bf16 v[196:199], a[228:231], v[168:171], v[196:199]
    v_mfma_f32_16x16x32_bf16 v[200:203], a[228:231], v[176:179], v[200:203]
    v_mfma_f32_16x16x32_bf16 v[204:207], a[228:231], v[184:187], v[204:207]
    v_mfma_f32_16x16x32_bf16 v[192:195], a[232:235], v[164:167], v[192:195]
    v_mfma_f32_16x16x32_bf16 v[196:199], a[232:235], v[172:175], v[196:199]
    v_mfma_f32_16x16x32_bf16 v[200:203], a[232:235], v[180:183], v[200:203]
    v_mfma_f32_16x16x32_bf16 v[204:207], a[232:235], v[188:191], v[204:207]
    s_nop 7
    s_cmp_eq_u32 s25, 2
    s_cbranch_scc1 L_back_last
    s_branch L_back_mid
.section .rodata,"a"
.p2align 6
.amdhsa_kernel standalone__gqa_softmax__near_ridge_kernel
  .amdhsa_next_free_vgpr 512
  .amdhsa_next_free_sgpr 102
  .amdhsa_accum_offset 256
  .amdhsa_group_segment_fixed_size 0
  .amdhsa_kernarg_size 48
  .amdhsa_user_sgpr_count 2
  .amdhsa_user_sgpr_kernarg_segment_ptr 1
  .amdhsa_system_sgpr_workgroup_id_x 1
.end_amdhsa_kernel
```
